```python
import torch

def _softmax(x, axis=-1):
    return torch.softmax(x, dim=axis)

def _gelu(x):
    return torch.nn.functional.gelu(x, approximate='tanh')

def _silu(x):
    return torch.nn.functional.silu(x)

def _sigmoid(x):
    return torch.sigmoid(x)

def _layernorm(x, axis=-1, eps=1e-05):
    m = x.mean(dim=axis, keepdim=True)
    v = x.var(dim=axis, keepdim=True, unbiased=False)
    return (x - m) / torch.sqrt(v + eps)

def _scatter_add(tgt, idx, src, axis=0):
    return tgt.clone().index_add_(axis, idx, src)

def _segment_sum(src, seg, n):
    out = torch.zeros((n,) + src.shape[1:], dtype=src.dtype)
    return out.index_add_(0, seg, src)

def _pad(x, pw):
    flat = tuple((v for pair in reversed(pw) for v in pair))
    return torch.nn.functional.pad(x, flat)
kernel_name = 'adaLN_cond__linear_kernel_hedgehog__geglu_ffn__prompt'

def setup_inputs():

    _w = lambda a: (lambda t: t.to(torch.bfloat16) if t.is_floating_point() else t)(torch.as_tensor(a))

    def _A_setup():
        B, S, D, H = (1, 2048, 448, 16)
        Dh = D // H
        return {'x': _w((lambda *s: torch.randn(*s, dtype=torch.bfloat16) * 0.05)(B, S, D)), 'wqkv': _w((lambda *s: torch.randn(*s, dtype=torch.bfloat16) * 0.4)(D, 3 * D)), 'w_phi': _w((lambda *s: torch.randn(*s, dtype=torch.bfloat16) * 0.4)(H, Dh, Dh) * Dh ** (-0.5)), 'wo': _w((lambda *s: torch.randn(*s, dtype=torch.bfloat16) * 0.05)(D, D))}
    _A_in = _A_setup()

    def _B_setup():
        B, S, D, F = (1, 2048, 448, 1792)
        return {'x': _w((lambda *s: torch.randn(*s, dtype=torch.bfloat16) * 0.05)(B, S, D)), 'w_gate': _w((lambda *s: torch.randn(*s, dtype=torch.bfloat16) * 0.05)(D, F)), 'w_up': _w((lambda *s: torch.randn(*s, dtype=torch.bfloat16) * 0.05)(D, F)), 'w_down': _w((lambda *s: torch.randn(*s, dtype=torch.bfloat16) * 0.05)(F, D))}
    _B_in = _B_setup()
    return {'A_x': _A_in['x'], 'A_wqkv': _A_in['wqkv'], 'A_w_phi': _A_in['w_phi'], 'A_wo': _A_in['wo'], 'B_x': _B_in['x'], 'B_w_gate': _B_in['w_gate'], 'B_w_up': _B_in['w_up'], 'B_w_down': _B_in['w_down'], 'c': _w((lambda *s: torch.randn(*s, dtype=torch.bfloat16) * 0.1)(1, 448) * 8.0), 'w_mod': _w((lambda *s: torch.randn(*s, dtype=torch.bfloat16) * 0.1)(448, 6 * 448) * 448 ** (-0.5) * 8.0)}

def reference(A_x, A_wqkv, A_w_phi, A_wo, B_x, B_w_gate, B_w_up, B_w_down, c, w_mod):

    def _A_ref(x, wqkv, w_phi, wo):
        B, S, D = x.shape
        H = 16
        Dh = D // H
        qkv = (lambda x, *d: x.permute(*d))((x @ wqkv).reshape(B, S, 3, H, Dh), 2, 0, 3, 1, 4)
        q, k, v = (qkv[0], qkv[1], qkv[2])
        pq = torch.einsum('bhsd,hdf->bhsf', q, w_phi)
        pk = torch.einsum('bhsd,hdf->bhsf', k, w_phi)
        phi_q = torch.concatenate([_softmax(pq, axis=-1), _softmax(-pq, axis=-1)], axis=-1)
        phi_k = torch.concatenate([_softmax(pk, axis=-1), _softmax(-pk, axis=-1)], axis=-1)
        kv = torch.einsum('bhsf,bhsd->bhfd', phi_k, v)
        z = torch.einsum('bhsf->bhf', phi_k)
        num = torch.einsum('bhqf,bhfd->bhqd', phi_q, kv)
        den = torch.einsum('bhqf,bhf->bhq', phi_q, z)[..., None] + 1e-06
        o = num / den
        return (lambda x, *d: x.permute(*d))(o, 0, 2, 1, 3).reshape(B, S, D) @ wo

    def _B_ref(x, w_gate, w_up, w_down):
        return _gelu(x @ w_gate) * (x @ w_up) @ w_down
    x = A_x
    mod = (_silu(c) @ w_mod).reshape(c.shape[0], 6, 1, -1)
    sa, ca, ga, sb, cb, gb = (mod[:, 0].clone(), mod[:, 1].clone(), mod[:, 2].clone(), mod[:, 3].clone(), mod[:, 4].clone(), mod[:, 5].clone())
    h = _layernorm(x, axis=-1) * (1 + ca) + sa
    x = x + ga * _A_ref(h, A_wqkv, A_w_phi, A_wo)
    h = _layernorm(x, axis=-1) * (1 + cb) + sb
    x = x + gb * _B_ref(h, B_w_gate, B_w_up, B_w_down)
    return x
```

```asm
; @launch grid=(256,1,1) block=(256,1,1) lds=157440
.amdgcn_target "amdgcn-amd-amdhsa--gfx950"
.text
.globl adaLN_cond__linear_kernel_hedgehog__geglu_ffn__prompt_kernel
.p2align 8
.type adaLN_cond__linear_kernel_hedgehog__geglu_ffn__prompt_kernel,@function
adaLN_cond__linear_kernel_hedgehog__geglu_ffn__prompt_kernel:
  s_cmp_ge_u32 s2, 256
  s_cbranch_scc1 .Lexit1
  s_load_dwordx16 s[4:19], s[0:1], 0
  s_load_dwordx8 s[20:27], s[0:1], 64
  s_load_dwordx2 s[28:29], s[0:1], 96
  v_and_b32 v1, 63, v0
  v_lshrrev_b32 v2, 6, v0
  s_nop 0
  v_readfirstlane_b32 s3, v2
  v_lshlrev_b32 v2, 4, v1
  v_lshrrev_b32 v10, 5, v1
  s_and_b32 s44, s2, 7
  s_bfe_u32 s45, s2, 65539
  s_lshl1_add_u32 s44, s44, s45
  s_lshr_b32 s45, s2, 4
  s_mov_b32 s31, s45
  s_sub_u32 s57, s44, s45
  s_and_b32 s57, s57, 15
  s_lshr_b32 s58, s2, 3
  s_mul_i32 s54, s31, 37
  s_lshr_b32 s54, s54, 8
  s_mul_i32 s54, s54, 7
  s_sub_u32 s31, s31, s54
  s_lshl_b32 s59, s3, 13
  s_add_u32 s59, s59, 114688
  s_cmp_lt_u32 s3, 3
  s_cbranch_scc1 .Ljob2
  s_cmp_ge_u32 s2, 56
  s_cbranch_scc1 .Lcpf6
  v_lshrrev_b32 v247, 3, v1
  v_and_b32 v248, 7, v1
  v_mul_u32_u24 v246, 28, v247
  v_mul_u32_u24 v247, 75264, v247
  v_lshl_add_u32 v247, v248, 4, v247
  v_min_u32 v248, 6, v248
  v_lshl_add_u32 v246, v248, 2, v246
  s_and_b32 s55, s2, 3
  s_mul_i32 s54, s55, 602112
  s_mul_i32 s55, s55, 224
  s_lshr_b32 s62, s2, 2
  s_lshl_b32 s62, s62, 7
  s_add_u32 s54, s54, s62
  s_waitcnt lgkmcnt(0)
  s_mov_b32 s40, s20
  s_mov_b32 s41, s21
  s_mov_b32 s42, 0x380
  s_mov_b32 s43, 0x00020000
  s_mov_b32 s64, s22
  s_mov_b32 s65, s23
  s_mov_b32 s66, 0x24c000
  s_mov_b32 s67, 0x00020000
  buffer_load_dword v128, v246, s[40:43], s55 offen
  buffer_load_dwordx4 v[136:139], v247, s[64:67], s54 offen
  s_add_u32 s54, s54, 5376
  buffer_load_dwordx4 v[140:143], v247, s[64:67], s54 offen
  s_add_u32 s54, s54, 5376
  buffer_load_dwordx4 v[144:147], v247, s[64:67], s54 offen
  s_add_u32 s54, s54, 5376
  buffer_load_dwordx4 v[148:151], v247, s[64:67], s54 offen
  s_add_u32 s54, s54, 5376
  buffer_load_dwordx4 v[152:155], v247, s[64:67], s54 offen
  s_add_u32 s54, s54, 5376
  buffer_load_dwordx4 v[156:159], v247, s[64:67], s54 offen
  s_add_u32 s54, s54, 5376
  buffer_load_dwordx4 v[160:163], v247, s[64:67], s54 offen
  s_add_u32 s54, s54, 5376
  buffer_load_dwordx4 v[164:167], v247, s[64:67], s54 offen
  s_add_u32 s54, s54, 5376
  buffer_load_dwordx4 v[168:171], v247, s[64:67], s54 offen
  s_add_u32 s54, s54, 5376
  buffer_load_dwordx4 v[172:175], v247, s[64:67], s54 offen
  s_add_u32 s54, s54, 5376
  buffer_load_dwordx4 v[176:179], v247, s[64:67], s54 offen
  s_add_u32 s54, s54, 5376
  buffer_load_dwordx4 v[180:183], v247, s[64:67], s54 offen
  s_add_u32 s54, s54, 5376
  buffer_load_dwordx4 v[184:187], v247, s[64:67], s54 offen
  s_add_u32 s54, s54, 5376
  buffer_load_dwordx4 v[188:191], v247, s[64:67], s54 offen
  s_branch .Ljob2
.Lcpf6:
  s_cmp_lt_u32 s58, 28
  s_cbranch_scc1 .Ljob2
  s_sub_u32 s55, s58, 28
  s_mul_i32 s55, s55, 3
  s_getpc_b64 s[62:63]
.Lpc7:
  v_lshlrev_b32 v128, 6, v1
  s_lshl_b32 s64, s55, 12
  v_add_u32 v128, s64, v128
  v_min_u32 v128, .Lcode_end-.Lpc7-4, v128
  v_mov_b32 v129, s63
  v_add_co_u32 v128, vcc, s62, v128
  s_nop 1
  v_addc_co_u32 v129, vcc, 0, v129, vcc
  global_load_dword v130, v[128:129], off
  v_lshlrev_b32 v128, 6, v1
  s_lshl_b32 s64, s55, 12
  s_add_u32 s64, s64, 4096
  v_add_u32 v128, s64, v128
  v_min_u32 v128, .Lcode_end-.Lpc7-4, v128
  v_mov_b32 v129, s63
  v_add_co_u32 v128, vcc, s62, v128
  s_nop 1
  v_addc_co_u32 v129, vcc, 0, v129, vcc
  global_load_dword v131, v[128:129], off
  v_lshlrev_b32 v128, 6, v1
  s_lshl_b32 s64, s55, 12
  s_add_u32 s64, s64, 8192
  v_add_u32 v128, s64, v128
  v_min_u32 v128, .Lcode_end-.Lpc7-4, v128
  v_mov_b32 v129, s63
  v_add_co_u32 v128, vcc, s62, v128
  s_nop 1
  v_addc_co_u32 v129, vcc, 0, v129, vcc
  global_load_dword v132, v[128:129], off
.Ljob2:
  s_cmp_ge_u32 s57, 14
  s_cbranch_scc1 .Lbtype5
  s_cmp_eq_u32 s3, 3
  s_cbranch_scc1 .Lxld4
  v_lshrrev_b32 v246, 2, v1
  v_mul_u32_u24 v246, 2688, v246
  v_and_b32 v247, 3, v1
  v_lshl_add_u32 v246, v247, 4, v246
  s_add_u32 s55, s3, 1
  s_cmp_eq_u32 s3, 2
  s_cselect_b32 s55, 0, s55
  s_mul_i32 s55, s55, 896
  s_mul_i32 s54, s57, 86016
  s_add_u32 s54, s54, s55
  s_mul_i32 s55, s45, 56
  s_add_u32 s54, s54, s55
  s_add_u32 s55, s54, 43008
  s_mov_b32 m0, s59
  s_waitcnt lgkmcnt(0)
  s_mov_b32 s40, s6
  s_mov_b32 s41, s7
  s_mov_b32 s42, 0x126000
  s_mov_b32 s43, 0x00020000
  buffer_load_dwordx4 v246, s[40:43], s54 offen lds
  s_add_u32 m0, s59, 1024
  s_nop 0
  buffer_load_dwordx4 v246, s[40:43], s55 offen lds
  s_branch .Lxld4
.Lbtype5:
  v_lshrrev_b32 v246, 4, v1
  v_mul_u32_u24 v246, 896, v246
  v_and_b32 v247, 15, v1
  v_lshl_add_u32 v246, v247, 4, v246
  s_mul_i32 s54, s45, 28
  s_lshl_b32 s55, s57, 4
  s_add_u32 s54, s54, s55
  s_sub_u32 s54, s54, 224
  s_mul_i32 s54, s54, 896
  s_mul_i32 s55, s3, 224
  s_add_u32 s54, s54, s55
  s_waitcnt lgkmcnt(0)
  s_mov_b32 s40, s10
  s_mov_b32 s41, s11
  s_mov_b32 s42, 0x62000
  s_mov_b32 s43, 0x00020000
  s_add_u32 m0, s59, 0
  s_nop 0
  buffer_load_dwordx4 v246, s[40:43], s54 offen lds
  s_add_u32 s54, s54, 3584
  s_add_u32 m0, s59, 1024
  s_nop 0
  buffer_load_dwordx4 v246, s[40:43], s54 offen lds
  s_add_u32 s54, s54, 3584
  s_add_u32 m0, s59, 2048
  s_nop 0
  buffer_load_dwordx4 v246, s[40:43], s54 offen lds
  s_add_u32 s54, s54, 3584
  s_add_u32 m0, s59, 3072
  s_nop 0
  buffer_load_dwordx4 v246, s[40:43], s54 offen lds
  s_lshl_b32 s55, s3, 4
  s_add_u32 s55, s55, s57
  s_cmp_lg_u32 s55, 15
  s_cbranch_scc1 .Lxld4
  s_mov_b32 s40, s8
  s_mov_b32 s41, s9
  s_mov_b32 s42, 0x6200
  s_mov_b32 s43, 0x00020000
  s_mul_i32 s54, s45, 1568
  v_bfe_u32 v160, v1, 3, 2
  v_and_b32 v161, 3, v1
  v_lshl_add_u32 v160, v160, 2, v161
  v_bfe_u32 v161, v1, 2, 1
  v_mad_u32_u24 v161, v161, 14, v160
  v_mul_u32_u24 v162, 224, v10
  v_lshl_add_u32 v162, v161, 1, v162
  v_mov_b32 v164, 0x40000000
  v_cmp_lt_u32 vcc, 13, v160
  s_nop 1
  v_cndmask_b32 v162, v162, v164, vcc
  v_cmp_eq_u32 vcc, 1, v10
  s_nop 1
  v_cndmask_b32 v163, v162, v164, vcc
  buffer_load_ushort v176, v162, s[40:43], s54 offen offset:0
  buffer_load_ushort v177, v162, s[40:43], s54 offen offset:56
  buffer_load_ushort v178, v162, s[40:43], s54 offen offset:112
  buffer_load_ushort v179, v162, s[40:43], s54 offen offset:168
  buffer_load_ushort v180, v162, s[40:43], s54 offen offset:448
  buffer_load_ushort v181, v162, s[40:43], s54 offen offset:504
  buffer_load_ushort v182, v162, s[40:43], s54 offen offset:560
  buffer_load_ushort v183, v162, s[40:43], s54 offen offset:616
  buffer_load_ushort v184, v162, s[40:43], s54 offen offset:896
  buffer_load_ushort v185, v162, s[40:43], s54 offen offset:952
  buffer_load_ushort v186, v162, s[40:43], s54 offen offset:1008
  buffer_load_ushort v187, v162, s[40:43], s54 offen offset:1064
  buffer_load_ushort v188, v163, s[40:43], s54 offen offset:1344
  buffer_load_ushort v189, v163, s[40:43], s54 offen offset:1400
  buffer_load_ushort v190, v163, s[40:43], s54 offen offset:1456
  buffer_load_ushort v191, v163, s[40:43], s54 offen offset:1512
.Lxld4:
  s_lshl_b32 s46, s44, 2
  s_add_u32 s46, s46, s3
  s_mul_i32 s48, s46, 28672
  s_add_u32 s49, s48, 896
  s_lshl_b32 s47, s31, 7
  s_add_u32 s47, s47, s48
  s_mul_i32 s50, s3, 28672
  v_lshrrev_b32 v11, 3, v1
  v_lshrrev_b32 v12, 4, v1
  v_and_b32 v242, 7, v1
  v_xor_b32 v242, v242, v12
  v_mul_u32_u24 v11, 896, v11
  v_lshl_add_u32 v11, v242, 4, v11
  v_xor_b32 v12, 64, v11
  v_add_u32 v12, 7168, v12
  v_add_u32 v13, 14336, v11
  v_add_u32 v14, 14336, v12
  s_waitcnt lgkmcnt(0)
  s_mov_b32 s36, s4
  s_mov_b32 s37, s5
  s_mov_b32 s38, 0x1c0000
  s_mov_b32 s39, 0x00020000
  s_mov_b32 s32, s28
  s_mov_b32 s33, s29
  s_mov_b32 s34, 0x10000000
  s_mov_b32 s35, 0x00020000
  s_load_dword s69, s[28:29], 0x1c000
  s_add_u32 m0, s50, 0
  s_nop 0
  buffer_load_dwordx4 v11, s[36:39], s47 offen lds
  s_add_u32 m0, s50, 1024
  s_nop 0
  buffer_load_dwordx4 v12, s[36:39], s47 offen lds
  s_add_u32 m0, s50, 2048
  s_nop 0
  buffer_load_dwordx4 v13, s[36:39], s47 offen lds
  s_add_u32 m0, s50, 3072
  s_nop 0
  buffer_load_dwordx4 v14, s[36:39], s47 offen lds
  s_add_u32 s47, s47, 128
  s_cmp_eq_u32 s47, s49
  s_cselect_b32 s47, s48, s47
  s_add_u32 m0, s50, 4096
  s_nop 0
  buffer_load_dwordx4 v11, s[36:39], s47 offen lds
  s_add_u32 m0, s50, 5120
  s_nop 0
  buffer_load_dwordx4 v12, s[36:39], s47 offen lds
  s_add_u32 m0, s50, 6144
  s_nop 0
  buffer_load_dwordx4 v13, s[36:39], s47 offen lds
  s_add_u32 m0, s50, 7168
  s_nop 0
  buffer_load_dwordx4 v14, s[36:39], s47 offen lds
  s_add_u32 s47, s47, 128
  v_and_b32 v247, 31, v1
  v_bfe_u32 v242, v1, 1, 3
  v_xor_b32 v242, v242, v10
  v_lshlrev_b32 v242, 4, v242
  v_lshl_add_u32 v242, v247, 7, v242
  v_add_u32 v242, s50, v242
  v_xor_b32 v243, 32, v242
  v_xor_b32 v244, 64, v242
  v_xor_b32 v245, 96, v242
  v_add_u32 v3, 65536, v2
  v_add_u32 v4, 131072, v2
  v_lshlrev_b32 v5, 4, v10
  v_add_u32 v5, 147456, v5
  v_mov_b32 v6, 0x40000000
  v_cmp_eq_u32 vcc, 0, v1
  s_nop 1
  v_cndmask_b32 v6, v6, 0, vcc
  s_lshl_b32 s51, s3, 10
  s_waitcnt lgkmcnt(0)
  s_mul_i32 s69, s69, 0x9e3779b1
  s_add_u32 s69, s69, 0x7f4a7c15
  v_mov_b32 v8, s69
  s_cmp_lt_u32 s3, 3
  s_cbranch_scc1 .Ljob28
  s_cmp_ge_u32 s2, 56
  s_cbranch_scc1 .Ldummy10
  s_lshr_b32 s54, s2, 2
  s_lshl_b32 s54, s54, 5
  v_and_b32 v246, 7, v1
  v_lshrrev_b32 v247, 4, v1
  v_lshl_add_u32 v246, v246, 2, v247
  v_add_u32 v246, s54, v246
  v_mul_u32_u24 v247, 1171, v246
  v_lshrrev_b32 v247, 17, v247
  v_mul_u32_u24 v247, 2688, v247
  v_lshl_add_u32 v246, v246, 3, v247
  v_and_b32 v247, 8, v1
  v_lshl_or_b32 v246, v247, 27, v246
  s_and_b32 s54, s2, 3
  s_mul_i32 s54, s54, 896
  s_add_u32 s54, s54, 0x30000
  s_mov_b32 s62, 0x05040100
  s_mov_b32 s63, 0x07060302
  s_waitcnt vmcnt(22)
  v_and_b32 v129, 0xffff0000, v128
  v_lshlrev_b32 v128, 16, v128
  v_mul_f32 v208, 0xbfb8aa3b, v128
  v_mul_f32 v209, 0xbfb8aa3b, v129
  v_exp_f32 v208, v208
  v_exp_f32 v209, v209
  v_add_f32 v208, 1.0, v208
  v_add_f32 v209, 1.0, v209
  v_rcp_f32 v208, v208
  v_rcp_f32 v209, v209
  v_mul_f32 v208, v208, v128
  v_mul_f32 v209, v209, v129
  v_cvt_pk_bf16_f32 v128, v208, v209
  ds_swizzle_b32 v200, v128 offset:24
  ds_swizzle_b32 v201, v128 offset:56
  ds_swizzle_b32 v202, v128 offset:88
  ds_swizzle_b32 v203, v128 offset:120
  ds_swizzle_b32 v204, v128 offset:152
  ds_swizzle_b32 v205, v128 offset:184
  ds_swizzle_b32 v206, v128 offset:216
  s_waitcnt vmcnt(20)
  v_perm_b32 v208, v140, v136, s62
  v_perm_b32 v209, v140, v136, s63
  v_perm_b32 v210, v141, v137, s62
  v_perm_b32 v211, v141, v137, s63
  v_perm_b32 v212, v142, v138, s62
  v_perm_b32 v213, v142, v138, s63
  v_perm_b32 v214, v143, v139, s62
  v_perm_b32 v215, v143, v139, s63
  s_waitcnt lgkmcnt(6)
  v_dot2_f32_bf16 v192, v208, v200, 0
  v_dot2_f32_bf16 v193, v209, v200, 0
  v_dot2_f32_bf16 v194, v210, v200, 0
  v_dot2_f32_bf16 v195, v211, v200, 0
  v_dot2_f32_bf16 v196, v212, v200, 0
  v_dot2_f32_bf16 v197, v213, v200, 0
  v_dot2_f32_bf16 v198, v214, v200, 0
  v_dot2_f32_bf16 v199, v215, v200, 0
  s_waitcnt vmcnt(18)
  v_perm_b32 v216, v148, v144, s62
  v_perm_b32 v217, v148, v144, s63
  v_perm_b32 v218, v149, v145, s62
  v_perm_b32 v219, v149, v145, s63
  v_perm_b32 v220, v150, v146, s62
  v_perm_b32 v221, v150, v146, s63
  v_perm_b32 v222, v151, v147, s62
  v_perm_b32 v223, v151, v147, s63
  s_waitcnt lgkmcnt(5)
  v_dot2_f32_bf16 v192, v216, v201, v192
  v_dot2_f32_bf16 v193, v217, v201, v193
  v_dot2_f32_bf16 v194, v218, v201, v194
  v_dot2_f32_bf16 v195, v219, v201, v195
  v_dot2_f32_bf16 v196, v220, v201, v196
  v_dot2_f32_bf16 v197, v221, v201, v197
  v_dot2_f32_bf16 v198, v222, v201, v198
  v_dot2_f32_bf16 v199, v223, v201, v199
  s_waitcnt vmcnt(16)
  v_perm_b32 v208, v156, v152, s62
  v_perm_b32 v209, v156, v152, s63
  v_perm_b32 v210, v157, v153, s62
  v_perm_b32 v211, v157, v153, s63
  v_perm_b32 v212, v158, v154, s62
  v_perm_b32 v213, v158, v154, s63
  v_perm_b32 v214, v159, v155, s62
  v_perm_b32 v215, v159, v155, s63
  s_waitcnt lgkmcnt(4)
  v_dot2_f32_bf16 v192, v208, v202, v192
  v_dot2_f32_bf16 v193, v209, v202, v193
  v_dot2_f32_bf16 v194, v210, v202, v194
  v_dot2_f32_bf16 v195, v211, v202, v195
  v_dot2_f32_bf16 v196, v212, v202, v196
  v_dot2_f32_bf16 v197, v213, v202, v197
  v_dot2_f32_bf16 v198, v214, v202, v198
  v_dot2_f32_bf16 v199, v215, v202, v199
  s_waitcnt vmcnt(14)
  v_perm_b32 v216, v164, v160, s62
  v_perm_b32 v217, v164, v160, s63
  v_perm_b32 v218, v165, v161, s62
  v_perm_b32 v219, v165, v161, s63
  v_perm_b32 v220, v166, v162, s62
  v_perm_b32 v221, v166, v162, s63
  v_perm_b32 v222, v167, v163, s62
  v_perm_b32 v223, v167, v163, s63
  s_waitcnt lgkmcnt(3)
  v_dot2_f32_bf16 v192, v216, v203, v192
  v_dot2_f32_bf16 v193, v217, v203, v193
  v_dot2_f32_bf16 v194, v218, v203, v194
  v_dot2_f32_bf16 v195, v219, v203, v195
  v_dot2_f32_bf16 v196, v220, v203, v196
  v_dot2_f32_bf16 v197, v221, v203, v197
  v_dot2_f32_bf16 v198, v222, v203, v198
  v_dot2_f32_bf16 v199, v223, v203, v199
  s_waitcnt vmcnt(12)
  v_perm_b32 v208, v172, v168, s62
  v_perm_b32 v209, v172, v168, s63
  v_perm_b32 v210, v173, v169, s62
  v_perm_b32 v211, v173, v169, s63
  v_perm_b32 v212, v174, v170, s62
  v_perm_b32 v213, v174, v170, s63
  v_perm_b32 v214, v175, v171, s62
  v_perm_b32 v215, v175, v171, s63
  s_waitcnt lgkmcnt(2)
  v_dot2_f32_bf16 v192, v208, v204, v192
  v_dot2_f32_bf16 v193, v209, v204, v193
  v_dot2_f32_bf16 v194, v210, v204, v194
  v_dot2_f32_bf16 v195, v211, v204, v195
  v_dot2_f32_bf16 v196, v212, v204, v196
  v_dot2_f32_bf16 v197, v213, v204, v197
  v_dot2_f32_bf16 v198, v214, v204, v198
  v_dot2_f32_bf16 v199, v215, v204, v199
  s_waitcnt vmcnt(10)
  v_perm_b32 v216, v180, v176, s62
  v_perm_b32 v217, v180, v176, s63
  v_perm_b32 v218, v181, v177, s62
  v_perm_b32 v219, v181, v177, s63
  v_perm_b32 v220, v182, v178, s62
  v_perm_b32 v221, v182, v178, s63
  v_perm_b32 v222, v183, v179, s62
  v_perm_b32 v223, v183, v179, s63
  s_waitcnt lgkmcnt(1)
  v_dot2_f32_bf16 v192, v216, v205, v192
  v_dot2_f32_bf16 v193, v217, v205, v193
  v_dot2_f32_bf16 v194, v218, v205, v194
  v_dot2_f32_bf16 v195, v219, v205, v195
  v_dot2_f32_bf16 v196, v220, v205, v196
  v_dot2_f32_bf16 v197, v221, v205, v197
  v_dot2_f32_bf16 v198, v222, v205, v198
  v_dot2_f32_bf16 v199, v223, v205, v199
  s_waitcnt vmcnt(8)
  v_perm_b32 v208, v188, v184, s62
  v_perm_b32 v209, v188, v184, s63
  v_perm_b32 v210, v189, v185, s62
  v_perm_b32 v211, v189, v185, s63
  v_perm_b32 v212, v190, v186, s62
  v_perm_b32 v213, v190, v186, s63
  v_perm_b32 v214, v191, v187, s62
  v_perm_b32 v215, v191, v187, s63
  s_waitcnt lgkmcnt(0)
  v_dot2_f32_bf16 v192, v208, v206, v192
  v_dot2_f32_bf16 v193, v209, v206, v193
  v_dot2_f32_bf16 v194, v210, v206, v194
  v_dot2_f32_bf16 v195, v211, v206, v195
  v_dot2_f32_bf16 v196, v212, v206, v196
  v_dot2_f32_bf16 v197, v213, v206, v197
  v_dot2_f32_bf16 v198, v214, v206, v198
  v_dot2_f32_bf16 v199, v215, v206, v199
  v_permlane32_swap_b32 v192, v196
  v_permlane32_swap_b32 v193, v197
  v_permlane32_swap_b32 v194, v198
  v_permlane32_swap_b32 v195, v199
  v_add_f32 v192, v192, v196
  v_add_f32 v193, v193, v197
  v_add_f32 v194, v194, v198
  v_add_f32 v195, v195, v199
  s_nop 0
  v_permlane16_swap_b32 v192, v194
  v_permlane16_swap_b32 v193, v195
  v_add_f32 v192, v192, v194
  v_add_f32 v193, v193, v195
  s_nop 0
  v_add_f32_dpp v192, v192, v192 row_ror:8 row_mask:0xf bank_mask:0xf
  v_add_f32_dpp v193, v193, v193 row_ror:8 row_mask:0xf bank_mask:0xf
  v_cvt_pk_f16_f32 v192, v192, v193
  v_mov_b32 v193, s69
  buffer_store_dwordx2 v[192:193], v246, s[32:35], s54 offen offset:0 sc1
.Ldummy10:
  v_mov_b32 v246, 0x40000000
  buffer_store_dword v246, v246, s[32:35], 0 offen offset:0 sc1
  buffer_store_dword v246, v246, s[32:35], 0 offen offset:0 sc1
.Ljob28:
  s_cmp_ge_u32 s57, 14
  s_cbranch_scc1 .Lbtype211
  s_cmp_eq_u32 s3, 3
  s_cbranch_scc1 .Ljoin212
  v_bfe_u32 v247, v1, 2, 2
  v_mad_u32_u24 v246, v10, 8, v247
  v_mul_u32_u24 v246, 64, v246
  v_bfe_u32 v247, v1, 4, 1
  v_mul_u32_u24 v247, 32, v247
  v_add3_u32 v246, v246, v247, s59
  v_and_b32 v247, 3, v1
  v_lshl_add_u32 v246, v247, 3, v246
  v_and_b32 v248, 31, v1
  v_cmp_gt_u32 vcc, 28, v248
  s_nop 1
  v_cndmask_b32 v248, 0, -1, vcc
  s_lshl_b32 s54, s57, 12
  s_add_u32 s54, s54, s51
  s_lshl_b32 s55, s57, 11
  s_add_u32 s55, s55, 57344
  s_cmp_eq_u32 s3, 2
  s_cselect_b32 s54, s55, s54
  s_cselect_b32 s62, 1, 2
  s_lshl_b32 s62, s62, 10
  s_mul_i32 s55, s45, 86016
  s_add_u32 s54, s54, s55
  s_add_u32 s54, s54, 0x400000
  s_add_u32 s55, s54, s62
  s_waitcnt vmcnt(8)
  ds_read_b64_tr_b16 v[128:129], v246 offset:0
  ds_read_b64_tr_b16 v[130:131], v246 offset:256
  ds_read_b64_tr_b16 v[132:133], v246 offset:1024
  ds_read_b64_tr_b16 v[134:135], v246 offset:1280
  s_waitcnt lgkmcnt(3)
  v_and_b32 v128, v128, v248
  v_and_b32 v129, v129, v248
  s_waitcnt lgkmcnt(2)
  v_and_b32 v130, v130, v248
  v_and_b32 v131, v131, v248
  v_lshlrev_b32 v208, 16, v128
  v_and_b32 v209, 0xffff0000, v128
  v_lshlrev_b32 v210, 16, v129
  v_and_b32 v211, 0xffff0000, v129
  v_lshlrev_b32 v212, 16, v130
  v_and_b32 v213, 0xffff0000, v130
  v_lshlrev_b32 v214, 16, v131
  v_and_b32 v215, 0xffff0000, v131
  v_cvt_pk_f16_f32 v128, v208, v209
  v_cvt_pk_f16_f32 v129, v210, v211
  v_cvt_pk_f16_f32 v130, v212, v213
  v_cvt_pk_f16_f32 v131, v214, v215
  buffer_store_dwordx4 v[128:131], v2, s[32:35], s54 offen offset:0 sc1
  s_waitcnt lgkmcnt(1)
  v_and_b32 v132, v132, v248
  v_and_b32 v133, v133, v248
  s_waitcnt lgkmcnt(0)
  v_and_b32 v134, v134, v248
  v_and_b32 v135, v135, v248
  v_lshlrev_b32 v216, 16, v132
  v_and_b32 v217, 0xffff0000, v132
  v_lshlrev_b32 v218, 16, v133
  v_and_b32 v219, 0xffff0000, v133
  v_lshlrev_b32 v220, 16, v134
  v_and_b32 v221, 0xffff0000, v134
  v_lshlrev_b32 v222, 16, v135
  v_and_b32 v223, 0xffff0000, v135
  v_cvt_pk_f16_f32 v132, v216, v217
  v_cvt_pk_f16_f32 v133, v218, v219
  v_cvt_pk_f16_f32 v134, v220, v221
  v_cvt_pk_f16_f32 v135, v222, v223
  buffer_store_dwordx4 v[132:135], v2, s[32:35], s55 offen offset:0 sc1
  s_nop 0
  s_branch .Ljoin212
.Lbtype211:
  v_bfe_u32 v247, v1, 2, 2
  v_mad_u32_u24 v246, v10, 8, v247
  v_mul_u32_u24 v246, 256, v246
  v_bfe_u32 v247, v1, 4, 1
  v_mul_u32_u24 v247, 32, v247
  v_add3_u32 v246, v246, v247, s59
  v_and_b32 v247, 3, v1
  v_lshl_add_u32 v246, v247, 3, v246
  s_cmp_eq_u32 s57, 15
  s_cselect_b32 s54, 32, 64
  v_cmp_gt_u32 vcc, s54, v1
  s_nop 1
  v_cndmask_b32 v248, 0, -1, vcc
  s_lshl_b32 s54, s3, 17
  s_lshl_b32 s55, s45, 1
  s_add_u32 s55, s55, s57
  s_lshl_b32 s55, s55, 10
  s_add_u32 s54, s54, s55
  s_add_u32 s54, s54, 0x57c800
  s_waitcnt vmcnt(8)
  ds_read_b64_tr_b16 v[128:129], v246 offset:0
  ds_read_b64_tr_b16 v[130:131], v246 offset:1024
  ds_read_b64_tr_b16 v[132:133], v246 offset:64
  ds_read_b64_tr_b16 v[134:135], v246 offset:1088
  ds_read_b64_tr_b16 v[136:137], v246 offset:128
  ds_read_b64_tr_b16 v[138:139], v246 offset:1152
  ds_read_b64_tr_b16 v[140:141], v246 offset:192
  ds_read_b64_tr_b16 v[142:143], v246 offset:1216
  s_lshl_b32 s55, s3, 4
  s_add_u32 s55, s55, s57
  s_cmp_lg_u32 s55, 15
  s_cbranch_scc1 .Lnophi13
  s_lshl_b32 s55, s45, 11
  s_add_u32 s55, s55, 0x20000
  v_lshl_or_b32 v160, v177, 16, v176
  v_lshl_or_b32 v161, v179, 16, v178
  v_lshl_or_b32 v162, v181, 16, v180
  v_lshl_or_b32 v163, v183, 16, v182
  buffer_store_dwordx4 v[160:163], v2, s[32:35], s55 offen offset:0 sc1
  v_lshl_or_b32 v164, v185, 16, v184
  v_lshl_or_b32 v165, v187, 16, v186
  v_lshl_or_b32 v166, v189, 16, v188
  v_lshl_or_b32 v167, v191, 16, v190
  buffer_store_dwordx4 v[164:167], v2, s[32:35], s55 offen offset:1024 sc1
.Lnophi13:
  s_waitcnt lgkmcnt(6)
  v_and_b32 v130, v130, v248
  v_and_b32 v131, v131, v248
  buffer_store_dwordx4 v[128:131], v2, s[32:35], s54 offen offset:0 sc1
  s_add_u32 s54, s54, 32768
  s_waitcnt lgkmcnt(4)
  v_and_b32 v134, v134, v248
  v_and_b32 v135, v135, v248
  buffer_store_dwordx4 v[132:135], v2, s[32:35], s54 offen offset:0 sc1
  s_add_u32 s54, s54, 32768
  s_waitcnt lgkmcnt(2)
  v_and_b32 v138, v138, v248
  v_and_b32 v139, v139, v248
  buffer_store_dwordx4 v[136:139], v2, s[32:35], s54 offen offset:0 sc1
  s_add_u32 s54, s54, 32768
  s_waitcnt lgkmcnt(0)
  v_and_b32 v142, v142, v248
  v_and_b32 v143, v143, v248
  buffer_store_dwordx4 v[140:143], v2, s[32:35], s54 offen offset:0 sc1
.Ljoin212:
  s_nop 0
  s_cmp_lt_u32 s2, 168
  s_cselect_b32 s12, 1, 0
  s_cmp_eq_u32 s3, 3
  s_cselect_b32 s12, s12, 0
  s_cmp_ge_u32 s2, 56
  s_cselect_b32 s12, s12, 0
  s_cmp_eq_u32 s12, 0
  s_cbranch_scc1 .Lnomod14
  v_lshrrev_b32 v247, 3, v1
  v_and_b32 v248, 7, v1
  v_mul_u32_u24 v246, 28, v247
  v_mul_u32_u24 v247, 75264, v247
  v_lshl_add_u32 v247, v248, 4, v247
  v_min_u32 v248, 6, v248
  v_lshl_add_u32 v246, v248, 2, v246
  s_and_b32 s55, s2, 3
  s_mul_i32 s54, s55, 602112
  s_mul_i32 s55, s55, 224
  s_lshr_b32 s62, s2, 2
  s_lshl_b32 s62, s62, 7
  s_add_u32 s54, s54, s62
  s_mov_b32 s40, s20
  s_mov_b32 s41, s21
  s_mov_b32 s42, 0x380
  s_mov_b32 s43, 0x00020000
  s_mov_b32 s64, s22
  s_mov_b32 s65, s23
  s_mov_b32 s66, 0x24c000
  s_mov_b32 s67, 0x00020000
  buffer_load_dword v128, v246, s[40:43], s55 offen
  buffer_load_dwordx4 v[136:139], v247, s[64:67], s54 offen
  s_add_u32 s54, s54, 5376
  buffer_load_dwordx4 v[140:143], v247, s[64:67], s54 offen
  s_add_u32 s54, s54, 5376
  buffer_load_dwordx4 v[144:147], v247, s[64:67], s54 offen
  s_add_u32 s54, s54, 5376
  buffer_load_dwordx4 v[148:151], v247, s[64:67], s54 offen
  s_add_u32 s54, s54, 5376
  buffer_load_dwordx4 v[152:155], v247, s[64:67], s54 offen
  s_add_u32 s54, s54, 5376
  buffer_load_dwordx4 v[156:159], v247, s[64:67], s54 offen
  s_add_u32 s54, s54, 5376
  buffer_load_dwordx4 v[160:163], v247, s[64:67], s54 offen
  s_add_u32 s54, s54, 5376
  buffer_load_dwordx4 v[164:167], v247, s[64:67], s54 offen
  s_add_u32 s54, s54, 5376
  buffer_load_dwordx4 v[168:171], v247, s[64:67], s54 offen
  s_add_u32 s54, s54, 5376
  buffer_load_dwordx4 v[172:175], v247, s[64:67], s54 offen
  s_add_u32 s54, s54, 5376
  buffer_load_dwordx4 v[176:179], v247, s[64:67], s54 offen
  s_add_u32 s54, s54, 5376
  buffer_load_dwordx4 v[180:183], v247, s[64:67], s54 offen
  s_add_u32 s54, s54, 5376
  buffer_load_dwordx4 v[184:187], v247, s[64:67], s54 offen
  s_add_u32 s54, s54, 5376
  buffer_load_dwordx4 v[188:191], v247, s[64:67], s54 offen
.Lnomod14:
  s_waitcnt lgkmcnt(0)
  s_cmp_eq_u32 s47, s49
  s_cselect_b32 s47, s48, s47
  s_add_u32 m0, s50, 8192
  s_nop 0
  buffer_load_dwordx4 v11, s[36:39], s47 offen lds
  s_add_u32 m0, s50, 9216
  s_nop 0
  buffer_load_dwordx4 v12, s[36:39], s47 offen lds
  s_add_u32 m0, s50, 10240
  s_nop 0
  buffer_load_dwordx4 v13, s[36:39], s47 offen lds
  s_add_u32 m0, s50, 11264
  s_nop 0
  buffer_load_dwordx4 v14, s[36:39], s47 offen lds
  s_add_u32 s47, s47, 128
  s_cmp_eq_u32 s47, s49
  s_cselect_b32 s47, s48, s47
  s_add_u32 m0, s50, 12288
  s_nop 0
  buffer_load_dwordx4 v11, s[36:39], s47 offen lds
  s_add_u32 m0, s50, 13312
  s_nop 0
  buffer_load_dwordx4 v12, s[36:39], s47 offen lds
  s_add_u32 m0, s50, 14336
  s_nop 0
  buffer_load_dwordx4 v13, s[36:39], s47 offen lds
  s_add_u32 m0, s50, 15360
  s_nop 0
  buffer_load_dwordx4 v14, s[36:39], s47 offen lds
  s_add_u32 s47, s47, 128
  s_lshl_b32 s54, s3, 4
  s_add_u32 s54, s54, s57
  s_lshl_b32 s54, s54, 2
  s_lshl_b32 s52, s45, 8
  s_add_u32 s52, s52, 0x1a000
  s_add_u32 s54, s54, s52
  s_cmp_eq_u32 s12, 1
  s_cbranch_scc1 .Lw215
  s_waitcnt vmcnt(14)
.Lw215:
  s_waitcnt vmcnt(29)
  ds_read_b128 v[16:19], v242 offset:0
  ds_read_b128 v[20:23], v243 offset:0
  ds_read_b128 v[24:27], v244 offset:0
  ds_read_b128 v[28:31], v245 offset:0
  s_cmp_eq_u32 s12, 1
  s_cbranch_scc1 .Lw216
  s_waitcnt vmcnt(10)
.Lw216:
  s_waitcnt vmcnt(25)
  ds_read_b128 v[32:35], v242 offset:4096
  ds_read_b128 v[36:39], v243 offset:4096
  ds_read_b128 v[40:43], v244 offset:4096
  ds_read_b128 v[44:47], v245 offset:4096
  s_waitcnt lgkmcnt(7)
  v_lshlrev_b32 v208, 16, v16
  v_and_b32 v209, 0xffff0000, v16
  v_lshlrev_b32 v210, 16, v17
  v_and_b32 v211, 0xffff0000, v17
  v_lshlrev_b32 v212, 16, v18
  v_and_b32 v213, 0xffff0000, v18
  v_lshlrev_b32 v214, 16, v19
  v_and_b32 v215, 0xffff0000, v19
  v_pk_mul_f32 v[236:237], v[208:209], v[208:209]
  v_cvt_pk_f16_f32 v16, v208, v209
  v_pk_mul_f32 v[238:239], v[210:211], v[210:211]
  v_cvt_pk_f16_f32 v17, v210, v211
  v_pk_fma_f32 v[236:237], v[212:213], v[212:213], v[236:237]
  v_pk_add_f32 v[232:233], v[208:209], v[212:213]
  v_cvt_pk_f16_f32 v18, v212, v213
  v_pk_fma_f32 v[238:239], v[214:215], v[214:215], v[238:239]
  v_pk_add_f32 v[234:235], v[210:211], v[214:215]
  v_cvt_pk_f16_f32 v19, v214, v215
  s_waitcnt lgkmcnt(6)
  v_lshlrev_b32 v216, 16, v20
  v_and_b32 v217, 0xffff0000, v20
  v_lshlrev_b32 v218, 16, v21
  v_and_b32 v219, 0xffff0000, v21
  v_lshlrev_b32 v220, 16, v22
  v_and_b32 v221, 0xffff0000, v22
  v_lshlrev_b32 v222, 16, v23
  v_and_b32 v223, 0xffff0000, v23
  v_pk_fma_f32 v[236:237], v[216:217], v[216:217], v[236:237]
  v_pk_add_f32 v[232:233], v[232:233], v[216:217]
  v_cvt_pk_f16_f32 v20, v216, v217
  v_pk_fma_f32 v[238:239], v[218:219], v[218:219], v[238:239]
  v_pk_add_f32 v[234:235], v[234:235], v[218:219]
  v_cvt_pk_f16_f32 v21, v218, v219
  v_pk_fma_f32 v[236:237], v[220:221], v[220:221], v[236:237]
  v_pk_add_f32 v[232:233], v[232:233], v[220:221]
  v_cvt_pk_f16_f32 v22, v220, v221
  v_pk_fma_f32 v[238:239], v[222:223], v[222:223], v[238:239]
  v_pk_add_f32 v[234:235], v[234:235], v[222:223]
  v_cvt_pk_f16_f32 v23, v222, v223
  s_waitcnt lgkmcnt(5)
  v_lshlrev_b32 v224, 16, v24
  v_and_b32 v225, 0xffff0000, v24
  v_lshlrev_b32 v226, 16, v25
  v_and_b32 v227, 0xffff0000, v25
  v_lshlrev_b32 v228, 16, v26
  v_and_b32 v229, 0xffff0000, v26
  v_lshlrev_b32 v230, 16, v27
  v_and_b32 v231, 0xffff0000, v27
  v_pk_fma_f32 v[236:237], v[224:225], v[224:225], v[236:237]
  v_pk_add_f32 v[232:233], v[232:233], v[224:225]
  v_cvt_pk_f16_f32 v24, v224, v225
  v_pk_fma_f32 v[238:239], v[226:227], v[226:227], v[238:239]
  v_pk_add_f32 v[234:235], v[234:235], v[226:227]
  v_cvt_pk_f16_f32 v25, v226, v227
  v_pk_fma_f32 v[236:237], v[228:229], v[228:229], v[236:237]
  v_pk_add_f32 v[232:233], v[232:233], v[228:229]
  v_cvt_pk_f16_f32 v26, v228, v229
  v_pk_fma_f32 v[238:239], v[230:231], v[230:231], v[238:239]
  v_pk_add_f32 v[234:235], v[234:235], v[230:231]
  v_cvt_pk_f16_f32 v27, v230, v231
  s_waitcnt lgkmcnt(4)
  v_lshlrev_b32 v208, 16, v28
  v_and_b32 v209, 0xffff0000, v28
  v_lshlrev_b32 v210, 16, v29
  v_and_b32 v211, 0xffff0000, v29
  v_lshlrev_b32 v212, 16, v30
  v_and_b32 v213, 0xffff0000, v30
  v_lshlrev_b32 v214, 16, v31
  v_and_b32 v215, 0xffff0000, v31
  v_pk_fma_f32 v[236:237], v[208:209], v[208:209], v[236:237]
  v_pk_add_f32 v[232:233], v[232:233], v[208:209]
  v_cvt_pk_f16_f32 v28, v208, v209
  v_pk_fma_f32 v[238:239], v[210:211], v[210:211], v[238:239]
  v_pk_add_f32 v[234:235], v[234:235], v[210:211]
  v_cvt_pk_f16_f32 v29, v210, v211
  v_pk_fma_f32 v[236:237], v[212:213], v[212:213], v[236:237]
  v_pk_add_f32 v[232:233], v[232:233], v[212:213]
  v_cvt_pk_f16_f32 v30, v212, v213
  v_pk_fma_f32 v[238:239], v[214:215], v[214:215], v[238:239]
  v_pk_add_f32 v[234:235], v[234:235], v[214:215]
  v_cvt_pk_f16_f32 v31, v214, v215
  s_waitcnt lgkmcnt(3)
  v_lshlrev_b32 v216, 16, v32
  v_and_b32 v217, 0xffff0000, v32
  v_lshlrev_b32 v218, 16, v33
  v_and_b32 v219, 0xffff0000, v33
  v_lshlrev_b32 v220, 16, v34
  v_and_b32 v221, 0xffff0000, v34
  v_lshlrev_b32 v222, 16, v35
  v_and_b32 v223, 0xffff0000, v35
  v_pk_fma_f32 v[236:237], v[216:217], v[216:217], v[236:237]
  v_pk_add_f32 v[232:233], v[232:233], v[216:217]
  v_cvt_pk_f16_f32 v32, v216, v217
  v_pk_fma_f32 v[238:239], v[218:219], v[218:219], v[238:239]
  v_pk_add_f32 v[234:235], v[234:235], v[218:219]
  v_cvt_pk_f16_f32 v33, v218, v219
  v_pk_fma_f32 v[236:237], v[220:221], v[220:221], v[236:237]
  v_pk_add_f32 v[232:233], v[232:233], v[220:221]
  v_cvt_pk_f16_f32 v34, v220, v221
  v_pk_fma_f32 v[238:239], v[222:223], v[222:223], v[238:239]
  v_pk_add_f32 v[234:235], v[234:235], v[222:223]
  v_cvt_pk_f16_f32 v35, v222, v223
  s_waitcnt lgkmcnt(2)
  v_lshlrev_b32 v224, 16, v36
  v_and_b32 v225, 0xffff0000, v36
  v_lshlrev_b32 v226, 16, v37
  v_and_b32 v227, 0xffff0000, v37
  v_lshlrev_b32 v228, 16, v38
  v_and_b32 v229, 0xffff0000, v38
  v_lshlrev_b32 v230, 16, v39
  v_and_b32 v231, 0xffff0000, v39
  v_pk_fma_f32 v[236:237], v[224:225], v[224:225], v[236:237]
  v_pk_add_f32 v[232:233], v[232:233], v[224:225]
  v_cvt_pk_f16_f32 v36, v224, v225
  v_pk_fma_f32 v[238:239], v[226:227], v[226:227], v[238:239]
  v_pk_add_f32 v[234:235], v[234:235], v[226:227]
  v_cvt_pk_f16_f32 v37, v226, v227
  v_pk_fma_f32 v[236:237], v[228:229], v[228:229], v[236:237]
  v_pk_add_f32 v[232:233], v[232:233], v[228:229]
  v_cvt_pk_f16_f32 v38, v228, v229
  v_pk_fma_f32 v[238:239], v[230:231], v[230:231], v[238:239]
  v_pk_add_f32 v[234:235], v[234:235], v[230:231]
  v_cvt_pk_f16_f32 v39, v230, v231
  s_waitcnt lgkmcnt(1)
  v_lshlrev_b32 v208, 16, v40
  v_and_b32 v209, 0xffff0000, v40
  v_lshlrev_b32 v210, 16, v41
  v_and_b32 v211, 0xffff0000, v41
  v_lshlrev_b32 v212, 16, v42
  v_and_b32 v213, 0xffff0000, v42
  v_lshlrev_b32 v214, 16, v43
  v_and_b32 v215, 0xffff0000, v43
  v_pk_fma_f32 v[236:237], v[208:209], v[208:209], v[236:237]
  v_pk_add_f32 v[232:233], v[232:233], v[208:209]
  v_cvt_pk_f16_f32 v40, v208, v209
  v_pk_fma_f32 v[238:239], v[210:211], v[210:211], v[238:239]
  v_pk_add_f32 v[234:235], v[234:235], v[210:211]
  v_cvt_pk_f16_f32 v41, v210, v211
  v_pk_fma_f32 v[236:237], v[212:213], v[212:213], v[236:237]
  v_pk_add_f32 v[232:233], v[232:233], v[212:213]
  v_cvt_pk_f16_f32 v42, v212, v213
  v_pk_fma_f32 v[238:239], v[214:215], v[214:215], v[238:239]
  v_pk_add_f32 v[234:235], v[234:235], v[214:215]
  v_cvt_pk_f16_f32 v43, v214, v215
  s_waitcnt lgkmcnt(0)
  v_lshlrev_b32 v216, 16, v44
  v_and_b32 v217, 0xffff0000, v44
  v_lshlrev_b32 v218, 16, v45
  v_and_b32 v219, 0xffff0000, v45
  v_lshlrev_b32 v220, 16, v46
  v_and_b32 v221, 0xffff0000, v46
  v_lshlrev_b32 v222, 16, v47
  v_and_b32 v223, 0xffff0000, v47
  v_pk_fma_f32 v[236:237], v[216:217], v[216:217], v[236:237]
  v_pk_add_f32 v[232:233], v[232:233], v[216:217]
  v_cvt_pk_f16_f32 v44, v216, v217
  v_pk_fma_f32 v[238:239], v[218:219], v[218:219], v[238:239]
  v_pk_add_f32 v[234:235], v[234:235], v[218:219]
  v_cvt_pk_f16_f32 v45, v218, v219
  v_pk_fma_f32 v[236:237], v[220:221], v[220:221], v[236:237]
  v_pk_add_f32 v[232:233], v[232:233], v[220:221]
  v_cvt_pk_f16_f32 v46, v220, v221
  v_pk_fma_f32 v[238:239], v[222:223], v[222:223], v[238:239]
  v_pk_add_f32 v[234:235], v[234:235], v[222:223]
  v_cvt_pk_f16_f32 v47, v222, v223
  s_cmp_eq_u32 s12, 1
  s_cbranch_scc1 .Lw217
  s_waitcnt vmcnt(8)
.Lw217:
  s_waitcnt vmcnt(23)
  buffer_store_dword v8, v6, s[32:35], s54 offen sc1
  s_cmp_eq_u32 s47, s49
  s_cselect_b32 s47, s48, s47
  s_add_u32 m0, s50, 16384
  s_nop 0
  buffer_load_dwordx4 v11, s[36:39], s47 offen lds
  s_add_u32 m0, s50, 17408
  s_nop 0
  buffer_load_dwordx4 v12, s[36:39], s47 offen lds
  s_add_u32 m0, s50, 18432
  s_nop 0
  buffer_load_dwordx4 v13, s[36:39], s47 offen lds
  s_add_u32 m0, s50, 19456
  s_nop 0
  buffer_load_dwordx4 v14, s[36:39], s47 offen lds
  s_add_u32 s47, s47, 128
  s_cmp_eq_u32 s47, s49
  s_cselect_b32 s47, s48, s47
  s_add_u32 m0, s50, 20480
  s_nop 0
  buffer_load_dwordx4 v11, s[36:39], s47 offen lds
  s_add_u32 m0, s50, 21504
  s_nop 0
  buffer_load_dwordx4 v12, s[36:39], s47 offen lds
  s_add_u32 m0, s50, 22528
  s_nop 0
  buffer_load_dwordx4 v13, s[36:39], s47 offen lds
  s_add_u32 m0, s50, 23552
  s_nop 0
  buffer_load_dwordx4 v14, s[36:39], s47 offen lds
  s_add_u32 s47, s47, 128
  s_cmp_eq_u32 s47, s49
  s_cselect_b32 s47, s48, s47
  s_add_u32 m0, s50, 24576
  s_nop 0
  buffer_load_dwordx4 v11, s[36:39], s47 offen lds
  s_add_u32 m0, s50, 25600
  s_nop 0
  buffer_load_dwordx4 v12, s[36:39], s47 offen lds
  s_add_u32 m0, s50, 26624
  s_nop 0
  buffer_load_dwordx4 v13, s[36:39], s47 offen lds
  s_add_u32 m0, s50, 27648
  s_nop 0
  buffer_load_dwordx4 v14, s[36:39], s47 offen lds
  v_lshrrev_b32 v247, 3, v1
  v_and_b32 v248, 7, v1
  v_lshlrev_b32 v248, 4, v248
  v_mul_u32_u24 v246, 896, v247
  v_add_u32 v246, v246, v248
  s_mul_i32 s62, s45, 14
  s_add_u32 s62, s62, s57
  s_lshr_b32 s54, s62, 1
  s_and_b32 s62, s62, 1
  s_lshl_b32 s62, s62, 2
  s_add_u32 s62, s62, s3
  s_mul_i32 s62, s62, 112
  s_lshr_b32 s63, s45, 2
  s_mul_i32 s63, s63, 28
  s_and_b32 s55, s45, 3
  s_add_u32 s63, s63, s55
  s_lshr_b32 s55, s57, 1
  s_lshl2_add_u32 s63, s55, s63
  s_add_u32 s63, s63, s62
  s_lshl_b32 s63, s63, 11
  s_add_u32 s63, s63, 0xa00000
  s_mul_i32 s54, s54, 14336
  s_add_u32 s54, s54, s62
  s_cmp_ge_u32 s57, 14
  s_cselect_b32 s54, 0x40000000, s54
  s_cselect_b32 s63, 0x40000000, s63
  s_mov_b32 s40, s18
  s_mov_b32 s41, s19
  s_mov_b32 s42, 0x188000
  s_mov_b32 s43, 0x00020000
  s_add_u32 m0, s59, 2048
  s_nop 0
  buffer_load_dwordx4 v246, s[40:43], s54 offen lds
  s_add_u32 s54, s54, 7168
  s_add_u32 m0, s59, 3072
  s_nop 0
  buffer_load_dwordx4 v246, s[40:43], s54 offen lds
  v_mul_u32_u24 v246, 3584, v247
  v_add_u32 v246, v246, v248
  s_lshl_b32 s54, s57, 1
  s_lshr_b32 s55, s3, 1
  s_add_u32 s54, s54, s55
  s_and_b32 s55, s3, 1
  s_mul_i32 s66, s45, 7
  s_lshl_b32 s62, s55, 2
  s_add_u32 s66, s66, s62
  s_mul_i32 s66, s66, 28
  s_add_u32 s66, s66, s54
  s_lshl_b32 s66, s66, 10
  s_add_u32 s66, s66, 0x600000
  s_mul_i32 s54, s54, 57344
  s_lshl_b32 s62, s55, 7
  s_add_u32 s54, s54, s62
  s_mul_i32 s62, s45, 224
  s_add_u32 s54, s54, s62
  s_cmp_ge_u32 s57, 14
  s_cselect_b32 s54, 0x40000000, s54
  s_cselect_b32 s66, 0x40000000, s66
  s_add_u32 s67, s66, 86016
  s_cmp_eq_u32 s55, 1
  s_cselect_b32 s67, 0x40000000, s67
  s_add_u32 s55, s54, 28672
  s_mov_b32 s40, s14
  s_mov_b32 s41, s15
  s_mov_b32 s42, 0x188000
  s_mov_b32 s43, 0x00020000
  s_add_u32 m0, s59, 4096
  s_nop 0
  buffer_load_dwordx4 v246, s[40:43], s54 offen lds
  s_add_u32 m0, s59, 5120
  s_nop 0
  buffer_load_dwordx4 v246, s[40:43], s55 offen lds
  s_mov_b32 s40, s16
  s_mov_b32 s41, s17
  s_mov_b32 s42, 0x188000
  s_mov_b32 s43, 0x00020000
  s_add_u32 m0, s59, 6144
  s_nop 0
  buffer_load_dwordx4 v246, s[40:43], s54 offen lds
  s_add_u32 m0, s59, 7168
  s_nop 0
  buffer_load_dwordx4 v246, s[40:43], s55 offen lds
  s_mov_b32 s40, s24
  s_mov_b32 s41, s25
  s_mov_b32 s42, 0x1c0000
  s_mov_b32 s43, 0x00020000
  v_min_u32 v11, 880, v2
  s_mul_i32 s54, s3, 3584
  s_add_u32 s53, s54, 0x30000
  v_and_b32 v12, 48, v1
  v_and_b32 v248, 15, v1
  v_min_u32 v248, 13, v248
  v_add_lshl_u32 v12, v12, v248, 2
  v_cmp_gt_u32 vcc, 48, v1
  s_nop 1
  v_cndmask_b32 v12, 60, v12, vcc
  s_cmp_eq_u32 s12, 0
  s_cbranch_scc1 .Lnomath18
  s_lshr_b32 s54, s2, 2
  s_lshl_b32 s54, s54, 5
  v_and_b32 v246, 7, v1
  v_lshrrev_b32 v247, 4, v1
  v_lshl_add_u32 v246, v246, 2, v247
  v_add_u32 v246, s54, v246
  v_mul_u32_u24 v247, 1171, v246
  v_lshrrev_b32 v247, 17, v247
  v_mul_u32_u24 v247, 2688, v247
  v_lshl_add_u32 v246, v246, 3, v247
  v_and_b32 v247, 8, v1
  v_lshl_or_b32 v246, v247, 27, v246
  s_and_b32 s54, s2, 3
  s_mul_i32 s54, s54, 896
  s_add_u32 s54, s54, 0x30000
  s_mov_b32 s22, 0x05040100
  s_mov_b32 s23, 0x07060302
  s_waitcnt vmcnt(41)
  v_and_b32 v129, 0xffff0000, v128
  v_lshlrev_b32 v128, 16, v128
  v_mul_f32 v208, 0xbfb8aa3b, v128
  v_mul_f32 v209, 0xbfb8aa3b, v129
  v_exp_f32 v208, v208
  v_exp_f32 v209, v209
  v_add_f32 v208, 1.0, v208
  v_add_f32 v209, 1.0, v209
  v_rcp_f32 v208, v208
  v_rcp_f32 v209, v209
  v_mul_f32 v208, v208, v128
  v_mul_f32 v209, v209, v129
  v_cvt_pk_bf16_f32 v128, v208, v209
  ds_swizzle_b32 v200, v128 offset:24
  ds_swizzle_b32 v201, v128 offset:56
  ds_swizzle_b32 v202, v128 offset:88
  ds_swizzle_b32 v203, v128 offset:120
  ds_swizzle_b32 v204, v128 offset:152
  ds_swizzle_b32 v205, v128 offset:184
  ds_swizzle_b32 v206, v128 offset:216
  s_waitcnt vmcnt(39)
  v_perm_b32 v208, v140, v136, s22
  v_perm_b32 v209, v140, v136, s23
  v_perm_b32 v210, v141, v137, s22
  v_perm_b32 v211, v141, v137, s23
  v_perm_b32 v212, v142, v138, s22
  v_perm_b32 v213, v142, v138, s23
  v_perm_b32 v214, v143, v139, s22
  v_perm_b32 v215, v143, v139, s23
  s_waitcnt lgkmcnt(6)
  v_dot2_f32_bf16 v192, v208, v200, 0
  v_dot2_f32_bf16 v193, v209, v200, 0
  v_dot2_f32_bf16 v194, v210, v200, 0
  v_dot2_f32_bf16 v195, v211, v200, 0
  v_dot2_f32_bf16 v196, v212, v200, 0
  v_dot2_f32_bf16 v197, v213, v200, 0
  v_dot2_f32_bf16 v198, v214, v200, 0
  v_dot2_f32_bf16 v199, v215, v200, 0
  s_waitcnt vmcnt(37)
  v_perm_b32 v216, v148, v144, s22
  v_perm_b32 v217, v148, v144, s23
  v_perm_b32 v218, v149, v145, s22
  v_perm_b32 v219, v149, v145, s23
  v_perm_b32 v220, v150, v146, s22
  v_perm_b32 v221, v150, v146, s23
  v_perm_b32 v222, v151, v147, s22
  v_perm_b32 v223, v151, v147, s23
  s_waitcnt lgkmcnt(5)
  v_dot2_f32_bf16 v192, v216, v201, v192
  v_dot2_f32_bf16 v193, v217, v201, v193
  v_dot2_f32_bf16 v194, v218, v201, v194
  v_dot2_f32_bf16 v195, v219, v201, v195
  v_dot2_f32_bf16 v196, v220, v201, v196
  v_dot2_f32_bf16 v197, v221, v201, v197
  v_dot2_f32_bf16 v198, v222, v201, v198
  v_dot2_f32_bf16 v199, v223, v201, v199
  s_waitcnt vmcnt(35)
  v_perm_b32 v208, v156, v152, s22
  v_perm_b32 v209, v156, v152, s23
  v_perm_b32 v210, v157, v153, s22
  v_perm_b32 v211, v157, v153, s23
  v_perm_b32 v212, v158, v154, s22
  v_perm_b32 v213, v158, v154, s23
  v_perm_b32 v214, v159, v155, s22
  v_perm_b32 v215, v159, v155, s23
  s_waitcnt lgkmcnt(4)
  v_dot2_f32_bf16 v192, v208, v202, v192
  v_dot2_f32_bf16 v193, v209, v202, v193
  v_dot2_f32_bf16 v194, v210, v202, v194
  v_dot2_f32_bf16 v195, v211, v202, v195
  v_dot2_f32_bf16 v196, v212, v202, v196
  v_dot2_f32_bf16 v197, v213, v202, v197
  v_dot2_f32_bf16 v198, v214, v202, v198
  v_dot2_f32_bf16 v199, v215, v202, v199
  s_waitcnt vmcnt(33)
  v_perm_b32 v216, v164, v160, s22
  v_perm_b32 v217, v164, v160, s23
  v_perm_b32 v218, v165, v161, s22
  v_perm_b32 v219, v165, v161, s23
  v_perm_b32 v220, v166, v162, s22
  v_perm_b32 v221, v166, v162, s23
  v_perm_b32 v222, v167, v163, s22
  v_perm_b32 v223, v167, v163, s23
  s_waitcnt lgkmcnt(3)
  v_dot2_f32_bf16 v192, v216, v203, v192
  v_dot2_f32_bf16 v193, v217, v203, v193
  v_dot2_f32_bf16 v194, v218, v203, v194
  v_dot2_f32_bf16 v195, v219, v203, v195
  v_dot2_f32_bf16 v196, v220, v203, v196
  v_dot2_f32_bf16 v197, v221, v203, v197
  v_dot2_f32_bf16 v198, v222, v203, v198
  v_dot2_f32_bf16 v199, v223, v203, v199
  s_waitcnt vmcnt(31)
  v_perm_b32 v208, v172, v168, s22
  v_perm_b32 v209, v172, v168, s23
  v_perm_b32 v210, v173, v169, s22
  v_perm_b32 v211, v173, v169, s23
  v_perm_b32 v212, v174, v170, s22
  v_perm_b32 v213, v174, v170, s23
  v_perm_b32 v214, v175, v171, s22
  v_perm_b32 v215, v175, v171, s23
  s_waitcnt lgkmcnt(2)
  v_dot2_f32_bf16 v192, v208, v204, v192
  v_dot2_f32_bf16 v193, v209, v204, v193
  v_dot2_f32_bf16 v194, v210, v204, v194
  v_dot2_f32_bf16 v195, v211, v204, v195
  v_dot2_f32_bf16 v196, v212, v204, v196
  v_dot2_f32_bf16 v197, v213, v204, v197
  v_dot2_f32_bf16 v198, v214, v204, v198
  v_dot2_f32_bf16 v199, v215, v204, v199
  s_waitcnt vmcnt(29)
  v_perm_b32 v216, v180, v176, s22
  v_perm_b32 v217, v180, v176, s23
  v_perm_b32 v218, v181, v177, s22
  v_perm_b32 v219, v181, v177, s23
  v_perm_b32 v220, v182, v178, s22
  v_perm_b32 v221, v182, v178, s23
  v_perm_b32 v222, v183, v179, s22
  v_perm_b32 v223, v183, v179, s23
  s_waitcnt lgkmcnt(1)
  v_dot2_f32_bf16 v192, v216, v205, v192
  v_dot2_f32_bf16 v193, v217, v205, v193
  v_dot2_f32_bf16 v194, v218, v205, v194
  v_dot2_f32_bf16 v195, v219, v205, v195
  v_dot2_f32_bf16 v196, v220, v205, v196
  v_dot2_f32_bf16 v197, v221, v205, v197
  v_dot2_f32_bf16 v198, v222, v205, v198
  v_dot2_f32_bf16 v199, v223, v205, v199
  s_waitcnt vmcnt(27)
  v_perm_b32 v208, v188, v184, s22
  v_perm_b32 v209, v188, v184, s23
  v_perm_b32 v210, v189, v185, s22
  v_perm_b32 v211, v189, v185, s23
  v_perm_b32 v212, v190, v186, s22
  v_perm_b32 v213, v190, v186, s23
  v_perm_b32 v214, v191, v187, s22
  v_perm_b32 v215, v191, v187, s23
  s_waitcnt lgkmcnt(0)
  v_dot2_f32_bf16 v192, v208, v206, v192
  v_dot2_f32_bf16 v193, v209, v206, v193
  v_dot2_f32_bf16 v194, v210, v206, v194
  v_dot2_f32_bf16 v195, v211, v206, v195
  v_dot2_f32_bf16 v196, v212, v206, v196
  v_dot2_f32_bf16 v197, v213, v206, v197
  v_dot2_f32_bf16 v198, v214, v206, v198
  v_dot2_f32_bf16 v199, v215, v206, v199
  v_permlane32_swap_b32 v192, v196
  v_permlane32_swap_b32 v193, v197
  v_permlane32_swap_b32 v194, v198
  v_permlane32_swap_b32 v195, v199
  v_add_f32 v192, v192, v196
  v_add_f32 v193, v193, v197
  v_add_f32 v194, v194, v198
  v_add_f32 v195, v195, v199
  s_nop 0
  v_permlane16_swap_b32 v192, v194
  v_permlane16_swap_b32 v193, v195
  v_add_f32 v192, v192, v194
  v_add_f32 v193, v193, v195
  s_nop 0
  v_add_f32_dpp v192, v192, v192 row_ror:8 row_mask:0xf bank_mask:0xf
  v_add_f32_dpp v193, v193, v193 row_ror:8 row_mask:0xf bank_mask:0xf
  v_cvt_pk_f16_f32 v192, v192, v193
  v_mov_b32 v193, s69
  buffer_store_dwordx2 v[192:193], v246, s[32:35], s54 offen offset:0 sc1
  s_waitcnt lgkmcnt(0)
.Lnomath18:
  s_waitcnt vmcnt(23)
  ds_read_b128 v[48:51], v242 offset:8192
  ds_read_b128 v[52:55], v243 offset:8192
  ds_read_b128 v[56:59], v244 offset:8192
  ds_read_b128 v[60:63], v245 offset:8192
  s_waitcnt vmcnt(19)
  ds_read_b128 v[64:67], v242 offset:12288
  ds_read_b128 v[68:71], v243 offset:12288
  ds_read_b128 v[72:75], v244 offset:12288
  ds_read_b128 v[76:79], v245 offset:12288
  s_waitcnt lgkmcnt(7)
  v_lshlrev_b32 v224, 16, v48
  v_and_b32 v225, 0xffff0000, v48
  v_lshlrev_b32 v226, 16, v49
  v_and_b32 v227, 0xffff0000, v49
  v_lshlrev_b32 v228, 16, v50
  v_and_b32 v229, 0xffff0000, v50
  v_lshlrev_b32 v230, 16, v51
  v_and_b32 v231, 0xffff0000, v51
  v_pk_fma_f32 v[236:237], v[224:225], v[224:225], v[236:237]
  v_pk_add_f32 v[232:233], v[232:233], v[224:225]
  v_cvt_pk_f16_f32 v48, v224, v225
  v_pk_fma_f32 v[238:239], v[226:227], v[226:227], v[238:239]
  v_pk_add_f32 v[234:235], v[234:235], v[226:227]
  v_cvt_pk_f16_f32 v49, v226, v227
  v_pk_fma_f32 v[236:237], v[228:229], v[228:229], v[236:237]
  v_pk_add_f32 v[232:233], v[232:233], v[228:229]
  v_cvt_pk_f16_f32 v50, v228, v229
  v_pk_fma_f32 v[238:239], v[230:231], v[230:231], v[238:239]
  v_pk_add_f32 v[234:235], v[234:235], v[230:231]
  v_cvt_pk_f16_f32 v51, v230, v231
  s_waitcnt lgkmcnt(6)
  v_lshlrev_b32 v208, 16, v52
  v_and_b32 v209, 0xffff0000, v52
  v_lshlrev_b32 v210, 16, v53
  v_and_b32 v211, 0xffff0000, v53
  v_lshlrev_b32 v212, 16, v54
  v_and_b32 v213, 0xffff0000, v54
  v_lshlrev_b32 v214, 16, v55
  v_and_b32 v215, 0xffff0000, v55
  v_pk_fma_f32 v[236:237], v[208:209], v[208:209], v[236:237]
  v_pk_add_f32 v[232:233], v[232:233], v[208:209]
  v_cvt_pk_f16_f32 v52, v208, v209
  v_pk_fma_f32 v[238:239], v[210:211], v[210:211], v[238:239]
  v_pk_add_f32 v[234:235], v[234:235], v[210:211]
  v_cvt_pk_f16_f32 v53, v210, v211
  v_pk_fma_f32 v[236:237], v[212:213], v[212:213], v[236:237]
  v_pk_add_f32 v[232:233], v[232:233], v[212:213]
  v_cvt_pk_f16_f32 v54, v212, v213
  v_pk_fma_f32 v[238:239], v[214:215], v[214:215], v[238:239]
  v_pk_add_f32 v[234:235], v[234:235], v[214:215]
  v_cvt_pk_f16_f32 v55, v214, v215
  s_waitcnt lgkmcnt(5)
  v_lshlrev_b32 v216, 16, v56
  v_and_b32 v217, 0xffff0000, v56
  v_lshlrev_b32 v218, 16, v57
  v_and_b32 v219, 0xffff0000, v57
  v_lshlrev_b32 v220, 16, v58
  v_and_b32 v221, 0xffff0000, v58
  v_lshlrev_b32 v222, 16, v59
  v_and_b32 v223, 0xffff0000, v59
  v_pk_fma_f32 v[236:237], v[216:217], v[216:217], v[236:237]
  v_pk_add_f32 v[232:233], v[232:233], v[216:217]
  v_cvt_pk_f16_f32 v56, v216, v217
  v_pk_fma_f32 v[238:239], v[218:219], v[218:219], v[238:239]
  v_pk_add_f32 v[234:235], v[234:235], v[218:219]
  v_cvt_pk_f16_f32 v57, v218, v219
  v_pk_fma_f32 v[236:237], v[220:221], v[220:221], v[236:237]
  v_pk_add_f32 v[232:233], v[232:233], v[220:221]
  v_cvt_pk_f16_f32 v58, v220, v221
  v_pk_fma_f32 v[238:239], v[222:223], v[222:223], v[238:239]
  v_pk_add_f32 v[234:235], v[234:235], v[222:223]
  v_cvt_pk_f16_f32 v59, v222, v223
  s_waitcnt lgkmcnt(4)
  v_lshlrev_b32 v224, 16, v60
  v_and_b32 v225, 0xffff0000, v60
  v_lshlrev_b32 v226, 16, v61
  v_and_b32 v227, 0xffff0000, v61
  v_lshlrev_b32 v228, 16, v62
  v_and_b32 v229, 0xffff0000, v62
  v_lshlrev_b32 v230, 16, v63
  v_and_b32 v231, 0xffff0000, v63
  v_pk_fma_f32 v[236:237], v[224:225], v[224:225], v[236:237]
  v_pk_add_f32 v[232:233], v[232:233], v[224:225]
  v_cvt_pk_f16_f32 v60, v224, v225
  v_pk_fma_f32 v[238:239], v[226:227], v[226:227], v[238:239]
  v_pk_add_f32 v[234:235], v[234:235], v[226:227]
  v_cvt_pk_f16_f32 v61, v226, v227
  v_pk_fma_f32 v[236:237], v[228:229], v[228:229], v[236:237]
  v_pk_add_f32 v[232:233], v[232:233], v[228:229]
  v_cvt_pk_f16_f32 v62, v228, v229
  v_pk_fma_f32 v[238:239], v[230:231], v[230:231], v[238:239]
  v_pk_add_f32 v[234:235], v[234:235], v[230:231]
  v_cvt_pk_f16_f32 v63, v230, v231
  s_waitcnt vmcnt(14)
  ds_read_b128 v[80:83], v242 offset:16384
  ds_read_b128 v[84:87], v243 offset:16384
  ds_read_b128 v[88:91], v244 offset:16384
  ds_read_b128 v[92:95], v245 offset:16384
  s_waitcnt lgkmcnt(7)
  v_lshlrev_b32 v208, 16, v64
  v_and_b32 v209, 0xffff0000, v64
  v_lshlrev_b32 v210, 16, v65
  v_and_b32 v211, 0xffff0000, v65
  v_lshlrev_b32 v212, 16, v66
  v_and_b32 v213, 0xffff0000, v66
  v_lshlrev_b32 v214, 16, v67
  v_and_b32 v215, 0xffff0000, v67
  v_pk_fma_f32 v[236:237], v[208:209], v[208:209], v[236:237]
  v_pk_add_f32 v[232:233], v[232:233], v[208:209]
  v_cvt_pk_f16_f32 v64, v208, v209
  v_pk_fma_f32 v[238:239], v[210:211], v[210:211], v[238:239]
  v_pk_add_f32 v[234:235], v[234:235], v[210:211]
  v_cvt_pk_f16_f32 v65, v210, v211
  v_pk_fma_f32 v[236:237], v[212:213], v[212:213], v[236:237]
  v_pk_add_f32 v[232:233], v[232:233], v[212:213]
  v_cvt_pk_f16_f32 v66, v212, v213
  v_pk_fma_f32 v[238:239], v[214:215], v[214:215], v[238:239]
  v_pk_add_f32 v[234:235], v[234:235], v[214:215]
  v_cvt_pk_f16_f32 v67, v214, v215
  s_waitcnt lgkmcnt(6)
  v_lshlrev_b32 v216, 16, v68
  v_and_b32 v217, 0xffff0000, v68
  v_lshlrev_b32 v218, 16, v69
  v_and_b32 v219, 0xffff0000, v69
  v_lshlrev_b32 v220, 16, v70
  v_and_b32 v221, 0xffff0000, v70
  v_lshlrev_b32 v222, 16, v71
  v_and_b32 v223, 0xffff0000, v71
  v_pk_fma_f32 v[236:237], v[216:217], v[216:217], v[236:237]
  v_pk_add_f32 v[232:233], v[232:233], v[216:217]
  v_cvt_pk_f16_f32 v68, v216, v217
  v_pk_fma_f32 v[238:239], v[218:219], v[218:219], v[238:239]
  v_pk_add_f32 v[234:235], v[234:235], v[218:219]
  v_cvt_pk_f16_f32 v69, v218, v219
  v_pk_fma_f32 v[236:237], v[220:221], v[220:221], v[236:237]
  v_pk_add_f32 v[232:233], v[232:233], v[220:221]
  v_cvt_pk_f16_f32 v70, v220, v221
  v_pk_fma_f32 v[238:239], v[222:223], v[222:223], v[238:239]
  v_pk_add_f32 v[234:235], v[234:235], v[222:223]
  v_cvt_pk_f16_f32 v71, v222, v223
  s_waitcnt lgkmcnt(5)
  v_lshlrev_b32 v224, 16, v72
  v_and_b32 v225, 0xffff0000, v72
  v_lshlrev_b32 v226, 16, v73
  v_and_b32 v227, 0xffff0000, v73
  v_lshlrev_b32 v228, 16, v74
  v_and_b32 v229, 0xffff0000, v74
  v_lshlrev_b32 v230, 16, v75
  v_and_b32 v231, 0xffff0000, v75
  v_pk_fma_f32 v[236:237], v[224:225], v[224:225], v[236:237]
  v_pk_add_f32 v[232:233], v[232:233], v[224:225]
  v_cvt_pk_f16_f32 v72, v224, v225
  v_pk_fma_f32 v[238:239], v[226:227], v[226:227], v[238:239]
  v_pk_add_f32 v[234:235], v[234:235], v[226:227]
  v_cvt_pk_f16_f32 v73, v226, v227
  v_pk_fma_f32 v[236:237], v[228:229], v[228:229], v[236:237]
  v_pk_add_f32 v[232:233], v[232:233], v[228:229]
  v_cvt_pk_f16_f32 v74, v228, v229
  v_pk_fma_f32 v[238:239], v[230:231], v[230:231], v[238:239]
  v_pk_add_f32 v[234:235], v[234:235], v[230:231]
  v_cvt_pk_f16_f32 v75, v230, v231
  s_waitcnt lgkmcnt(4)
  v_lshlrev_b32 v208, 16, v76
  v_and_b32 v209, 0xffff0000, v76
  v_lshlrev_b32 v210, 16, v77
  v_and_b32 v211, 0xffff0000, v77
  v_lshlrev_b32 v212, 16, v78
  v_and_b32 v213, 0xffff0000, v78
  v_lshlrev_b32 v214, 16, v79
  v_and_b32 v215, 0xffff0000, v79
  v_pk_fma_f32 v[236:237], v[208:209], v[208:209], v[236:237]
  v_pk_add_f32 v[232:233], v[232:233], v[208:209]
  v_cvt_pk_f16_f32 v76, v208, v209
  v_pk_fma_f32 v[238:239], v[210:211], v[210:211], v[238:239]
  v_pk_add_f32 v[234:235], v[234:235], v[210:211]
  v_cvt_pk_f16_f32 v77, v210, v211
  v_pk_fma_f32 v[236:237], v[212:213], v[212:213], v[236:237]
  v_pk_add_f32 v[232:233], v[232:233], v[212:213]
  v_cvt_pk_f16_f32 v78, v212, v213
  v_pk_fma_f32 v[238:239], v[214:215], v[214:215], v[238:239]
  v_pk_add_f32 v[234:235], v[234:235], v[214:215]
  v_cvt_pk_f16_f32 v79, v214, v215
  s_waitcnt vmcnt(10)
  ds_read_b128 v[96:99], v242 offset:20480
  ds_read_b128 v[100:103], v243 offset:20480
  ds_read_b128 v[104:107], v244 offset:20480
  ds_read_b128 v[108:111], v245 offset:20480
  s_waitcnt lgkmcnt(7)
  v_lshlrev_b32 v216, 16, v80
  v_and_b32 v217, 0xffff0000, v80
  v_lshlrev_b32 v218, 16, v81
  v_and_b32 v219, 0xffff0000, v81
  v_lshlrev_b32 v220, 16, v82
  v_and_b32 v221, 0xffff0000, v82
  v_lshlrev_b32 v222, 16, v83
  v_and_b32 v223, 0xffff0000, v83
  v_pk_fma_f32 v[236:237], v[216:217], v[216:217], v[236:237]
  v_pk_add_f32 v[232:233], v[232:233], v[216:217]
  v_cvt_pk_f16_f32 v80, v216, v217
  v_pk_fma_f32 v[238:239], v[218:219], v[218:219], v[238:239]
  v_pk_add_f32 v[234:235], v[234:235], v[218:219]
  v_cvt_pk_f16_f32 v81, v218, v219
  v_pk_fma_f32 v[236:237], v[220:221], v[220:221], v[236:237]
  v_pk_add_f32 v[232:233], v[232:233], v[220:221]
  v_cvt_pk_f16_f32 v82, v220, v221
  v_pk_fma_f32 v[238:239], v[222:223], v[222:223], v[238:239]
  v_pk_add_f32 v[234:235], v[234:235], v[222:223]
  v_cvt_pk_f16_f32 v83, v222, v223
  s_waitcnt lgkmcnt(6)
  v_lshlrev_b32 v224, 16, v84
  v_and_b32 v225, 0xffff0000, v84
  v_lshlrev_b32 v226, 16, v85
  v_and_b32 v227, 0xffff0000, v85
  v_lshlrev_b32 v228, 16, v86
  v_and_b32 v229, 0xffff0000, v86
  v_lshlrev_b32 v230, 16, v87
  v_and_b32 v231, 0xffff0000, v87
  v_pk_fma_f32 v[236:237], v[224:225], v[224:225], v[236:237]
  v_pk_add_f32 v[232:233], v[232:233], v[224:225]
  v_cvt_pk_f16_f32 v84, v224, v225
  v_pk_fma_f32 v[238:239], v[226:227], v[226:227], v[238:239]
  v_pk_add_f32 v[234:235], v[234:235], v[226:227]
  v_cvt_pk_f16_f32 v85, v226, v227
  v_pk_fma_f32 v[236:237], v[228:229], v[228:229], v[236:237]
  v_pk_add_f32 v[232:233], v[232:233], v[228:229]
  v_cvt_pk_f16_f32 v86, v228, v229
  v_pk_fma_f32 v[238:239], v[230:231], v[230:231], v[238:239]
  v_pk_add_f32 v[234:235], v[234:235], v[230:231]
  v_cvt_pk_f16_f32 v87, v230, v231
  s_waitcnt lgkmcnt(5)
  v_lshlrev_b32 v208, 16, v88
  v_and_b32 v209, 0xffff0000, v88
  v_lshlrev_b32 v210, 16, v89
  v_and_b32 v211, 0xffff0000, v89
  v_lshlrev_b32 v212, 16, v90
  v_and_b32 v213, 0xffff0000, v90
  v_lshlrev_b32 v214, 16, v91
  v_and_b32 v215, 0xffff0000, v91
  v_pk_fma_f32 v[236:237], v[208:209], v[208:209], v[236:237]
  v_pk_add_f32 v[232:233], v[232:233], v[208:209]
  v_cvt_pk_f16_f32 v88, v208, v209
  v_pk_fma_f32 v[238:239], v[210:211], v[210:211], v[238:239]
  v_pk_add_f32 v[234:235], v[234:235], v[210:211]
  v_cvt_pk_f16_f32 v89, v210, v211
  v_pk_fma_f32 v[236:237], v[212:213], v[212:213], v[236:237]
  v_pk_add_f32 v[232:233], v[232:233], v[212:213]
  v_cvt_pk_f16_f32 v90, v212, v213
  v_pk_fma_f32 v[238:239], v[214:215], v[214:215], v[238:239]
  v_pk_add_f32 v[234:235], v[234:235], v[214:215]
  v_cvt_pk_f16_f32 v91, v214, v215
  s_waitcnt lgkmcnt(4)
  v_lshlrev_b32 v216, 16, v92
  v_and_b32 v217, 0xffff0000, v92
  v_lshlrev_b32 v218, 16, v93
  v_and_b32 v219, 0xffff0000, v93
  v_lshlrev_b32 v220, 16, v94
  v_and_b32 v221, 0xffff0000, v94
  v_lshlrev_b32 v222, 16, v95
  v_and_b32 v223, 0xffff0000, v95
  v_pk_fma_f32 v[236:237], v[216:217], v[216:217], v[236:237]
  v_pk_add_f32 v[232:233], v[232:233], v[216:217]
  v_cvt_pk_f16_f32 v92, v216, v217
  v_pk_fma_f32 v[238:239], v[218:219], v[218:219], v[238:239]
  v_pk_add_f32 v[234:235], v[234:235], v[218:219]
  v_cvt_pk_f16_f32 v93, v218, v219
  v_pk_fma_f32 v[236:237], v[220:221], v[220:221], v[236:237]
  v_pk_add_f32 v[232:233], v[232:233], v[220:221]
  v_cvt_pk_f16_f32 v94, v220, v221
  v_pk_fma_f32 v[238:239], v[222:223], v[222:223], v[238:239]
  v_pk_add_f32 v[234:235], v[234:235], v[222:223]
  v_cvt_pk_f16_f32 v95, v222, v223
  s_waitcnt vmcnt(6)
  ds_read_b128 v[112:115], v242 offset:24576
  ds_read_b128 v[116:119], v243 offset:24576
  ds_read_b128 v[120:123], v244 offset:24576
  ds_read_b128 v[124:127], v245 offset:24576
  s_waitcnt lgkmcnt(7)
  v_lshlrev_b32 v224, 16, v96
  v_and_b32 v225, 0xffff0000, v96
  v_lshlrev_b32 v226, 16, v97
  v_and_b32 v227, 0xffff0000, v97
  v_lshlrev_b32 v228, 16, v98
  v_and_b32 v229, 0xffff0000, v98
  v_lshlrev_b32 v230, 16, v99
  v_and_b32 v231, 0xffff0000, v99
  v_pk_fma_f32 v[236:237], v[224:225], v[224:225], v[236:237]
  v_pk_add_f32 v[232:233], v[232:233], v[224:225]
  v_cvt_pk_f16_f32 v96, v224, v225
  v_pk_fma_f32 v[238:239], v[226:227], v[226:227], v[238:239]
  v_pk_add_f32 v[234:235], v[234:235], v[226:227]
  v_cvt_pk_f16_f32 v97, v226, v227
  v_pk_fma_f32 v[236:237], v[228:229], v[228:229], v[236:237]
  v_pk_add_f32 v[232:233], v[232:233], v[228:229]
  v_cvt_pk_f16_f32 v98, v228, v229
  v_pk_fma_f32 v[238:239], v[230:231], v[230:231], v[238:239]
  v_pk_add_f32 v[234:235], v[234:235], v[230:231]
  v_cvt_pk_f16_f32 v99, v230, v231
  s_waitcnt lgkmcnt(6)
  v_lshlrev_b32 v208, 16, v100
  v_and_b32 v209, 0xffff0000, v100
  v_lshlrev_b32 v210, 16, v101
  v_and_b32 v211, 0xffff0000, v101
  v_lshlrev_b32 v212, 16, v102
  v_and_b32 v213, 0xffff0000, v102
  v_lshlrev_b32 v214, 16, v103
  v_and_b32 v215, 0xffff0000, v103
  v_pk_fma_f32 v[236:237], v[208:209], v[208:209], v[236:237]
  v_pk_add_f32 v[232:233], v[232:233], v[208:209]
  v_cvt_pk_f16_f32 v100, v208, v209
  v_pk_fma_f32 v[238:239], v[210:211], v[210:211], v[238:239]
  v_pk_add_f32 v[234:235], v[234:235], v[210:211]
  v_cvt_pk_f16_f32 v101, v210, v211
  v_pk_fma_f32 v[236:237], v[212:213], v[212:213], v[236:237]
  v_pk_add_f32 v[232:233], v[232:233], v[212:213]
  v_cvt_pk_f16_f32 v102, v212, v213
  v_pk_fma_f32 v[238:239], v[214:215], v[214:215], v[238:239]
  v_pk_add_f32 v[234:235], v[234:235], v[214:215]
  v_cvt_pk_f16_f32 v103, v214, v215
  s_waitcnt lgkmcnt(5)
  v_lshlrev_b32 v216, 16, v104
  v_and_b32 v217, 0xffff0000, v104
  v_lshlrev_b32 v218, 16, v105
  v_and_b32 v219, 0xffff0000, v105
  v_lshlrev_b32 v220, 16, v106
  v_and_b32 v221, 0xffff0000, v106
  v_lshlrev_b32 v222, 16, v107
  v_and_b32 v223, 0xffff0000, v107
  v_pk_fma_f32 v[236:237], v[216:217], v[216:217], v[236:237]
  v_pk_add_f32 v[232:233], v[232:233], v[216:217]
  v_cvt_pk_f16_f32 v104, v216, v217
  v_pk_fma_f32 v[238:239], v[218:219], v[218:219], v[238:239]
  v_pk_add_f32 v[234:235], v[234:235], v[218:219]
  v_cvt_pk_f16_f32 v105, v218, v219
  v_pk_fma_f32 v[236:237], v[220:221], v[220:221], v[236:237]
  v_pk_add_f32 v[232:233], v[232:233], v[220:221]
  v_cvt_pk_f16_f32 v106, v220, v221
  v_pk_fma_f32 v[238:239], v[222:223], v[222:223], v[238:239]
  v_pk_add_f32 v[234:235], v[234:235], v[222:223]
  v_cvt_pk_f16_f32 v107, v222, v223
  s_waitcnt lgkmcnt(4)
  v_lshlrev_b32 v224, 16, v108
  v_and_b32 v225, 0xffff0000, v108
  v_lshlrev_b32 v226, 16, v109
  v_and_b32 v227, 0xffff0000, v109
  v_lshlrev_b32 v228, 16, v110
  v_and_b32 v229, 0xffff0000, v110
  v_lshlrev_b32 v230, 16, v111
  v_and_b32 v231, 0xffff0000, v111
  v_pk_fma_f32 v[236:237], v[224:225], v[224:225], v[236:237]
  v_pk_add_f32 v[232:233], v[232:233], v[224:225]
  v_cvt_pk_f16_f32 v108, v224, v225
  v_pk_fma_f32 v[238:239], v[226:227], v[226:227], v[238:239]
  v_pk_add_f32 v[234:235], v[234:235], v[226:227]
  v_cvt_pk_f16_f32 v109, v226, v227
  v_pk_fma_f32 v[236:237], v[228:229], v[228:229], v[236:237]
  v_pk_add_f32 v[232:233], v[232:233], v[228:229]
  v_cvt_pk_f16_f32 v110, v228, v229
  v_pk_fma_f32 v[238:239], v[230:231], v[230:231], v[238:239]
  v_pk_add_f32 v[234:235], v[234:235], v[230:231]
  v_cvt_pk_f16_f32 v111, v230, v231
  buffer_load_dword v9, v12, s[32:35], s52 offen sc1
  buffer_load_dwordx4 v[128:131], v11, s[32:35], s53 offen offset:0 sc1
  buffer_load_dwordx4 v[132:135], v11, s[32:35], s53 offen offset:896 sc1
  buffer_load_dwordx4 v[136:139], v11, s[32:35], s53 offen offset:1792 sc1
  buffer_load_dwordx4 v[140:143], v11, s[32:35], s53 offen offset:2688 sc1
  s_waitcnt lgkmcnt(3)
  v_lshlrev_b32 v208, 16, v112
  v_and_b32 v209, 0xffff0000, v112
  v_lshlrev_b32 v210, 16, v113
  v_and_b32 v211, 0xffff0000, v113
  v_lshlrev_b32 v212, 16, v114
  v_and_b32 v213, 0xffff0000, v114
  v_lshlrev_b32 v214, 16, v115
  v_and_b32 v215, 0xffff0000, v115
  v_pk_fma_f32 v[236:237], v[208:209], v[208:209], v[236:237]
  v_pk_add_f32 v[232:233], v[232:233], v[208:209]
  v_cvt_pk_f16_f32 v112, v208, v209
  v_pk_fma_f32 v[238:239], v[210:211], v[210:211], v[238:239]
  v_pk_add_f32 v[234:235], v[234:235], v[210:211]
  v_cvt_pk_f16_f32 v113, v210, v211
  v_pk_fma_f32 v[236:237], v[212:213], v[212:213], v[236:237]
  v_pk_add_f32 v[232:233], v[232:233], v[212:213]
  v_cvt_pk_f16_f32 v114, v212, v213
  v_pk_fma_f32 v[238:239], v[214:215], v[214:215], v[238:239]
  v_pk_add_f32 v[234:235], v[234:235], v[214:215]
  v_cvt_pk_f16_f32 v115, v214, v215
  s_waitcnt lgkmcnt(2)
  v_lshlrev_b32 v216, 16, v116
  v_and_b32 v217, 0xffff0000, v116
  v_lshlrev_b32 v218, 16, v117
  v_and_b32 v219, 0xffff0000, v117
  v_lshlrev_b32 v220, 16, v118
  v_and_b32 v221, 0xffff0000, v118
  v_lshlrev_b32 v222, 16, v119
  v_and_b32 v223, 0xffff0000, v119
  v_pk_fma_f32 v[236:237], v[216:217], v[216:217], v[236:237]
  v_pk_add_f32 v[232:233], v[232:233], v[216:217]
  v_cvt_pk_f16_f32 v116, v216, v217
  v_pk_fma_f32 v[238:239], v[218:219], v[218:219], v[238:239]
  v_pk_add_f32 v[234:235], v[234:235], v[218:219]
  v_cvt_pk_f16_f32 v117, v218, v219
  v_pk_fma_f32 v[236:237], v[220:221], v[220:221], v[236:237]
  v_pk_add_f32 v[232:233], v[232:233], v[220:221]
  v_cvt_pk_f16_f32 v118, v220, v221
  v_pk_fma_f32 v[238:239], v[222:223], v[222:223], v[238:239]
  v_pk_add_f32 v[234:235], v[234:235], v[222:223]
  v_cvt_pk_f16_f32 v119, v222, v223
  s_waitcnt lgkmcnt(1)
  v_lshlrev_b32 v224, 16, v120
  v_and_b32 v225, 0xffff0000, v120
  v_lshlrev_b32 v226, 16, v121
  v_and_b32 v227, 0xffff0000, v121
  v_lshlrev_b32 v228, 16, v122
  v_and_b32 v229, 0xffff0000, v122
  v_lshlrev_b32 v230, 16, v123
  v_and_b32 v231, 0xffff0000, v123
  v_pk_fma_f32 v[236:237], v[224:225], v[224:225], v[236:237]
  v_pk_add_f32 v[232:233], v[232:233], v[224:225]
  v_cvt_pk_f16_f32 v120, v224, v225
  v_pk_fma_f32 v[238:239], v[226:227], v[226:227], v[238:239]
  v_pk_add_f32 v[234:235], v[234:235], v[226:227]
  v_cvt_pk_f16_f32 v121, v226, v227
  v_pk_fma_f32 v[236:237], v[228:229], v[228:229], v[236:237]
  v_pk_add_f32 v[232:233], v[232:233], v[228:229]
  v_cvt_pk_f16_f32 v122, v228, v229
  v_pk_fma_f32 v[238:239], v[230:231], v[230:231], v[238:239]
  v_pk_add_f32 v[234:235], v[234:235], v[230:231]
  v_cvt_pk_f16_f32 v123, v230, v231
  s_waitcnt lgkmcnt(0)
  v_lshlrev_b32 v208, 16, v124
  v_and_b32 v209, 0xffff0000, v124
  v_lshlrev_b32 v210, 16, v125
  v_and_b32 v211, 0xffff0000, v125
  v_lshlrev_b32 v212, 16, v126
  v_and_b32 v213, 0xffff0000, v126
  v_lshlrev_b32 v214, 16, v127
  v_and_b32 v215, 0xffff0000, v127
  v_pk_fma_f32 v[236:237], v[208:209], v[208:209], v[236:237]
  v_pk_add_f32 v[232:233], v[232:233], v[208:209]
  v_cvt_pk_f16_f32 v124, v208, v209
  v_pk_fma_f32 v[238:239], v[210:211], v[210:211], v[238:239]
  v_pk_add_f32 v[234:235], v[234:235], v[210:211]
  v_cvt_pk_f16_f32 v125, v210, v211
  v_pk_fma_f32 v[236:237], v[212:213], v[212:213], v[236:237]
  v_pk_add_f32 v[232:233], v[232:233], v[212:213]
  v_cvt_pk_f16_f32 v126, v212, v213
  v_pk_fma_f32 v[238:239], v[214:215], v[214:215], v[238:239]
  v_pk_add_f32 v[234:235], v[234:235], v[214:215]
  v_cvt_pk_f16_f32 v127, v214, v215
  v_pk_add_f32 v[232:233], v[232:233], v[234:235]
  v_pk_add_f32 v[236:237], v[236:237], v[238:239]
  v_add_f32 v232, v232, v233
  v_add_f32 v236, v236, v237
  s_nop 1
  v_permlane32_swap_b32 v232, v236
  v_add_f32 v232, v232, v236
  v_mul_f32 v232, 0x3b124925, v232
  v_mov_b32 v233, v232
  s_nop 1
  v_permlane32_swap_b32 v232, v233
  v_fma_f32 v233, -v232, v232, v233
  v_max_f32 v233, 0, v233
  v_add_f32 v233, 0x3727c5ac, v233
  v_rsq_f32 v233, v233
  v_bfe_u32 v250, v1, 2, 2
  v_mad_u32_u24 v249, v10, 4, v250
  v_mul_u32_u24 v249, 128, v249
  v_bfe_u32 v250, v1, 4, 1
  v_mul_u32_u24 v250, 32, v250
  v_add3_u32 v249, v249, v250, s59
  v_and_b32 v250, 3, v1
  v_lshl_add_u32 v249, v250, 3, v249
  v_mul_f32 v232, -v232, v233
  v_cvt_pk_f16_f32 v236, v233, v233
  v_cvt_pk_f16_f32 v237, v232, v232
  v_bfe_u32 v250, v1, 4, 1
  v_mul_u32_u24 v250, 2016, v250
  v_add_u32 v250, v250, v249
  v_pk_fma_f16 v16, v16, v236, v237
  v_pk_fma_f16 v17, v17, v236, v237
  v_pk_fma_f16 v18, v18, v236, v237
  v_pk_fma_f16 v19, v19, v236, v237
  v_pk_fma_f16 v20, v20, v236, v237
  v_pk_fma_f16 v21, v21, v236, v237
  v_pk_fma_f16 v22, v22, v236, v237
  v_pk_fma_f16 v23, v23, v236, v237
  v_pk_fma_f16 v24, v24, v236, v237
  v_pk_fma_f16 v25, v25, v236, v237
  v_pk_fma_f16 v26, v26, v236, v237
  v_pk_fma_f16 v27, v27, v236, v237
  v_pk_fma_f16 v28, v28, v236, v237
  v_pk_fma_f16 v29, v29, v236, v237
  v_pk_fma_f16 v30, v30, v236, v237
  v_pk_fma_f16 v31, v31, v236, v237
  v_pk_fma_f16 v32, v32, v236, v237
  v_pk_fma_f16 v33, v33, v236, v237
  v_pk_fma_f16 v34, v34, v236, v237
  v_pk_fma_f16 v35, v35, v236, v237
  v_pk_fma_f16 v36, v36, v236, v237
  v_pk_fma_f16 v37, v37, v236, v237
  v_pk_fma_f16 v38, v38, v236, v237
  v_pk_fma_f16 v39, v39, v236, v237
  v_pk_fma_f16 v40, v40, v236, v237
  v_pk_fma_f16 v41, v41, v236, v237
  v_pk_fma_f16 v42, v42, v236, v237
  v_pk_fma_f16 v43, v43, v236, v237
  v_pk_fma_f16 v44, v44, v236, v237
  v_pk_fma_f16 v45, v45, v236, v237
  v_pk_fma_f16 v46, v46, v236, v237
  v_pk_fma_f16 v47, v47, v236, v237
  v_pk_fma_f16 v48, v48, v236, v237
  v_pk_fma_f16 v49, v49, v236, v237
  v_pk_fma_f16 v50, v50, v236, v237
  v_pk_fma_f16 v51, v51, v236, v237
  v_pk_fma_f16 v52, v52, v236, v237
  v_pk_fma_f16 v53, v53, v236, v237
  v_pk_fma_f16 v54, v54, v236, v237
  v_pk_fma_f16 v55, v55, v236, v237
  v_pk_fma_f16 v56, v56, v236, v237
  v_pk_fma_f16 v57, v57, v236, v237
  v_pk_fma_f16 v58, v58, v236, v237
  v_pk_fma_f16 v59, v59, v236, v237
  v_pk_fma_f16 v60, v60, v236, v237
  v_pk_fma_f16 v61, v61, v236, v237
  v_pk_fma_f16 v62, v62, v236, v237
  v_pk_fma_f16 v63, v63, v236, v237
  v_pk_fma_f16 v64, v64, v236, v237
  v_pk_fma_f16 v65, v65, v236, v237
  v_pk_fma_f16 v66, v66, v236, v237
  v_pk_fma_f16 v67, v67, v236, v237
  v_pk_fma_f16 v68, v68, v236, v237
  v_pk_fma_f16 v69, v69, v236, v237
  v_pk_fma_f16 v70, v70, v236, v237
  v_pk_fma_f16 v71, v71, v236, v237
  v_pk_fma_f16 v72, v72, v236, v237
  v_pk_fma_f16 v73, v73, v236, v237
  v_pk_fma_f16 v74, v74, v236, v237
  v_pk_fma_f16 v75, v75, v236, v237
  v_pk_fma_f16 v76, v76, v236, v237
  v_pk_fma_f16 v77, v77, v236, v237
  v_pk_fma_f16 v78, v78, v236, v237
  v_pk_fma_f16 v79, v79, v236, v237
  s_waitcnt vmcnt(5)
  ds_read_b64_tr_b16 v[240:241], v249 offset:2048
  ds_read_b64_tr_b16 v[242:243], v249 offset:3072
  ds_read_b64_tr_b16 v[244:245], v249 offset:2112
  ds_read_b64_tr_b16 v[246:247], v249 offset:3136
  ds_read_b64_tr_b16 v[160:161], v250 offset:4096
  ds_read_b64_tr_b16 v[162:163], v250 offset:5120
  ds_read_b64_tr_b16 v[164:165], v250 offset:4128
  ds_read_b64_tr_b16 v[166:167], v250 offset:5152
  ds_read_b64_tr_b16 v[168:169], v250 offset:4160
  ds_read_b64_tr_b16 v[170:171], v250 offset:5184
  ds_read_b64_tr_b16 v[172:173], v250 offset:4192
  ds_read_b64_tr_b16 v[174:175], v250 offset:5216
  v_pk_fma_f16 v80, v80, v236, v237
  v_pk_fma_f16 v81, v81, v236, v237
  v_pk_fma_f16 v82, v82, v236, v237
  v_pk_fma_f16 v83, v83, v236, v237
  v_pk_fma_f16 v84, v84, v236, v237
  v_pk_fma_f16 v85, v85, v236, v237
  v_pk_fma_f16 v86, v86, v236, v237
  v_pk_fma_f16 v87, v87, v236, v237
  v_pk_fma_f16 v88, v88, v236, v237
  v_pk_fma_f16 v89, v89, v236, v237
  v_pk_fma_f16 v90, v90, v236, v237
  v_pk_fma_f16 v91, v91, v236, v237
  v_pk_fma_f16 v92, v92, v236, v237
  v_pk_fma_f16 v93, v93, v236, v237
  v_pk_fma_f16 v94, v94, v236, v237
  v_pk_fma_f16 v95, v95, v236, v237
  v_pk_fma_f16 v96, v96, v236, v237
  v_pk_fma_f16 v97, v97, v236, v237
  v_pk_fma_f16 v98, v98, v236, v237
  v_pk_fma_f16 v99, v99, v236, v237
  v_pk_fma_f16 v100, v100, v236, v237
  v_pk_fma_f16 v101, v101, v236, v237
  v_pk_fma_f16 v102, v102, v236, v237
  v_pk_fma_f16 v103, v103, v236, v237
  v_pk_fma_f16 v104, v104, v236, v237
  v_pk_fma_f16 v105, v105, v236, v237
  v_pk_fma_f16 v106, v106, v236, v237
  v_pk_fma_f16 v107, v107, v236, v237
  v_pk_fma_f16 v108, v108, v236, v237
  v_pk_fma_f16 v109, v109, v236, v237
  v_pk_fma_f16 v110, v110, v236, v237
  v_pk_fma_f16 v111, v111, v236, v237
  v_pk_fma_f16 v112, v112, v236, v237
  v_pk_fma_f16 v113, v113, v236, v237
  v_pk_fma_f16 v114, v114, v236, v237
  v_pk_fma_f16 v115, v115, v236, v237
  v_pk_fma_f16 v116, v116, v236, v237
  v_pk_fma_f16 v117, v117, v236, v237
  v_pk_fma_f16 v118, v118, v236, v237
  v_pk_fma_f16 v119, v119, v236, v237
  v_pk_fma_f16 v120, v120, v236, v237
  v_pk_fma_f16 v121, v121, v236, v237
  v_pk_fma_f16 v122, v122, v236, v237
  v_pk_fma_f16 v123, v123, v236, v237
  v_pk_fma_f16 v124, v124, v236, v237
  v_pk_fma_f16 v125, v125, v236, v237
  v_pk_fma_f16 v126, v126, v236, v237
  v_pk_fma_f16 v127, v127, v236, v237
  s_waitcnt lgkmcnt(7)
  v_lshlrev_b32 v208, 16, v160
  v_and_b32 v209, 0xffff0000, v160
  v_lshlrev_b32 v210, 16, v161
  v_and_b32 v211, 0xffff0000, v161
  s_waitcnt lgkmcnt(6)
  v_lshlrev_b32 v212, 16, v162
  v_and_b32 v213, 0xffff0000, v162
  v_lshlrev_b32 v214, 16, v163
  v_and_b32 v215, 0xffff0000, v163
  v_cvt_pk_f16_f32 v160, v208, v209
  v_cvt_pk_f16_f32 v161, v210, v211
  v_cvt_pk_f16_f32 v162, v212, v213
  v_cvt_pk_f16_f32 v163, v214, v215
  s_waitcnt lgkmcnt(5)
  v_lshlrev_b32 v216, 16, v164
  v_and_b32 v217, 0xffff0000, v164
  v_lshlrev_b32 v218, 16, v165
  v_and_b32 v219, 0xffff0000, v165
  s_waitcnt lgkmcnt(4)
  v_lshlrev_b32 v220, 16, v166
  v_and_b32 v221, 0xffff0000, v166
  v_lshlrev_b32 v222, 16, v167
  v_and_b32 v223, 0xffff0000, v167
  v_cvt_pk_f16_f32 v164, v216, v217
  v_cvt_pk_f16_f32 v165, v218, v219
  v_cvt_pk_f16_f32 v166, v220, v221
  v_cvt_pk_f16_f32 v167, v222, v223
  s_waitcnt lgkmcnt(3)
  v_lshlrev_b32 v208, 16, v168
  v_and_b32 v209, 0xffff0000, v168
  v_lshlrev_b32 v210, 16, v169
  v_and_b32 v211, 0xffff0000, v169
  s_waitcnt lgkmcnt(2)
  v_lshlrev_b32 v212, 16, v170
  v_and_b32 v213, 0xffff0000, v170
  v_lshlrev_b32 v214, 16, v171
  v_and_b32 v215, 0xffff0000, v171
  v_cvt_pk_f16_f32 v168, v208, v209
  v_cvt_pk_f16_f32 v169, v210, v211
  v_cvt_pk_f16_f32 v170, v212, v213
  v_cvt_pk_f16_f32 v171, v214, v215
  s_waitcnt lgkmcnt(1)
  v_lshlrev_b32 v216, 16, v172
  v_and_b32 v217, 0xffff0000, v172
  v_lshlrev_b32 v218, 16, v173
  v_and_b32 v219, 0xffff0000, v173
  s_waitcnt lgkmcnt(0)
  v_lshlrev_b32 v220, 16, v174
  v_and_b32 v221, 0xffff0000, v174
  v_lshlrev_b32 v222, 16, v175
  v_and_b32 v223, 0xffff0000, v175
  v_cvt_pk_f16_f32 v172, v216, v217
  v_cvt_pk_f16_f32 v173, v218, v219
  v_cvt_pk_f16_f32 v174, v220, v221
  v_cvt_pk_f16_f32 v175, v222, v223
  v_lshlrev_b32 v208, 16, v240
  v_and_b32 v209, 0xffff0000, v240
  v_lshlrev_b32 v210, 16, v241
  v_and_b32 v211, 0xffff0000, v241
  v_lshlrev_b32 v212, 16, v242
  v_and_b32 v213, 0xffff0000, v242
  v_lshlrev_b32 v214, 16, v243
  v_and_b32 v215, 0xffff0000, v243
  v_cvt_pk_f16_f32 v240, v208, v209
  v_cvt_pk_f16_f32 v241, v210, v211
  v_cvt_pk_f16_f32 v242, v212, v213
  v_cvt_pk_f16_f32 v243, v214, v215
  v_lshlrev_b32 v216, 16, v244
  v_and_b32 v217, 0xffff0000, v244
  v_lshlrev_b32 v218, 16, v245
  v_and_b32 v219, 0xffff0000, v245
  v_lshlrev_b32 v220, 16, v246
  v_and_b32 v221, 0xffff0000, v246
  v_lshlrev_b32 v222, 16, v247
  v_and_b32 v223, 0xffff0000, v247
  v_cvt_pk_f16_f32 v244, v216, v217
  v_cvt_pk_f16_f32 v245, v218, v219
  v_cvt_pk_f16_f32 v246, v220, v221
  v_cvt_pk_f16_f32 v247, v222, v223
  s_mul_i32 s48, s45, 86016
  s_add_u32 s48, s48, s51
  s_add_u32 s48, s48, 0x400000
  s_mov_b32 s30, 0x40000000
  s_mov_b32 s56, 30000
.Lpoll019:
  s_waitcnt vmcnt(0)
  v_cmp_eq_u32 vcc, s69, v9
  v_cmp_eq_u32 s[54:55], s69, v129
  s_and_b64 vcc, vcc, s[54:55]
  v_cmp_eq_u32 s[54:55], s69, v131
  s_and_b64 vcc, vcc, s[54:55]
  v_cmp_eq_u32 s[54:55], s69, v133
  s_and_b64 vcc, vcc, s[54:55]
  v_cmp_eq_u32 s[54:55], s69, v135
  s_and_b64 vcc, vcc, s[54:55]
  v_cmp_eq_u32 s[54:55], s69, v137
  s_and_b64 vcc, vcc, s[54:55]
  v_cmp_eq_u32 s[54:55], s69, v139
  s_and_b64 vcc, vcc, s[54:55]
  v_cmp_eq_u32 s[54:55], s69, v141
  s_and_b64 vcc, vcc, s[54:55]
  v_cmp_eq_u32 s[54:55], s69, v143
  s_and_b64 vcc, vcc, s[54:55]
  s_cmp_eq_u64 vcc, -1
  s_cbranch_scc1 .Lpolled020
  s_sub_u32 s56, s56, 1
  s_cbranch_scc1 .Lpolled020
  buffer_load_dword v9, v12, s[32:35], s52 offen sc1
  buffer_load_dwordx4 v[128:131], v11, s[32:35], s53 offen offset:0 sc1
  buffer_load_dwordx4 v[132:135], v11, s[32:35], s53 offen offset:896 sc1
  buffer_load_dwordx4 v[136:139], v11, s[32:35], s53 offen offset:1792 sc1
  buffer_load_dwordx4 v[140:143], v11, s[32:35], s53 offen offset:2688 sc1
  s_branch .Lpoll019
.Lpolled020:
  s_barrier
  s_lshl_b32 s4, s31, 13
  s_lshl_b32 s5, s31, 12
  s_lshl_b32 s6, s31, 7
  s_add_u32 m0, s51, 0
  s_add_u32 s7, s48, s4
  buffer_load_dwordx4 v2, s[32:35], s7 offen sc1 lds
  s_add_u32 m0, s51, 4096
  s_add_u32 s7, s7, 4096
  buffer_load_dwordx4 v2, s[32:35], s7 offen sc1 lds
  s_add_u32 s4, s4, 8192
  s_cmp_eq_u32 s4, 57344
  s_cselect_b32 s4, 0, s4
  s_add_u32 m0, s51, 8192
  s_add_u32 s7, s48, s4
  buffer_load_dwordx4 v2, s[32:35], s7 offen sc1 lds
  s_add_u32 m0, s51, 12288
  s_add_u32 s7, s7, 4096
  buffer_load_dwordx4 v2, s[32:35], s7 offen sc1 lds
  s_add_u32 s4, s4, 8192
  s_cmp_eq_u32 s4, 57344
  s_cselect_b32 s4, 0, s4
  s_add_u32 s8, s48, 57344
  s_cmp_ge_u32 s3, 2
  s_cselect_b32 s55, 1.0, 0
  v_fma_mix_f32 v129, v128, 1.0, v132 op_sel:[0,0,0] op_sel_hi:[1,0,1]
  v_fma_mix_f32 v131, v128, 1.0, v132 op_sel:[1,0,1] op_sel_hi:[1,0,1]
  v_fma_mix_f32 v133, v130, 1.0, v134 op_sel:[0,0,0] op_sel_hi:[1,0,1]
  v_fma_mix_f32 v135, v130, 1.0, v134 op_sel:[1,0,1] op_sel_hi:[1,0,1]
  v_fma_mix_f32 v129, v136, 1.0, v129 op_sel:[0,0,0] op_sel_hi:[1,0,0]
  v_fma_mix_f32 v131, v136, 1.0, v131 op_sel:[1,0,0] op_sel_hi:[1,0,0]
  v_fma_mix_f32 v133, v138, 1.0, v133 op_sel:[0,0,0] op_sel_hi:[1,0,0]
  v_fma_mix_f32 v135, v138, 1.0, v135 op_sel:[1,0,0] op_sel_hi:[1,0,0]
  v_fma_mix_f32 v129, v140, 1.0, v129 op_sel:[0,0,0] op_sel_hi:[1,0,0]
  v_fma_mix_f32 v131, v140, 1.0, v131 op_sel:[1,0,0] op_sel_hi:[1,0,0]
  v_fma_mix_f32 v133, v142, 1.0, v133 op_sel:[0,0,0] op_sel_hi:[1,0,0]
  v_fma_mix_f32 v135, v142, 1.0, v135 op_sel:[1,0,0] op_sel_hi:[1,0,0]
  v_cvt_pk_bf16_f32 v128, v129, v131
  v_cvt_pk_bf16_f32 v130, v133, v135
  v_lshlrev_b32 v129, 16, v128
  v_and_b32 v131, 0xffff0000, v128
  v_lshlrev_b32 v133, 16, v130
  v_and_b32 v135, 0xffff0000, v130
  v_add_f32 v129, s55, v129
  v_add_f32 v131, s55, v131
  v_add_f32 v133, s55, v133
  v_add_f32 v135, s55, v135
  v_cvt_pk_bf16_f32 v128, v129, v131
  v_cvt_pk_bf16_f32 v130, v133, v135
  v_lshlrev_b32 v129, 16, v128
  v_and_b32 v131, 0xffff0000, v128
  v_lshlrev_b32 v133, 16, v130
  v_and_b32 v135, 0xffff0000, v130
  v_cvt_pk_f16_f32 v128, v129, v131
  v_cvt_pk_f16_f32 v129, v133, v135
  v_lshrrev_b32 v11, 1, v11
  s_mul_i32 s54, s3, 448
  s_add_u32 s54, s54, 147456
  v_add_u32 v11, s54, v11
  ds_write_b64 v11, v[128:129]
  s_lshl_b32 s49, s45, 11
  s_add_u32 s49, s49, 0x20000
  v_and_b32 v7, 15, v1
  v_lshlrev_b32 v15, 8, v7
  v_bfe_u32 v12, v1, 4, 1
  v_lshl_add_u32 v15, v12, 2, v15
  s_and_b32 s47, s45, 3
  s_lshl_b32 s47, s47, 6
  s_add_u32 s47, s47, 106552
  s_waitcnt lgkmcnt(0)
  s_barrier
  v_add_u32 v14, s6, v5
  ds_read_b128 v[176:179], v14 offset:896
  ds_read_b128 v[180:183], v14 offset:0
  ds_read_b128 v[184:187], v14 offset:928
  ds_read_b128 v[188:191], v14 offset:32
  ds_read_b128 v[192:195], v14 offset:960
  ds_read_b128 v[196:199], v14 offset:64
  ds_read_b128 v[200:203], v14 offset:992
  ds_read_b128 v[204:207], v14 offset:96
  s_add_u32 s6, s6, 128
  s_cmp_eq_u32 s6, 896
  s_cselect_b32 s6, 0, s6
  v_add_u32 v14, s6, v5
  ds_read_b128 v[208:211], v14 offset:896
  ds_read_b128 v[212:215], v14 offset:0
  ds_read_b128 v[216:219], v14 offset:928
  ds_read_b128 v[220:223], v14 offset:32
  ds_read_b128 v[224:227], v14 offset:960
  ds_read_b128 v[228:231], v14 offset:64
  ds_read_b128 v[232:235], v14 offset:992
  ds_read_b128 v[236:239], v14 offset:96
  s_add_u32 s6, s6, 128
  s_cmp_eq_u32 s6, 896
  s_cselect_b32 s6, 0, s6
  v_lshlrev_b32 v7, 2, v7
  s_mov_b32 s60, 0x3fb8aa3b
  s_mov_b32 s61, 0xbdd2d3e8
  s_mul_i32 s50, s45, 200704
  s_add_u32 s50, s50, s51
  s_add_u32 s50, s50, 0x600000
  s_and_b32 s52, s45, 3
  s_lshl_b32 s52, s52, 2
  s_add_u32 s52, s52, s3
  s_lshl_b32 s52, s52, 15
  s_add_u32 s52, s52, 0x580000
  s_lshr_b32 s53, s45, 1
  s_mul_i32 s53, s53, 112
  s_mul_i32 s54, s3, 28
  s_add_u32 s53, s53, s54
  s_lshl_b32 s53, s53, 11
  s_add_u32 s53, s53, 0xa00000
  v_and_b32 v11, 31, v1
  s_lshl_b32 s54, s3, 5
  v_add_u32 v11, s54, v11
  v_mul_u32_u24 v11, 224, v11
  v_lshl_add_u32 v11, v10, 4, v11
  v_add_u32 v11, 86016, v11
  v_lshrrev_b32 v13, 2, v1
  v_mul_u32_u24 v13, 224, v13
  v_and_b32 v12, 3, v1
  v_lshl_add_u32 v13, v12, 3, v13
  s_add_u32 s54, s54, 86016
  v_add_u32 v12, s54, v13
  v_add_u32 v13, 86144, v13
  s_waitcnt lgkmcnt(14)
  v_pk_fma_f16 v16, v16, v176, v180
  v_pk_fma_f16 v17, v17, v177, v181
  v_pk_fma_f16 v18, v18, v178, v182
  v_pk_fma_f16 v19, v19, v179, v183
  s_waitcnt lgkmcnt(12)
  v_pk_fma_f16 v20, v20, v184, v188
  v_pk_fma_f16 v21, v21, v185, v189
  v_pk_fma_f16 v22, v22, v186, v190
  v_pk_fma_f16 v23, v23, v187, v191
  s_add_u32 m0, s51, 16384
  s_add_u32 s7, s48, s4
  buffer_load_dwordx4 v2, s[32:35], s7 offen sc1 lds
  s_waitcnt lgkmcnt(10)
  v_pk_fma_f16 v24, v24, v192, v196
  v_pk_fma_f16 v25, v25, v193, v197
  v_pk_fma_f16 v26, v26, v194, v198
  v_pk_fma_f16 v27, v27, v195, v199
  s_waitcnt lgkmcnt(8)
  v_pk_fma_f16 v28, v28, v200, v204
  v_pk_fma_f16 v29, v29, v201, v205
  v_pk_fma_f16 v30, v30, v202, v206
  v_pk_fma_f16 v31, v31, v203, v207
  s_add_u32 m0, s51, 20480
  s_add_u32 s7, s7, 4096
  buffer_load_dwordx4 v2, s[32:35], s7 offen sc1 lds
  s_add_u32 s4, s4, 8192
  s_cmp_eq_u32 s4, 57344
  s_cselect_b32 s4, 0, s4
  v_add_u32 v14, s6, v5
  ds_read_b128 v[176:179], v14 offset:896
  ds_read_b128 v[180:183], v14 offset:0
  ds_read_b128 v[184:187], v14 offset:928
  ds_read_b128 v[188:191], v14 offset:32
  ds_read_b128 v[192:195], v14 offset:960
  ds_read_b128 v[196:199], v14 offset:64
  ds_read_b128 v[200:203], v14 offset:992
  ds_read_b128 v[204:207], v14 offset:96
  s_add_u32 s6, s6, 128
  s_cmp_eq_u32 s6, 896
  s_cselect_b32 s6, 0, s6
  s_waitcnt lgkmcnt(14)
  v_pk_fma_f16 v32, v32, v208, v212
  v_pk_fma_f16 v33, v33, v209, v213
  v_pk_fma_f16 v34, v34, v210, v214
  v_pk_fma_f16 v35, v35, v211, v215
  s_waitcnt lgkmcnt(12)
  v_pk_fma_f16 v36, v36, v216, v220
  v_pk_fma_f16 v37, v37, v217, v221
  v_pk_fma_f16 v38, v38, v218, v222
  v_pk_fma_f16 v39, v39, v219, v223
  s_add_u32 m0, s51, 24576
  s_add_u32 s7, s48, s4
  buffer_load_dwordx4 v2, s[32:35], s7 offen sc1 lds
  s_waitcnt lgkmcnt(10)
  v_pk_fma_f16 v40, v40, v224, v228
  v_pk_fma_f16 v41, v41, v225, v229
  v_pk_fma_f16 v42, v42, v226, v230
  v_pk_fma_f16 v43, v43, v227, v231
  s_waitcnt lgkmcnt(8)
  v_pk_fma_f16 v44, v44, v232, v236
  v_pk_fma_f16 v45, v45, v233, v237
  v_pk_fma_f16 v46, v46, v234, v238
  v_pk_fma_f16 v47, v47, v235, v239
  s_add_u32 m0, s51, 28672
  s_add_u32 s7, s7, 4096
  buffer_load_dwordx4 v2, s[32:35], s7 offen sc1 lds
  s_add_u32 s4, s4, 8192
  s_cmp_eq_u32 s4, 57344
  s_cselect_b32 s4, 0, s4
  v_add_u32 v14, s6, v5
  ds_read_b128 v[208:211], v14 offset:896
  ds_read_b128 v[212:215], v14 offset:0
  ds_read_b128 v[216:219], v14 offset:928
  ds_read_b128 v[220:223], v14 offset:32
  ds_read_b128 v[224:227], v14 offset:960
  ds_read_b128 v[228:231], v14 offset:64
  ds_read_b128 v[232:235], v14 offset:992
  ds_read_b128 v[236:239], v14 offset:96
  s_add_u32 s6, s6, 128
  s_cmp_eq_u32 s6, 896
  s_cselect_b32 s6, 0, s6
  s_waitcnt lgkmcnt(14)
  v_pk_fma_f16 v48, v48, v176, v180
  v_pk_fma_f16 v49, v49, v177, v181
  v_pk_fma_f16 v50, v50, v178, v182
  v_pk_fma_f16 v51, v51, v179, v183
  s_waitcnt lgkmcnt(12)
  v_pk_fma_f16 v52, v52, v184, v188
  v_pk_fma_f16 v53, v53, v185, v189
  v_pk_fma_f16 v54, v54, v186, v190
  v_pk_fma_f16 v55, v55, v187, v191
  s_waitcnt lgkmcnt(10)
  v_pk_fma_f16 v56, v56, v192, v196
  v_pk_fma_f16 v57, v57, v193, v197
  v_pk_fma_f16 v58, v58, v194, v198
  v_pk_fma_f16 v59, v59, v195, v199
  s_waitcnt lgkmcnt(8)
  v_pk_fma_f16 v60, v60, v200, v204
  v_pk_fma_f16 v61, v61, v201, v205
  v_pk_fma_f16 v62, v62, v202, v206
  v_pk_fma_f16 v63, v63, v203, v207
  v_add_u32 v14, s6, v5
  ds_read_b128 v[176:179], v14 offset:896
  ds_read_b128 v[180:183], v14 offset:0
  ds_read_b128 v[184:187], v14 offset:928
  ds_read_b128 v[188:191], v14 offset:32
  ds_read_b128 v[192:195], v14 offset:960
  ds_read_b128 v[196:199], v14 offset:64
  ds_read_b128 v[200:203], v14 offset:992
  ds_read_b128 v[204:207], v14 offset:96
  s_add_u32 s6, s6, 128
  s_cmp_eq_u32 s6, 896
  s_cselect_b32 s6, 0, s6
  s_waitcnt lgkmcnt(14)
  v_pk_fma_f16 v64, v64, v208, v212
  v_pk_fma_f16 v65, v65, v209, v213
  v_pk_fma_f16 v66, v66, v210, v214
  v_pk_fma_f16 v67, v67, v211, v215
  s_waitcnt lgkmcnt(12)
  v_pk_fma_f16 v68, v68, v216, v220
  v_pk_fma_f16 v69, v69, v217, v221
  v_pk_fma_f16 v70, v70, v218, v222
  v_pk_fma_f16 v71, v71, v219, v223
  s_waitcnt lgkmcnt(10)
  v_pk_fma_f16 v72, v72, v224, v228
  v_pk_fma_f16 v73, v73, v225, v229
  v_pk_fma_f16 v74, v74, v226, v230
  v_pk_fma_f16 v75, v75, v227, v231
  s_waitcnt lgkmcnt(8)
  v_pk_fma_f16 v76, v76, v232, v236
  v_pk_fma_f16 v77, v77, v233, v237
  v_pk_fma_f16 v78, v78, v234, v238
  v_pk_fma_f16 v79, v79, v235, v239
  v_add_u32 v14, s6, v5
  ds_read_b128 v[208:211], v14 offset:896
  ds_read_b128 v[212:215], v14 offset:0
  ds_read_b128 v[216:219], v14 offset:928
  ds_read_b128 v[220:223], v14 offset:32
  ds_read_b128 v[224:227], v14 offset:960
  ds_read_b128 v[228:231], v14 offset:64
  ds_read_b128 v[232:235], v14 offset:992
  ds_read_b128 v[236:239], v14 offset:96
  s_add_u32 s6, s6, 128
  s_cmp_eq_u32 s6, 896
  s_cselect_b32 s6, 0, s6
  s_waitcnt lgkmcnt(14)
  v_pk_fma_f16 v80, v80, v176, v180
  v_pk_fma_f16 v81, v81, v177, v181
  v_pk_fma_f16 v82, v82, v178, v182
  v_pk_fma_f16 v83, v83, v179, v183
  s_waitcnt lgkmcnt(12)
  v_pk_fma_f16 v84, v84, v184, v188
  v_pk_fma_f16 v85, v85, v185, v189
  v_pk_fma_f16 v86, v86, v186, v190
  v_pk_fma_f16 v87, v87, v187, v191
  s_waitcnt lgkmcnt(10)
  v_pk_fma_f16 v88, v88, v192, v196
  v_pk_fma_f16 v89, v89, v193, v197
  v_pk_fma_f16 v90, v90, v194, v198
  v_pk_fma_f16 v91, v91, v195, v199
  s_waitcnt lgkmcnt(8)
  v_pk_fma_f16 v92, v92, v200, v204
  v_pk_fma_f16 v93, v93, v201, v205
  v_pk_fma_f16 v94, v94, v202, v206
  v_pk_fma_f16 v95, v95, v203, v207
  v_add_u32 v14, s6, v5
  ds_read_b128 v[176:179], v14 offset:896
  ds_read_b128 v[180:183], v14 offset:0
  ds_read_b128 v[184:187], v14 offset:928
  ds_read_b128 v[188:191], v14 offset:32
  ds_read_b128 v[192:195], v14 offset:960
  ds_read_b128 v[196:199], v14 offset:64
  ds_read_b128 v[200:203], v14 offset:992
  ds_read_b128 v[204:207], v14 offset:96
  s_waitcnt lgkmcnt(14)
  v_pk_fma_f16 v96, v96, v208, v212
  v_pk_fma_f16 v97, v97, v209, v213
  v_pk_fma_f16 v98, v98, v210, v214
  v_pk_fma_f16 v99, v99, v211, v215
  s_waitcnt lgkmcnt(12)
  v_pk_fma_f16 v100, v100, v216, v220
  v_pk_fma_f16 v101, v101, v217, v221
  v_pk_fma_f16 v102, v102, v218, v222
  v_pk_fma_f16 v103, v103, v219, v223
  s_waitcnt lgkmcnt(10)
  v_pk_fma_f16 v104, v104, v224, v228
  v_pk_fma_f16 v105, v105, v225, v229
  v_pk_fma_f16 v106, v106, v226, v230
  v_pk_fma_f16 v107, v107, v227, v231
  s_waitcnt lgkmcnt(8)
  v_pk_fma_f16 v108, v108, v232, v236
  v_pk_fma_f16 v109, v109, v233, v237
  v_pk_fma_f16 v110, v110, v234, v238
  v_pk_fma_f16 v111, v111, v235, v239
  s_waitcnt lgkmcnt(6)
  v_pk_fma_f16 v112, v112, v176, v180
  v_pk_fma_f16 v113, v113, v177, v181
  v_pk_fma_f16 v114, v114, v178, v182
  v_pk_fma_f16 v115, v115, v179, v183
  s_waitcnt lgkmcnt(4)
  v_pk_fma_f16 v116, v116, v184, v188
  v_pk_fma_f16 v117, v117, v185, v189
  v_pk_fma_f16 v118, v118, v186, v190
  v_pk_fma_f16 v119, v119, v187, v191
  s_waitcnt lgkmcnt(2)
  v_pk_fma_f16 v120, v120, v192, v196
  v_pk_fma_f16 v121, v121, v193, v197
  v_pk_fma_f16 v122, v122, v194, v198
  v_pk_fma_f16 v123, v123, v195, v199
  s_waitcnt lgkmcnt(0)
  v_pk_fma_f16 v124, v124, v200, v204
  v_pk_fma_f16 v125, v125, v201, v205
  v_pk_fma_f16 v126, v126, v202, v206
  v_pk_fma_f16 v127, v127, v203, v207
  v_mul_u32_u24 v14, 15360, v10
  s_waitcnt vmcnt(6)
  s_barrier
  ds_read_b128 v[176:179], v2 offset:0
  ds_read_b128 v[180:183], v2 offset:1024
  ds_read_b128 v[184:187], v2 offset:2048
  ds_read_b128 v[188:191], v2 offset:3072
  ds_read_b128 v[192:195], v2 offset:4096
  ds_read_b128 v[196:199], v2 offset:5120
  ds_read_b128 v[200:203], v2 offset:6144
  ds_read_b128 v[204:207], v2 offset:7168
  s_waitcnt lgkmcnt(7)
  v_mfma_f32_32x32x16_f16 v[128:143], v[176:179], v[16:19], 0
  buffer_load_dwordx4 v[248:251], v2, s[32:35], s49 offen offset:0 sc1
  s_waitcnt lgkmcnt(6)
  v_mfma_f32_32x32x16_f16 v[144:159], v[180:183], v[16:19], 0
  buffer_load_dwordx4 v[252:255], v2, s[32:35], s49 offen offset:1024 sc1
  s_waitcnt lgkmcnt(5)
  v_mfma_f32_32x32x16_f16 v[128:143], v[184:187], v[20:23], v[128:143]
  s_add_u32 m0, s51, 32768
  s_add_u32 s7, s48, s4
  buffer_load_dwordx4 v2, s[32:35], s7 offen sc1 lds
  s_waitcnt lgkmcnt(4)
  v_mfma_f32_32x32x16_f16 v[144:159], v[188:191], v[20:23], v[144:159]
  s_waitcnt vmcnt(7)
  s_barrier
  ds_read_b128 v[208:211], v2 offset:8192
  ds_read_b128 v[212:215], v2 offset:9216
  s_waitcnt lgkmcnt(5)
  v_mfma_f32_32x32x16_f16 v[128:143], v[192:195], v[24:27], v[128:143]
  ds_read_b128 v[216:219], v2 offset:10240
  ds_read_b128 v[220:223], v2 offset:11264
  s_waitcnt lgkmcnt(6)
  v_mfma_f32_32x32x16_f16 v[144:159], v[196:199], v[24:27], v[144:159]
  ds_read_b128 v[224:227], v2 offset:12288
  ds_read_b128 v[228:231], v2 offset:13312
  s_add_u32 m0, s51, 36864
  s_add_u32 s7, s7, 4096
  buffer_load_dwordx4 v2, s[32:35], s7 offen sc1 lds
  s_add_u32 s4, s4, 8192
  s_cmp_eq_u32 s4, 57344
  s_cselect_b32 s4, 0, s4
  s_waitcnt lgkmcnt(7)
  v_mfma_f32_32x32x16_f16 v[128:143], v[200:203], v[28:31], v[128:143]
  ds_read_b128 v[232:235], v2 offset:14336
  s_waitcnt lgkmcnt(7)
  v_mfma_f32_32x32x16_f16 v[144:159], v[204:207], v[28:31], v[144:159]
  ds_read_b128 v[236:239], v2 offset:15360
  s_waitcnt lgkmcnt(7)
  v_mfma_f32_32x32x16_f16 v[128:143], v[208:211], v[32:35], v[128:143]
  s_add_u32 m0, s51, 40960
  s_add_u32 s7, s48, s4
  buffer_load_dwordx4 v2, s[32:35], s7 offen sc1 lds
  s_waitcnt lgkmcnt(6)
  v_mfma_f32_32x32x16_f16 v[144:159], v[212:215], v[32:35], v[144:159]
  s_add_u32 m0, s51, 45056
  s_add_u32 s7, s7, 4096
  buffer_load_dwordx4 v2, s[32:35], s7 offen sc1 lds
  s_add_u32 s4, s4, 8192
  s_cmp_eq_u32 s4, 57344
  s_cselect_b32 s4, 0, s4
  s_waitcnt lgkmcnt(5)
  v_mfma_f32_32x32x16_f16 v[128:143], v[216:219], v[36:39], v[128:143]
  s_add_u32 m0, s51, 49152
  s_add_u32 s7, s48, s4
  buffer_load_dwordx4 v2, s[32:35], s7 offen sc1 lds
  s_waitcnt lgkmcnt(4)
  v_mfma_f32_32x32x16_f16 v[144:159], v[220:223], v[36:39], v[144:159]
  s_waitcnt vmcnt(9)
  s_barrier
  ds_read_b128 v[176:179], v2 offset:16384
  ds_read_b128 v[180:183], v2 offset:17408
  s_waitcnt lgkmcnt(5)
  v_mfma_f32_32x32x16_f16 v[128:143], v[224:227], v[40:43], v[128:143]
  ds_read_b128 v[184:187], v2 offset:18432
  ds_read_b128 v[188:191], v2 offset:19456
  s_waitcnt lgkmcnt(6)
  v_mfma_f32_32x32x16_f16 v[144:159], v[228:231], v[40:43], v[144:159]
  ds_read_b128 v[192:195], v2 offset:20480
  ds_read_b128 v[196:199], v2 offset:21504
  s_add_u32 m0, s51, 53248
  s_add_u32 s7, s7, 4096
  buffer_load_dwordx4 v2, s[32:35], s7 offen sc1 lds
  s_waitcnt lgkmcnt(7)
  v_mfma_f32_32x32x16_f16 v[128:143], v[232:235], v[44:47], v[128:143]
  ds_read_b128 v[200:203], v2 offset:22528
  s_waitcnt lgkmcnt(7)
  v_mfma_f32_32x32x16_f16 v[144:159], v[236:239], v[44:47], v[144:159]
  ds_read_b128 v[204:207], v2 offset:23552
  s_waitcnt lgkmcnt(7)
  v_mfma_f32_32x32x16_f16 v[128:143], v[176:179], v[48:51], v[128:143]
  buffer_load_dword v9, v15, s[32:35], s47 offen sc1
  s_waitcnt lgkmcnt(6)
  v_mfma_f32_32x32x16_f16 v[144:159], v[180:183], v[48:51], v[144:159]
  s_add_u32 m0, s51, 57344
  s_add_u32 s54, s8, s5
  buffer_load_dwordx4 v2, s[32:35], s54 offen sc1 lds
  s_add_u32 s5, s5, 4096
  s_cmp_eq_u32 s5, 28672
  s_cselect_b32 s5, 0, s5
  s_waitcnt lgkmcnt(5)
  v_mfma_f32_32x32x16_f16 v[128:143], v[184:187], v[52:55], v[128:143]
  s_add_u32 m0, s51, 61440
  s_add_u32 s54, s8, s5
  buffer_load_dwordx4 v2, s[32:35], s54 offen sc1 lds
  s_add_u32 s5, s5, 4096
  s_cmp_eq_u32 s5, 28672
  s_cselect_b32 s5, 0, s5
  s_waitcnt lgkmcnt(4)
  v_mfma_f32_32x32x16_f16 v[144:159], v[188:191], v[52:55], v[144:159]
  s_waitcnt vmcnt(11)
  s_barrier
  ds_read_b128 v[208:211], v2 offset:24576
  ds_read_b128 v[212:215], v2 offset:25600
  s_waitcnt lgkmcnt(5)
  v_mfma_f32_32x32x16_f16 v[128:143], v[192:195], v[56:59], v[128:143]
  ds_read_b128 v[216:219], v2 offset:26624
  ds_read_b128 v[220:223], v2 offset:27648
  s_waitcnt lgkmcnt(6)
  v_mfma_f32_32x32x16_f16 v[144:159], v[196:199], v[56:59], v[144:159]
  ds_read_b128 v[224:227], v2 offset:28672
  ds_read_b128 v[228:231], v2 offset:29696
  s_add_u32 m0, s51, 65536
  s_add_u32 s54, s8, s5
  buffer_load_dwordx4 v2, s[32:35], s54 offen sc1 lds
  s_add_u32 s5, s5, 4096
  s_cmp_eq_u32 s5, 28672
  s_cselect_b32 s5, 0, s5
  s_waitcnt lgkmcnt(7)
  v_mfma_f32_32x32x16_f16 v[128:143], v[200:203], v[60:63], v[128:143]
  ds_read_b128 v[232:235], v2 offset:30720
  s_waitcnt lgkmcnt(7)
  v_mfma_f32_32x32x16_f16 v[144:159], v[204:207], v[60:63], v[144:159]
  ds_read_b128 v[236:239], v2 offset:31744
  s_waitcnt lgkmcnt(7)
  v_mfma_f32_32x32x16_f16 v[128:143], v[208:211], v[64:67], v[128:143]
  s_add_u32 m0, s51, 69632
  s_add_u32 s54, s8, s5
  buffer_load_dwordx4 v2, s[32:35], s54 offen sc1 lds
  s_add_u32 s5, s5, 4096
  s_cmp_eq_u32 s5, 28672
  s_cselect_b32 s5, 0, s5
  s_waitcnt lgkmcnt(6)
  v_mfma_f32_32x32x16_f16 v[144:159], v[212:215], v[64:67], v[144:159]
  s_add_u32 m0, s51, 73728
  s_add_u32 s54, s8, s5
  buffer_load_dwordx4 v2, s[32:35], s54 offen sc1 lds
  s_add_u32 s5, s5, 4096
  s_cmp_eq_u32 s5, 28672
  s_cselect_b32 s5, 0, s5
  s_waitcnt lgkmcnt(5)
  v_mfma_f32_32x32x16_f16 v[128:143], v[216:219], v[68:71], v[128:143]
  s_add_u32 m0, s51, 77824
  s_add_u32 s54, s8, s5
  buffer_load_dwordx4 v2, s[32:35], s54 offen sc1 lds
  s_add_u32 s5, s5, 4096
  s_cmp_eq_u32 s5, 28672
  s_cselect_b32 s5, 0, s5
  s_waitcnt lgkmcnt(4)
  v_mfma_f32_32x32x16_f16 v[144:159], v[220:223], v[68:71], v[144:159]
  s_waitcnt vmcnt(11)
  s_barrier
  ds_read_b128 v[176:179], v2 offset:32768
  ds_read_b128 v[180:183], v2 offset:33792
  s_waitcnt lgkmcnt(5)
  v_mfma_f32_32x32x16_f16 v[128:143], v[224:227], v[72:75], v[128:143]
  ds_read_b128 v[184:187], v2 offset:34816
  ds_read_b128 v[188:191], v2 offset:35840
  s_waitcnt lgkmcnt(6)
  v_mfma_f32_32x32x16_f16 v[144:159], v[228:231], v[72:75], v[144:159]
  ds_read_b128 v[192:195], v2 offset:36864
  ds_read_b128 v[196:199], v2 offset:37888
  s_add_u32 m0, s51, 81920
  s_add_u32 s54, s8, s5
  buffer_load_dwordx4 v2, s[32:35], s54 offen sc1 lds
  s_waitcnt lgkmcnt(7)
  v_mfma_f32_32x32x16_f16 v[128:143], v[232:235], v[76:79], v[128:143]
  ds_read_b128 v[200:203], v2 offset:38912
  s_waitcnt lgkmcnt(7)
  v_mfma_f32_32x32x16_f16 v[144:159], v[236:239], v[76:79], v[144:159]
  ds_read_b128 v[204:207], v2 offset:39936
  s_waitcnt lgkmcnt(7)
  v_mfma_f32_32x32x16_f16 v[128:143], v[176:179], v[80:83], v[128:143]
  buffer_store_dwordx4 v[240:243], v2, s[32:35], s63 offen offset:0 sc1
  s_waitcnt lgkmcnt(6)
  v_mfma_f32_32x32x16_f16 v[144:159], v[180:183], v[80:83], v[144:159]
  buffer_store_dwordx4 v[244:247], v2, s[32:35], s63 offen offset:1024 sc1
  s_waitcnt lgkmcnt(5)
  v_mfma_f32_32x32x16_f16 v[128:143], v[184:187], v[84:87], v[128:143]
  buffer_store_dwordx4 v[160:163], v2, s[32:35], s66 offen offset:0 sc1
  s_add_u32 s66, s66, 28672
  s_waitcnt lgkmcnt(4)
  v_mfma_f32_32x32x16_f16 v[144:159], v[188:191], v[84:87], v[144:159]
  s_waitcnt vmcnt(13)
  s_barrier
  ds_read_b128 v[208:211], v2 offset:40960
  ds_read_b128 v[212:215], v2 offset:41984
  s_waitcnt lgkmcnt(5)
  v_mfma_f32_32x32x16_f16 v[128:143], v[192:195], v[88:91], v[128:143]
  ds_read_b128 v[216:219], v2 offset:43008
  ds_read_b128 v[220:223], v2 offset:44032
  s_waitcnt lgkmcnt(6)
  v_mfma_f32_32x32x16_f16 v[144:159], v[196:199], v[88:91], v[144:159]
  ds_read_b128 v[224:227], v2 offset:45056
  ds_read_b128 v[228:231], v2 offset:46080
  buffer_store_dwordx4 v[164:167], v2, s[32:35], s66 offen offset:0 sc1
  s_add_u32 s66, s66, 28672
  s_waitcnt lgkmcnt(7)
  v_mfma_f32_32x32x16_f16 v[128:143], v[200:203], v[92:95], v[128:143]
  ds_read_b128 v[232:235], v2 offset:47104
  s_waitcnt lgkmcnt(7)
  v_mfma_f32_32x32x16_f16 v[144:159], v[204:207], v[92:95], v[144:159]
  ds_read_b128 v[236:239], v2 offset:48128
  s_waitcnt lgkmcnt(7)
  v_mfma_f32_32x32x16_f16 v[128:143], v[208:211], v[96:99], v[128:143]
  buffer_store_dwordx4 v[168:171], v2, s[32:35], s66 offen offset:0 sc1
  s_waitcnt lgkmcnt(6)
  v_mfma_f32_32x32x16_f16 v[144:159], v[212:215], v[96:99], v[144:159]
  buffer_store_dwordx4 v[172:175], v2, s[32:35], s67 offen offset:0 sc1
  s_waitcnt lgkmcnt(5)
  v_mfma_f32_32x32x16_f16 v[128:143], v[216:219], v[100:103], v[128:143]
  s_waitcnt lgkmcnt(4)
  v_mfma_f32_32x32x16_f16 v[144:159], v[220:223], v[100:103], v[144:159]
  s_waitcnt vmcnt(14)
  s_barrier
  ds_read_b128 v[176:179], v2 offset:49152
  ds_read_b128 v[180:183], v2 offset:50176
  s_waitcnt lgkmcnt(5)
  v_mfma_f32_32x32x16_f16 v[128:143], v[224:227], v[104:107], v[128:143]
  ds_read_b128 v[184:187], v2 offset:51200
  ds_read_b128 v[188:191], v2 offset:52224
  s_waitcnt lgkmcnt(6)
  v_mfma_f32_32x32x16_f16 v[144:159], v[228:231], v[104:107], v[144:159]
  ds_read_b128 v[192:195], v2 offset:53248
  ds_read_b128 v[196:199], v2 offset:54272
  s_waitcnt lgkmcnt(7)
  v_mfma_f32_32x32x16_f16 v[128:143], v[232:235], v[108:111], v[128:143]
  ds_read_b128 v[200:203], v2 offset:55296
  s_waitcnt lgkmcnt(7)
  v_mfma_f32_32x32x16_f16 v[144:159], v[236:239], v[108:111], v[144:159]
  ds_read_b128 v[204:207], v2 offset:56320
  s_waitcnt lgkmcnt(7)
  v_mfma_f32_32x32x16_f16 v[128:143], v[176:179], v[112:115], v[128:143]
  s_waitcnt lgkmcnt(6)
  v_mfma_f32_32x32x16_f16 v[144:159], v[180:183], v[112:115], v[144:159]
  s_waitcnt lgkmcnt(5)
  v_mfma_f32_32x32x16_f16 v[128:143], v[184:187], v[116:119], v[128:143]
  s_waitcnt vmcnt(13)
  v_cmp_eq_u32 vcc, s69, v9
  s_cmp_eq_u64 vcc, -1
  s_cbranch_scc0 .Lwfslow21
.Lwfback22:
  s_waitcnt lgkmcnt(4)
  v_mfma_f32_32x32x16_f16 v[144:159], v[188:191], v[116:119], v[144:159]
  s_waitcnt lgkmcnt(3)
  v_mfma_f32_32x32x16_f16 v[128:143], v[192:195], v[120:123], v[128:143]
  s_waitcnt lgkmcnt(2)
  v_mfma_f32_32x32x16_f16 v[144:159], v[196:199], v[120:123], v[144:159]
  s_waitcnt lgkmcnt(1)
  v_mfma_f32_32x32x16_f16 v[128:143], v[200:203], v[124:127], v[128:143]
  s_waitcnt lgkmcnt(0)
  v_mfma_f32_32x32x16_f16 v[144:159], v[204:207], v[124:127], v[144:159]
  s_nop 9
  v_cvt_pk_bf16_f32 v208, v128, v129
  v_cvt_pk_bf16_f32 v209, v130, v131
  v_cvt_pk_bf16_f32 v210, v132, v133
  v_cvt_pk_bf16_f32 v211, v134, v135
  v_cvt_pk_bf16_f32 v212, v136, v137
  v_cvt_pk_bf16_f32 v213, v138, v139
  v_cvt_pk_bf16_f32 v214, v140, v141
  v_cvt_pk_bf16_f32 v215, v142, v143
  v_mfma_f32_32x32x16_bf16 v[176:191], v[248:251], v[208:211], 0
  s_nop 0
  v_mfma_f32_32x32x16_bf16 v[176:191], v[252:255], v[212:215], v[176:191]
  v_cvt_pk_f16_f32 v232, v144, v145
  v_cvt_pk_f16_f32 v233, v146, v147
  v_cvt_pk_f16_f32 v234, v148, v149
  v_cvt_pk_f16_f32 v235, v150, v151
  v_cvt_pk_f16_f32 v236, v152, v153
  v_cvt_pk_f16_f32 v237, v154, v155
  v_cvt_pk_f16_f32 v238, v156, v157
  v_cvt_pk_f16_f32 v239, v158, v159
  v_or_b32 v238, v238, v14
  ds_write_b128 v11, v[232:235] offset:128
  ds_write_b128 v11, v[236:239] offset:160
  s_lshl_b32 s54, s45, 2
  s_add_u32 s54, s54, s3
  s_lshl_b32 s47, s54, 14
  s_add_u32 s47, s47, 0x80000
  s_lshl_b32 s49, s44, 10
  s_add_u32 s49, s49, s47
  s_lshl_b32 s58, s54, 7
  s_add_u32 s58, s58, 0x10000
  s_lshl_b32 s57, s44, 2
  s_add_u32 s57, s57, s58
  v_max3_f32 v240, v176, v177, v178
  v_max3_f32 v241, -v176, -v177, -v178
  v_max3_f32 v240, v240, v179, v180
  v_max3_f32 v241, v241, -v179, -v180
  v_max3_f32 v240, v240, v181, v182
  v_max3_f32 v241, v241, -v181, -v182
  v_max3_f32 v240, v240, v183, v184
  v_max3_f32 v241, v241, -v183, -v184
  v_max3_f32 v240, v240, v185, v186
  v_max3_f32 v241, v241, -v185, -v186
  v_max3_f32 v240, v240, v187, v188
  v_max3_f32 v241, v241, -v187, -v188
  buffer_load_dwordx4 a[0:3], v2, s[32:35], s52 offen offset:0 sc1
  v_max_f32 v240, v240, v189
  v_max_f32_e64 v241, v241, -v189
  s_nop 1
  v_permlane32_swap_b32 v240, v241
  v_max_f32 v240, v240, v241
  v_mul_f32 v240, s60, v240
  v_mov_b32 v241, v240
  s_nop 1
  v_permlane32_swap_b32 v240, v241
  v_fma_f32 v192, -v176, s60, -v241
  v_fma_f32 v176, v176, s60, -v240
  v_fma_f32 v193, -v177, s60, -v241
  v_fma_f32 v177, v177, s60, -v240
  v_fma_f32 v194, -v178, s60, -v241
  buffer_load_dwordx4 a[4:7], v2, s[32:35], s52 offen offset:1024 sc1
  v_fma_f32 v178, v178, s60, -v240
  v_fma_f32 v195, -v179, s60, -v241
  v_fma_f32 v179, v179, s60, -v240
  v_fma_f32 v196, -v180, s60, -v241
  v_fma_f32 v180, v180, s60, -v240
  v_fma_f32 v197, -v181, s60, -v241
  v_fma_f32 v181, v181, s60, -v240
  v_fma_f32 v198, -v182, s60, -v241
  v_fma_f32 v182, v182, s60, -v240
  v_fma_f32 v199, -v183, s60, -v241
  v_fma_f32 v183, v183, s60, -v240
  v_fma_f32 v200, -v184, s60, -v241
  buffer_load_dwordx4 a[8:11], v2, s[32:35], s52 offen offset:2048 sc1
  v_fma_f32 v184, v184, s60, -v240
  v_fma_f32 v201, -v185, s60, -v241
  v_fma_f32 v185, v185, s60, -v240
  v_fma_f32 v202, -v186, s60, -v241
  v_fma_f32 v186, v186, s60, -v240
  v_fma_f32 v203, -v187, s60, -v241
  v_fma_f32 v187, v187, s60, -v240
  v_fma_f32 v204, -v188, s60, -v241
  v_fma_f32 v188, v188, s60, -v240
  v_fma_f32 v205, -v189, s60, -v241
  v_fma_f32 v189, v189, s60, -v240
  v_exp_f32 v192, v192
  buffer_load_dwordx4 a[12:15], v2, s[32:35], s52 offen offset:3072 sc1
  v_exp_f32 v176, v176
  v_exp_f32 v193, v193
  v_exp_f32 v177, v177
  v_exp_f32 v194, v194
  v_exp_f32 v178, v178
  v_exp_f32 v195, v195
  v_exp_f32 v179, v179
  v_exp_f32 v196, v196
  v_exp_f32 v180, v180
  v_exp_f32 v197, v197
  v_exp_f32 v181, v181
  v_exp_f32 v198, v198
  s_add_u32 s63, s52, 4096
  buffer_load_dwordx4 a[16:19], v2, s[32:35], s63 offen offset:0 sc1
  v_exp_f32 v182, v182
  v_exp_f32 v199, v199
  v_exp_f32 v183, v183
  v_exp_f32 v200, v200
  v_exp_f32 v184, v184
  v_exp_f32 v201, v201
  v_exp_f32 v185, v185
  v_exp_f32 v202, v202
  v_exp_f32 v186, v186
  v_exp_f32 v203, v203
  v_exp_f32 v187, v187
  v_exp_f32 v204, v204
  buffer_load_dwordx4 a[20:23], v2, s[32:35], s63 offen offset:1024 sc1
  v_exp_f32 v188, v188
  v_exp_f32 v205, v205
  v_exp_f32 v189, v189
  v_add_f32 v240, v176, v177
  v_add_f32 v241, v192, v193
  v_add_f32 v208, v178, v179
  v_add_f32 v209, v194, v195
  v_add_f32 v240, v240, v180
  v_add_f32 v241, v241, v196
  v_add_f32 v208, v208, v181
  v_add_f32 v209, v209, v197
  v_add_f32 v240, v240, v182
  buffer_load_dwordx4 a[24:27], v2, s[32:35], s63 offen offset:2048 sc1
  v_add_f32 v241, v241, v198
  v_add_f32 v208, v208, v183
  v_add_f32 v209, v209, v199
  v_add_f32 v240, v240, v184
  v_add_f32 v241, v241, v200
  v_add_f32 v208, v208, v185
  v_add_f32 v209, v209, v201
  v_add_f32 v240, v240, v186
  v_add_f32 v241, v241, v202
  v_add_f32 v208, v208, v187
  v_add_f32 v209, v209, v203
  v_add_f32 v240, v240, v188
  buffer_load_dwordx4 a[28:31], v2, s[32:35], s63 offen offset:3072 sc1
  v_add_f32 v241, v241, v204
  v_add_f32 v208, v208, v189
  v_add_f32 v209, v209, v205
  v_add_f32 v240, v240, v208
  v_add_f32 v241, v241, v209
  s_nop 1
  v_permlane32_swap_b32 v240, v241
  v_cvt_pk_f16_f32 v224, v192, v193
  v_cvt_pk_f16_f32 v225, v194, v195
  v_cvt_pk_f16_f32 v226, v196, v197
  v_add_f32 v240, v240, v241
  v_mul_f32 v240, 0x41800000, v240
  v_rcp_f32 v240, v240
  v_cvt_pk_f16_f32 v216, v176, v177
  v_cvt_pk_f16_f32 v217, v178, v179
  v_cvt_pk_f16_f32 v218, v180, v181
  v_cvt_pk_f16_f32 v240, v240, v240
  v_mov_b32 v241, v240
  v_cvt_pk_f16_f32 v219, v182, v183
  v_cvt_pk_f16_f32 v220, v184, v185
  v_cvt_pk_f16_f32 v221, v186, v187
  v_cvt_pk_f16_f32 v222, v188, v189
  v_permlane32_swap_b32 v240, v241
  v_cvt_pk_f16_f32 v227, v198, v199
  v_cvt_pk_f16_f32 v228, v200, v201
  v_cvt_pk_f16_f32 v229, v202, v203
  v_cvt_pk_f16_f32 v230, v204, v205
  v_pk_mul_f16 v216, v216, v240
  v_pk_mul_f16 v217, v217, v240
  v_pk_mul_f16 v218, v218, v240
  v_pk_mul_f16 v219, v219, v240
  v_pk_mul_f16 v220, v220, v240
  v_pk_mul_f16 v221, v221, v240
  v_pk_mul_f16 v222, v222, v240
  v_mov_b32 v223, 0
  ds_write_b128 v11, v[216:219]
  ds_write_b128 v11, v[220:223] offset:32
  v_pk_mul_f16 v224, v224, v241
  v_pk_mul_f16 v225, v225, v241
  v_pk_mul_f16 v226, v226, v241
  v_pk_mul_f16 v227, v227, v241
  v_pk_mul_f16 v228, v228, v241
  v_pk_mul_f16 v229, v229, v241
  v_pk_mul_f16 v230, v230, v241
  v_mov_b32 v231, 0
  ds_write_b128 v11, v[224:227] offset:64
  ds_write_b128 v11, v[228:231] offset:96
  s_waitcnt vmcnt(14)
  s_waitcnt lgkmcnt(0)
  s_barrier
  ds_read_b64_tr_b16 v[176:177], v12 offset:0
  ds_read_b64_tr_b16 v[178:179], v12 offset:3584
  ds_read_b64_tr_b16 v[192:193], v13 offset:0
  ds_read_b64_tr_b16 v[194:195], v13 offset:3584
  ds_read_b64_tr_b16 v[208:209], v13 offset:32
  ds_read_b64_tr_b16 v[210:211], v13 offset:3616
  ds_read_b64_tr_b16 v[180:181], v12 offset:7168
  ds_read_b64_tr_b16 v[182:183], v12 offset:10752
  ds_read_b64_tr_b16 v[196:197], v13 offset:7168
  ds_read_b64_tr_b16 v[198:199], v13 offset:10752
  ds_read_b64_tr_b16 v[212:213], v13 offset:7200
  ds_read_b64_tr_b16 v[214:215], v13 offset:10784
  ds_read_b64_tr_b16 v[184:185], v12 offset:14336
  ds_read_b64_tr_b16 v[186:187], v12 offset:17920
  ds_read_b64_tr_b16 v[200:201], v13 offset:14336
  ds_read_b64_tr_b16 v[202:203], v13 offset:17920
  ds_read_b64_tr_b16 v[216:217], v13 offset:14368
  ds_read_b64_tr_b16 v[218:219], v13 offset:17952
  ds_read_b64_tr_b16 v[188:189], v12 offset:21504
  ds_read_b64_tr_b16 v[190:191], v12 offset:25088
  ds_read_b64_tr_b16 v[204:205], v13 offset:21504
  ds_read_b64_tr_b16 v[206:207], v13 offset:25088
  ds_read_b64_tr_b16 v[220:221], v13 offset:21536
  ds_read_b64_tr_b16 v[222:223], v13 offset:25120
  s_waitcnt lgkmcnt(15)
  v_mfma_f32_16x16x32_f16 v[128:131], v[176:179], v[192:195], 0
  v_mfma_f32_16x16x32_f16 v[132:135], v[176:179], v[208:211], 0
  ds_read_b128 v[224:227], v2 offset:57344
  s_waitcnt lgkmcnt(15)
  v_mfma_f32_16x16x32_f16 v[128:131], v[180:183], v[196:199], v[128:131]
  s_waitcnt lgkmcnt(13)
  v_mfma_f32_16x16x32_f16 v[132:135], v[180:183], v[212:215], v[132:135]
  ds_read_b128 v[228:231], v2 offset:58368
  s_waitcnt lgkmcnt(10)
  v_mfma_f32_16x16x32_f16 v[128:131], v[184:187], v[200:203], v[128:131]
  s_waitcnt lgkmcnt(8)
  v_mfma_f32_16x16x32_f16 v[132:135], v[184:187], v[216:219], v[132:135]
  ds_read_b128 v[232:235], v2 offset:59392
  s_waitcnt lgkmcnt(5)
  v_mfma_f32_16x16x32_f16 v[128:131], v[188:191], v[204:207], v[128:131]
  s_waitcnt lgkmcnt(3)
  v_mfma_f32_16x16x32_f16 v[132:135], v[188:191], v[220:223], v[132:135]
  ds_read_b128 v[236:239], v2 offset:60416
  s_waitcnt lgkmcnt(3)
  v_mfma_f32_32x32x16_f16 v[160:175], v[224:227], v[16:19], 0
  s_nop 2
  v_cvt_pk_f16_f32 v136, v128, v129
  v_cvt_pk_f16_f32 v137, v130, v131
  v_cvt_pk_f16_f32 v138, v132, v133
  v_cvt_pk_f16_f32 v139, v134, v135
  buffer_store_dwordx4 v[136:139], v2, s[32:35], s49 offen sc1
  ds_read_b128 v[240:243], v2 offset:61440
  s_waitcnt lgkmcnt(3)
  v_mfma_f32_32x32x16_f16 v[160:175], v[228:231], v[20:23], v[160:175]
  ds_read_b128 v[244:247], v2 offset:62464
  s_waitcnt lgkmcnt(3)
  v_mfma_f32_32x32x16_f16 v[160:175], v[232:235], v[24:27], v[160:175]
  ds_read_b128 v[224:227], v2 offset:63488
  s_waitcnt lgkmcnt(3)
  v_mfma_f32_32x32x16_f16 v[160:175], v[236:239], v[28:31], v[160:175]
  ds_read_b128 v[228:231], v2 offset:64512
  s_waitcnt lgkmcnt(3)
  v_mfma_f32_32x32x16_f16 v[160:175], v[240:243], v[32:35], v[160:175]
  ds_read_b128 v[232:235], v3 offset:0
  s_waitcnt lgkmcnt(3)
  v_mfma_f32_32x32x16_f16 v[160:175], v[244:247], v[36:39], v[160:175]
  ds_read_b128 v[236:239], v3 offset:1024
  s_waitcnt lgkmcnt(3)
  v_mfma_f32_32x32x16_f16 v[160:175], v[224:227], v[40:43], v[160:175]
  ds_read_b128 v[240:243], v3 offset:2048
  s_waitcnt lgkmcnt(3)
  v_mfma_f32_32x32x16_f16 v[160:175], v[228:231], v[44:47], v[160:175]
  ds_read_b128 v[244:247], v3 offset:3072
  s_waitcnt lgkmcnt(3)
  v_mfma_f32_32x32x16_f16 v[160:175], v[232:235], v[48:51], v[160:175]
  ds_read_b128 v[224:227], v3 offset:4096
  s_waitcnt lgkmcnt(3)
  v_mfma_f32_32x32x16_f16 v[160:175], v[236:239], v[52:55], v[160:175]
  ds_read_b128 v[228:231], v3 offset:5120
  s_waitcnt lgkmcnt(3)
  v_mfma_f32_32x32x16_f16 v[160:175], v[240:243], v[56:59], v[160:175]
  ds_read_b128 v[232:235], v3 offset:6144
  s_waitcnt lgkmcnt(3)
  v_mfma_f32_32x32x16_f16 v[160:175], v[244:247], v[60:63], v[160:175]
  ds_read_b128 v[236:239], v3 offset:7168
  s_waitcnt lgkmcnt(3)
  v_mfma_f32_32x32x16_f16 v[160:175], v[224:227], v[64:67], v[160:175]
  ds_read_b128 v[240:243], v3 offset:8192
  s_waitcnt lgkmcnt(3)
  v_mfma_f32_32x32x16_f16 v[160:175], v[228:231], v[68:71], v[160:175]
  ds_read_b128 v[244:247], v3 offset:9216
  s_waitcnt lgkmcnt(3)
  v_mfma_f32_32x32x16_f16 v[160:175], v[232:235], v[72:75], v[160:175]
  ds_read_b128 v[224:227], v3 offset:10240
  s_waitcnt lgkmcnt(3)
  v_mfma_f32_32x32x16_f16 v[160:175], v[236:239], v[76:79], v[160:175]
  ds_read_b128 v[228:231], v3 offset:11264
  s_waitcnt lgkmcnt(3)
  v_mfma_f32_32x32x16_f16 v[160:175], v[240:243], v[80:83], v[160:175]
  ds_read_b128 v[232:235], v3 offset:12288
  s_waitcnt lgkmcnt(3)
  v_mfma_f32_32x32x16_f16 v[160:175], v[244:247], v[84:87], v[160:175]
  ds_read_b128 v[236:239], v3 offset:13312
  s_waitcnt lgkmcnt(3)
  v_mfma_f32_32x32x16_f16 v[160:175], v[224:227], v[88:91], v[160:175]
  ds_read_b128 v[240:243], v3 offset:14336
  s_waitcnt lgkmcnt(3)
  v_mfma_f32_32x32x16_f16 v[160:175], v[228:231], v[92:95], v[160:175]
  ds_read_b128 v[244:247], v3 offset:15360
  s_waitcnt lgkmcnt(3)
  v_mfma_f32_32x32x16_f16 v[160:175], v[232:235], v[96:99], v[160:175]
  ds_read_b128 v[224:227], v3 offset:16384
  s_waitcnt lgkmcnt(3)
  v_mfma_f32_32x32x16_f16 v[160:175], v[236:239], v[100:103], v[160:175]
  ds_read_b128 v[228:231], v3 offset:17408
  s_waitcnt lgkmcnt(3)
  v_mfma_f32_32x32x16_f16 v[160:175], v[240:243], v[104:107], v[160:175]
  ds_read_b128 v[232:235], v3 offset:18432
  s_waitcnt vmcnt(0)
  buffer_store_dword v8, v6, s[32:35], s57 offen sc1
  s_waitcnt lgkmcnt(3)
  v_mfma_f32_32x32x16_f16 v[160:175], v[244:247], v[108:111], v[160:175]
  ds_read_b128 v[236:239], v3 offset:19456
  s_add_u32 s63, s52, 8192
  buffer_load_dwordx4 a[32:35], v2, s[32:35], s63 offen offset:0 sc1
  s_waitcnt lgkmcnt(3)
  v_mfma_f32_32x32x16_f16 v[160:175], v[224:227], v[112:115], v[160:175]
  buffer_load_dwordx4 a[36:39], v2, s[32:35], s63 offen offset:1024 sc1
  s_waitcnt lgkmcnt(2)
  v_mfma_f32_32x32x16_f16 v[160:175], v[228:231], v[116:119], v[160:175]
  buffer_load_dwordx4 a[40:43], v2, s[32:35], s63 offen offset:2048 sc1
  s_waitcnt lgkmcnt(1)
  v_mfma_f32_32x32x16_f16 v[160:175], v[232:235], v[120:123], v[160:175]
  buffer_load_dwordx4 a[44:47], v2, s[32:35], s63 offen offset:3072 sc1
  s_waitcnt lgkmcnt(0)
  v_mfma_f32_32x32x16_f16 v[160:175], v[236:239], v[124:127], v[160:175]
  s_add_u32 s63, s52, 12288
  buffer_load_dwordx4 a[48:51], v2, s[32:35], s63 offen offset:0 sc1
  s_nop 9
  v_cvt_pk_bf16_f32 v208, v160, v161
  v_cvt_pk_bf16_f32 v209, v162, v163
  v_cvt_pk_bf16_f32 v210, v164, v165
  v_cvt_pk_bf16_f32 v211, v166, v167
  v_cvt_pk_bf16_f32 v212, v168, v169
  v_cvt_pk_bf16_f32 v213, v170, v171
  v_cvt_pk_bf16_f32 v214, v172, v173
  v_cvt_pk_bf16_f32 v215, v174, v175
  v_mfma_f32_32x32x16_bf16 v[176:191], v[248:251], v[208:211], 0
  s_nop 0
  v_mfma_f32_32x32x16_bf16 v[176:191], v[252:255], v[212:215], v[176:191]
  s_nop 11
  v_max3_f32 v240, v176, v177, v178
  v_max3_f32 v241, -v176, -v177, -v178
  v_max3_f32 v240, v240, v179, v180
  v_max3_f32 v241, v241, -v179, -v180
  v_max3_f32 v240, v240, v181, v182
  v_max3_f32 v241, v241, -v181, -v182
  buffer_load_dwordx4 a[52:55], v2, s[32:35], s63 offen offset:1024 sc1
  v_max3_f32 v240, v240, v183, v184
  v_max3_f32 v241, v241, -v183, -v184
  v_max3_f32 v240, v240, v185, v186
  v_max3_f32 v241, v241, -v185, -v186
  v_max3_f32 v240, v240, v187, v188
  v_max3_f32 v241, v241, -v187, -v188
  buffer_load_dwordx4 a[56:59], v2, s[32:35], s63 offen offset:2048 sc1
  v_max_f32 v240, v240, v189
  v_max_f32_e64 v241, v241, -v189
  s_nop 1
  v_permlane32_swap_b32 v240, v241
  v_max_f32 v240, v240, v241
  v_mul_f32 v240, s60, v240
  v_mov_b32 v241, v240
  buffer_load_dwordx4 a[60:63], v2, s[32:35], s63 offen offset:3072 sc1
  s_nop 0
  v_permlane32_swap_b32 v240, v241
  v_fma_f32 v192, -v176, s60, -v241
  v_fma_f32 v176, v176, s60, -v240
  v_fma_f32 v193, -v177, s60, -v241
  v_fma_f32 v177, v177, s60, -v240
  v_fma_f32 v194, -v178, s60, -v241
  s_add_u32 s63, s52, 16384
  buffer_load_dwordx4 a[64:67], v2, s[32:35], s63 offen offset:0 sc1
  v_fma_f32 v178, v178, s60, -v240
  v_fma_f32 v195, -v179, s60, -v241
  v_fma_f32 v179, v179, s60, -v240
  v_fma_f32 v196, -v180, s60, -v241
  v_fma_f32 v180, v180, s60, -v240
  v_fma_f32 v197, -v181, s60, -v241
  buffer_load_dwordx4 a[68:71], v2, s[32:35], s63 offen offset:1024 sc1
  v_fma_f32 v181, v181, s60, -v240
  v_fma_f32 v198, -v182, s60, -v241
  v_fma_f32 v182, v182, s60, -v240
  v_fma_f32 v199, -v183, s60, -v241
  v_fma_f32 v183, v183, s60, -v240
  v_fma_f32 v200, -v184, s60, -v241
  buffer_load_dwordx4 a[72:75], v2, s[32:35], s63 offen offset:2048 sc1
  v_fma_f32 v184, v184, s60, -v240
  v_fma_f32 v201, -v185, s60, -v241
  v_fma_f32 v185, v185, s60, -v240
  v_fma_f32 v202, -v186, s60, -v241
  v_fma_f32 v186, v186, s60, -v240
  v_fma_f32 v203, -v187, s60, -v241
  buffer_load_dwordx4 a[76:79], v2, s[32:35], s63 offen offset:3072 sc1
  v_fma_f32 v187, v187, s60, -v240
  v_fma_f32 v204, -v188, s60, -v241
  v_fma_f32 v188, v188, s60, -v240
  v_fma_f32 v205, -v189, s60, -v241
  v_fma_f32 v189, v189, s60, -v240
  v_exp_f32 v192, v192
  s_add_u32 s63, s52, 20480
  buffer_load_dwordx4 a[80:83], v2, s[32:35], s63 offen offset:0 sc1
  v_exp_f32 v176, v176
  v_exp_f32 v193, v193
  v_exp_f32 v177, v177
  v_exp_f32 v194, v194
  v_exp_f32 v178, v178
  v_exp_f32 v195, v195
  buffer_load_dwordx4 a[84:87], v2, s[32:35], s63 offen offset:1024 sc1
  v_exp_f32 v179, v179
  v_exp_f32 v196, v196
  v_exp_f32 v180, v180
  v_exp_f32 v197, v197
  v_exp_f32 v181, v181
  v_exp_f32 v198, v198
  buffer_load_dwordx4 a[88:91], v2, s[32:35], s63 offen offset:2048 sc1
  v_exp_f32 v182, v182
  v_exp_f32 v199, v199
  v_exp_f32 v183, v183
  v_exp_f32 v200, v200
  v_exp_f32 v184, v184
  v_exp_f32 v201, v201
  buffer_load_dwordx4 a[92:95], v2, s[32:35], s63 offen offset:3072 sc1
  v_exp_f32 v185, v185
  v_exp_f32 v202, v202
  v_exp_f32 v186, v186
  v_exp_f32 v203, v203
  v_exp_f32 v187, v187
  v_exp_f32 v204, v204
  s_add_u32 s63, s52, 24576
  buffer_load_dwordx4 a[96:99], v2, s[32:35], s63 offen offset:0 sc1
  v_exp_f32 v188, v188
  v_exp_f32 v205, v205
  v_exp_f32 v189, v189
  v_add_f32 v240, v176, v177
  v_add_f32 v241, v192, v193
  v_add_f32 v208, v178, v179
  buffer_load_dwordx4 a[100:103], v2, s[32:35], s63 offen offset:1024 sc1
  v_add_f32 v209, v194, v195
  v_add_f32 v240, v240, v180
  v_add_f32 v241, v241, v196
  v_add_f32 v208, v208, v181
  v_add_f32 v209, v209, v197
  v_add_f32 v240, v240, v182
  buffer_load_dwordx4 a[104:107], v2, s[32:35], s63 offen offset:2048 sc1
  v_add_f32 v241, v241, v198
  v_add_f32 v208, v208, v183
  v_add_f32 v209, v209, v199
  v_add_f32 v240, v240, v184
  v_add_f32 v241, v241, v200
  v_add_f32 v208, v208, v185
  buffer_load_dwordx4 a[108:111], v2, s[32:35], s63 offen offset:3072 sc1
  v_add_f32 v209, v209, v201
  v_add_f32 v240, v240, v186
  v_add_f32 v241, v241, v202
  v_add_f32 v208, v208, v187
  v_add_f32 v209, v209, v203
  v_add_f32 v240, v240, v188
  s_add_u32 s63, s52, 28672
  buffer_load_dwordx4 a[112:115], v2, s[32:35], s63 offen offset:0 sc1
  v_add_f32 v241, v241, v204
  v_add_f32 v208, v208, v189
  v_add_f32 v209, v209, v205
  v_add_f32 v240, v240, v208
  v_add_f32 v241, v241, v209
  s_nop 1
  v_permlane32_swap_b32 v240, v241
  buffer_load_dwordx4 a[116:119], v2, s[32:35], s63 offen offset:1024 sc1
  v_cvt_pk_f16_f32 v224, v192, v193
  v_cvt_pk_f16_f32 v225, v194, v195
  v_cvt_pk_f16_f32 v226, v196, v197
  v_add_f32 v240, v240, v241
  v_rcp_f32 v240, v240
  v_cvt_pk_f16_f32 v216, v176, v177
  buffer_load_dwordx4 a[120:123], v2, s[32:35], s63 offen offset:2048 sc1
  v_cvt_pk_f16_f32 v217, v178, v179
  v_cvt_pk_f16_f32 v218, v180, v181
  v_cvt_pk_f16_f32 v240, v240, v240
  v_mov_b32 v241, v240
  v_cvt_pk_f16_f32 v219, v182, v183
  v_cvt_pk_f16_f32 v220, v184, v185
  buffer_load_dwordx4 a[124:127], v2, s[32:35], s63 offen offset:3072 sc1
  v_cvt_pk_f16_f32 v221, v186, v187
  v_cvt_pk_f16_f32 v222, v188, v189
  v_permlane32_swap_b32 v240, v241
  v_cvt_pk_f16_f32 v227, v198, v199
  v_cvt_pk_f16_f32 v228, v200, v201
  v_cvt_pk_f16_f32 v229, v202, v203
  v_cvt_pk_f16_f32 v230, v204, v205
  v_pk_mul_f16 v216, v216, v240
  v_pk_mul_f16 v217, v217, v240
  v_pk_mul_f16 v218, v218, v240
  v_pk_mul_f16 v219, v219, v240
  v_pk_mul_f16 v220, v220, v240
  v_pk_mul_f16 v221, v221, v240
  v_pk_mul_f16 v222, v222, v240
  v_mov_b32 v223, 0
  v_pk_mul_f16 v224, v224, v241
  v_pk_mul_f16 v225, v225, v241
  v_pk_mul_f16 v226, v226, v241
  v_pk_mul_f16 v227, v227, v241
  v_pk_mul_f16 v228, v228, v241
  v_pk_mul_f16 v229, v229, v241
  v_pk_mul_f16 v230, v230, v241
  v_mov_b32 v231, 0
  v_and_b32 v11, 15, v1
  v_mul_u32_u24 v11, 144, v11
  v_lshrrev_b32 v12, 4, v1
  v_lshl_add_u32 v11, v12, 3, v11
  s_lshl_b32 s54, s3, 5
  s_add_u32 s54, s54, 152832
  v_add_u32 v11, s54, v11
  v_and_b32 v13, 31, v1
  v_mul_u32_u24 v13, 144, v13
  v_lshl_add_u32 v13, v10, 4, v13
  v_add_u32 v13, 152832, v13
  s_lshl_b32 s49, s46, 4
  s_add_u32 s49, s49, s45
  s_lshl_b32 s49, s49, 11
  s_add_u32 s49, s49, 0xc00000
  s_lshl_b32 s57, s46, 7
  s_lshl_b32 s54, s45, 2
  s_add_u32 s57, s57, s54
  s_add_u32 s57, s57, 0x12000
  s_mov_b32 s56, 30000
.Lpoll23:
  buffer_load_dword v9, v7, s[32:35], s58 offen sc1
  s_sub_u32 s56, s56, 1
  s_cbranch_scc1 .Lpolled24
  s_waitcnt vmcnt(0)
  v_cmp_eq_u32 vcc, s69, v9
  s_cmp_eq_u64 vcc, -1
  s_cbranch_scc0 .Lpoll23
.Lpolled24:
  buffer_load_dwordx4 v[16:19], v2, s[32:35], s47 offen offset:0 sc1
  buffer_load_dwordx4 v[20:23], v2, s[32:35], s47 offen offset:1024 sc1
  buffer_load_dwordx4 v[24:27], v2, s[32:35], s47 offen offset:2048 sc1
  buffer_load_dwordx4 v[28:31], v2, s[32:35], s47 offen offset:3072 sc1
  s_add_u32 s62, s47, 4096
  buffer_load_dwordx4 v[32:35], v2, s[32:35], s62 offen offset:0 sc1
  buffer_load_dwordx4 v[36:39], v2, s[32:35], s62 offen offset:1024 sc1
  buffer_load_dwordx4 v[40:43], v2, s[32:35], s62 offen offset:2048 sc1
  buffer_load_dwordx4 v[44:47], v2, s[32:35], s62 offen offset:3072 sc1
  s_add_u32 s62, s47, 8192
  buffer_load_dwordx4 v[48:51], v2, s[32:35], s62 offen offset:0 sc1
  buffer_load_dwordx4 v[52:55], v2, s[32:35], s62 offen offset:1024 sc1
  buffer_load_dwordx4 v[56:59], v2, s[32:35], s62 offen offset:2048 sc1
  buffer_load_dwordx4 v[60:63], v2, s[32:35], s62 offen offset:3072 sc1
  s_add_u32 s62, s47, 12288
  buffer_load_dwordx4 v[64:67], v2, s[32:35], s62 offen offset:0 sc1
  buffer_load_dwordx4 v[68:71], v2, s[32:35], s62 offen offset:1024 sc1
  buffer_load_dwordx4 v[72:75], v2, s[32:35], s62 offen offset:2048 sc1
  buffer_load_dwordx4 v[76:79], v2, s[32:35], s62 offen offset:3072 sc1
  s_waitcnt vmcnt(13)
  v_pk_add_f16 v16, v16, v24
  v_pk_add_f16 v17, v17, v25
  v_pk_add_f16 v18, v18, v26
  v_pk_add_f16 v19, v19, v27
  s_waitcnt vmcnt(12)
  v_pk_add_f16 v20, v20, v28
  v_pk_add_f16 v21, v21, v29
  v_pk_add_f16 v22, v22, v30
  v_pk_add_f16 v23, v23, v31
  s_waitcnt vmcnt(11)
  v_pk_add_f16 v16, v16, v32
  v_pk_add_f16 v17, v17, v33
  v_pk_add_f16 v18, v18, v34
  v_pk_add_f16 v19, v19, v35
  s_waitcnt vmcnt(10)
  v_pk_add_f16 v20, v20, v36
  v_pk_add_f16 v21, v21, v37
  v_pk_add_f16 v22, v22, v38
  v_pk_add_f16 v23, v23, v39
  s_waitcnt vmcnt(9)
  v_pk_add_f16 v16, v16, v40
  v_pk_add_f16 v17, v17, v41
  v_pk_add_f16 v18, v18, v42
  v_pk_add_f16 v19, v19, v43
  s_waitcnt vmcnt(8)
  v_pk_add_f16 v20, v20, v44
  v_pk_add_f16 v21, v21, v45
  v_pk_add_f16 v22, v22, v46
  v_pk_add_f16 v23, v23, v47
  s_waitcnt vmcnt(7)
  v_pk_add_f16 v16, v16, v48
  v_pk_add_f16 v17, v17, v49
  v_pk_add_f16 v18, v18, v50
  v_pk_add_f16 v19, v19, v51
  s_waitcnt vmcnt(6)
  v_pk_add_f16 v20, v20, v52
  v_pk_add_f16 v21, v21, v53
  v_pk_add_f16 v22, v22, v54
  v_pk_add_f16 v23, v23, v55
  s_waitcnt vmcnt(5)
  v_pk_add_f16 v16, v16, v56
  v_pk_add_f16 v17, v17, v57
  v_pk_add_f16 v18, v18, v58
  v_pk_add_f16 v19, v19, v59
  s_waitcnt vmcnt(4)
  v_pk_add_f16 v20, v20, v60
  v_pk_add_f16 v21, v21, v61
  v_pk_add_f16 v22, v22, v62
  v_pk_add_f16 v23, v23, v63
  s_waitcnt vmcnt(3)
  v_pk_add_f16 v16, v16, v64
  v_pk_add_f16 v17, v17, v65
  v_pk_add_f16 v18, v18, v66
  v_pk_add_f16 v19, v19, v67
  s_waitcnt vmcnt(2)
  v_pk_add_f16 v20, v20, v68
  v_pk_add_f16 v21, v21, v69
  v_pk_add_f16 v22, v22, v70
  v_pk_add_f16 v23, v23, v71
  s_waitcnt vmcnt(1)
  v_pk_add_f16 v16, v16, v72
  v_pk_add_f16 v17, v17, v73
  v_pk_add_f16 v18, v18, v74
  v_pk_add_f16 v19, v19, v75
  s_waitcnt vmcnt(0)
  v_pk_add_f16 v20, v20, v76
  v_pk_add_f16 v21, v21, v77
  v_pk_add_f16 v22, v22, v78
  v_pk_add_f16 v23, v23, v79
  v_pk_add_f16 v16, v16, v20
  v_pk_add_f16 v17, v17, v21
  v_pk_add_f16 v18, v18, v22
  v_pk_add_f16 v19, v19, v23
  ds_write_b64 v11, v[16:17]
  ds_write_b64 v11, v[18:19] offset:2304
  s_waitcnt lgkmcnt(0)
  s_barrier
  ds_read_b128 v[176:179], v13 offset:0
  ds_read_b128 v[180:183], v13 offset:32
  ds_read_b128 v[184:187], v13 offset:64
  ds_read_b128 v[188:191], v13 offset:96
  s_add_u32 m0, s51, 118784
  s_add_u32 s65, s50, 0
  buffer_load_dwordx4 v2, s[32:35], s65 offen sc1 lds
  s_add_u32 m0, s51, 122880
  s_add_u32 s65, s50, 4096
  buffer_load_dwordx4 v2, s[32:35], s65 offen sc1 lds
  s_add_u32 m0, s51, 126976
  s_add_u32 s65, s50, 8192
  buffer_load_dwordx4 v2, s[32:35], s65 offen sc1 lds
  s_add_u32 m0, s51, 131072
  s_add_u32 s65, s50, 12288
  buffer_load_dwordx4 v2, s[32:35], s65 offen sc1 lds
  s_waitcnt lgkmcnt(3)
  v_mfma_f32_32x32x16_f16 v[128:143], v[176:179], v[216:219], 0
  s_waitcnt lgkmcnt(2)
  v_mfma_f32_32x32x16_f16 v[128:143], v[180:183], v[220:223], v[128:143]
  s_waitcnt lgkmcnt(1)
  v_mfma_f32_32x32x16_f16 v[128:143], v[184:187], v[224:227], v[128:143]
  s_waitcnt lgkmcnt(0)
  v_mfma_f32_32x32x16_f16 v[128:143], v[188:191], v[228:231], v[128:143]
  s_add_u32 m0, s51, 135168
  s_add_u32 s65, s50, 16384
  buffer_load_dwordx4 v2, s[32:35], s65 offen sc1 lds
  s_add_u32 m0, s51, 139264
  s_add_u32 s65, s50, 20480
  buffer_load_dwordx4 v2, s[32:35], s65 offen sc1 lds
  s_add_u32 m0, s51, 143360
  s_add_u32 s65, s50, 24576
  buffer_load_dwordx4 v2, s[32:35], s65 offen sc1 lds
  s_nop 2
  v_mov_b32 v12, v140
  s_nop 1
  v_permlane32_swap_b32 v140, v12
  v_add_f32 v12, 0x338637bd, v12
  v_rcp_f32 v12, v12
  s_nop 0
  v_mul_f32 v128, v128, v12
  v_mul_f32 v129, v129, v12
  v_mul_f32 v130, v130, v12
  v_mul_f32 v131, v131, v12
  v_mul_f32 v132, v132, v12
  v_mul_f32 v133, v133, v12
  v_mul_f32 v134, v134, v12
  v_mul_f32 v135, v135, v12
  v_cvt_pk_bf16_f32 v144, v128, v129
  v_cvt_pk_bf16_f32 v145, v130, v131
  v_cvt_pk_bf16_f32 v146, v132, v133
  v_cvt_pk_bf16_f32 v147, v134, v135
  buffer_store_dwordx4 v[144:147], v2, s[32:35], s49 offen offset:0 sc1
  v_mul_f32 v136, v136, v12
  v_mul_f32 v137, v137, v12
  v_mul_f32 v138, v138, v12
  v_mul_f32 v139, v139, v12
  v_mul_f32 v140, v140, v12
  v_mul_f32 v141, v141, v12
  v_mul_f32 v142, v142, v12
  v_mul_f32 v143, v143, v12
  v_cvt_pk_bf16_f32 v148, v136, v137
  v_cvt_pk_bf16_f32 v149, v138, v139
  v_cvt_pk_bf16_f32 v150, v140, v141
  v_cvt_pk_bf16_f32 v151, v142, v143
  buffer_store_dwordx4 v[148:151], v2, s[32:35], s49 offen offset:1024 sc1
  s_lshr_b32 s59, s45, 2
  s_lshl_b32 s54, s44, 2
  s_add_u32 s59, s59, s54
  s_lshl_b32 s58, s59, 7
  s_add_u32 s58, s58, 0x12000
  s_lshl_b32 s47, s59, 15
  s_lshl_b32 s54, s3, 13
  s_add_u32 s47, s47, s54
  s_add_u32 s47, s47, 0xc00000
  s_add_u32 s48, s54, 86016
  s_and_b32 s54, s45, 3
  s_mul_i32 s54, s54, 112
  s_lshl_b32 s55, s3, 5
  s_add_u32 s54, s54, s55
  s_mul_i32 s68, s59, 28672
  s_lshl_b32 s55, s54, 1
  s_add_u32 s68, s68, s55
  v_and_b32 v11, 31, v1
  v_mul_u32_u24 v11, 896, v11
  v_lshl_add_u32 v11, v10, 3, v11
  v_add_u32 v12, s55, v5
  s_waitcnt vmcnt(0)
  buffer_store_dword v8, v6, s[32:35], s57 offen
  s_add_u32 s9, s57, 0x16f0000
  buffer_store_dword v8, v6, s[32:35], s9 offen sc1
  buffer_load_dwordx2 v[232:233], v11, s[36:39], s68 offen offset:0
  buffer_load_dwordx2 v[234:235], v11, s[36:39], s68 offen offset:16
  buffer_load_dwordx2 v[236:237], v11, s[36:39], s68 offen offset:32
  buffer_load_dwordx2 v[238:239], v11, s[36:39], s68 offen offset:48
  s_add_u32 m0, s51, 0
  s_add_u32 s65, s50, 28672
  buffer_load_dwordx4 v2, s[32:35], s65 offen sc1 lds
  s_add_u32 m0, s51, 4096
  s_add_u32 s65, s50, 32768
  buffer_load_dwordx4 v2, s[32:35], s65 offen sc1 lds
  s_add_u32 m0, s51, 8192
  s_add_u32 s65, s50, 36864
  buffer_load_dwordx4 v2, s[32:35], s65 offen sc1 lds
  s_add_u32 m0, s51, 12288
  s_add_u32 s65, s50, 40960
  buffer_load_dwordx4 v2, s[32:35], s65 offen sc1 lds
  s_add_u32 m0, s51, 16384
  s_add_u32 s65, s50, 45056
  buffer_load_dwordx4 v2, s[32:35], s65 offen sc1 lds
  s_add_u32 m0, s51, 20480
  s_add_u32 s65, s50, 49152
  buffer_load_dwordx4 v2, s[32:35], s65 offen sc1 lds
  s_add_u32 m0, s51, 24576
  s_add_u32 s65, s50, 53248
  buffer_load_dwordx4 v2, s[32:35], s65 offen sc1 lds
  v_min_u32 v14, 880, v2
  s_mul_i32 s68, s3, 7168
  s_add_u32 s68, s68, 210944
  s_add_u32 s67, s68, 3584
  buffer_load_dwordx4 v[96:99], v14, s[32:35], s68 offen offset:0 sc1
  buffer_load_dwordx4 v[100:103], v14, s[32:35], s68 offen offset:896 sc1
  buffer_load_dwordx4 v[104:107], v14, s[32:35], s68 offen offset:1792 sc1
  buffer_load_dwordx4 v[108:111], v14, s[32:35], s68 offen offset:2688 sc1
  buffer_load_dwordx4 v[112:115], v14, s[32:35], s67 offen offset:0 sc1
  buffer_load_dwordx4 v[116:119], v14, s[32:35], s67 offen offset:896 sc1
  buffer_load_dwordx4 v[120:123], v14, s[32:35], s67 offen offset:1792 sc1
  buffer_load_dwordx4 v[124:127], v14, s[32:35], s67 offen offset:2688 sc1
  v_and_b32 v15, 16, v14
  v_lshrrev_b32 v13, 2, v14
  v_and_or_b32 v15, v13, 8, v15
  v_lshrrev_b32 v13, 6, v14
  v_lshl_add_u32 v15, v13, 5, v15
  s_mul_i32 s55, s3, 896
  s_sub_u32 s55, 151040, s55
  s_cmp_eq_u32 s3, 3
  s_cselect_b32 s55, 151936, s55
  v_add_u32 v15, s55, v15
  s_mul_i32 s49, s59, 28
  s_lshr_b32 s54, s54, 4
  s_add_u32 s49, s49, s54
  s_lshl_b32 s49, s49, 10
  s_add_u32 s49, s49, 0xe00000
  s_and_b32 s54, s45, 3
  s_lshl_b32 s66, s59, 2
  s_add_u32 s66, s66, s54
  s_lshl2_add_u32 s66, s66, s3
  s_lshl_b32 s66, s66, 8
  v_and_b32 v13, 3, v1
  v_lshlrev_b32 v11, 2, v1
  v_cmp_eq_u32 vcc, 0, v13
  v_mov_b32 v13, 0x40000000
  s_nop 0
  v_cndmask_b32 v11, v13, v11, vcc
  s_add_u32 s66, s66, 0x40000
  s_lshl_b32 s54, s54, 2
  s_add_u32 s54, s54, s3
  s_lshl_b32 s54, s54, 2
  s_lshl_b32 s57, s59, 7
  s_add_u32 s57, s57, s54
  s_add_u32 s57, s57, 0x14000
  s_mov_b32 s56, 30015
.Lpoll25:
  s_and_b32 s9, s56, 15
  s_cselect_b32 s9, 0, 0x16f0000
  s_add_u32 s9, s9, s58
  buffer_load_dword v9, v7, s[32:35], s9 offen sc1
  s_sub_u32 s56, s56, 1
  s_cbranch_scc1 .Lpolled26
  s_waitcnt vmcnt(0)
  v_cmp_eq_u32 vcc, s69, v9
  s_cmp_eq_u64 vcc, -1
  s_cbranch_scc0 .Lpoll25
.Lpolled26:
  s_add_u32 m0, s48, 0
  s_nop 0
  buffer_load_dwordx4 v2, s[32:35], s47 offen offset:0 sc1 lds
  s_add_u32 m0, s48, 0
  s_nop 0
  buffer_load_dwordx4 v2, s[32:35], s47 offen offset:1024 sc1 lds
  s_add_u32 m0, s48, 0
  s_nop 0
  buffer_load_dwordx4 v2, s[32:35], s47 offen offset:2048 sc1 lds
  s_add_u32 m0, s48, 0
  s_nop 0
  buffer_load_dwordx4 v2, s[32:35], s47 offen offset:3072 sc1 lds
  s_add_u32 m0, s48, 4096
  s_add_u32 s62, s47, 4096
  buffer_load_dwordx4 v2, s[32:35], s62 offen offset:0 sc1 lds
  s_add_u32 m0, s48, 4096
  s_nop 0
  buffer_load_dwordx4 v2, s[32:35], s62 offen offset:1024 sc1 lds
  s_add_u32 m0, s48, 4096
  s_nop 0
  buffer_load_dwordx4 v2, s[32:35], s62 offen offset:2048 sc1 lds
  s_add_u32 m0, s48, 4096
  s_nop 0
  buffer_load_dwordx4 v2, s[32:35], s62 offen offset:3072 sc1 lds
  v_cmp_eq_u32 vcc, s69, v97
  v_cmp_eq_u32 s[54:55], s69, v99
  s_and_b64 vcc, vcc, s[54:55]
  v_cmp_eq_u32 s[54:55], s69, v101
  s_and_b64 vcc, vcc, s[54:55]
  v_cmp_eq_u32 s[54:55], s69, v103
  s_and_b64 vcc, vcc, s[54:55]
  v_cmp_eq_u32 s[54:55], s69, v105
  s_and_b64 vcc, vcc, s[54:55]
  v_cmp_eq_u32 s[54:55], s69, v107
  s_and_b64 vcc, vcc, s[54:55]
  v_cmp_eq_u32 s[54:55], s69, v109
  s_and_b64 vcc, vcc, s[54:55]
  v_cmp_eq_u32 s[54:55], s69, v111
  s_and_b64 vcc, vcc, s[54:55]
  v_cmp_eq_u32 s[54:55], s69, v113
  s_and_b64 vcc, vcc, s[54:55]
  v_cmp_eq_u32 s[54:55], s69, v115
  s_and_b64 vcc, vcc, s[54:55]
  v_cmp_eq_u32 s[54:55], s69, v117
  s_and_b64 vcc, vcc, s[54:55]
  v_cmp_eq_u32 s[54:55], s69, v119
  s_and_b64 vcc, vcc, s[54:55]
  v_cmp_eq_u32 s[54:55], s69, v121
  s_and_b64 vcc, vcc, s[54:55]
  v_cmp_eq_u32 s[54:55], s69, v123
  s_and_b64 vcc, vcc, s[54:55]
  v_cmp_eq_u32 s[54:55], s69, v125
  s_and_b64 vcc, vcc, s[54:55]
  v_cmp_eq_u32 s[54:55], s69, v127
  s_and_b64 vcc, vcc, s[54:55]
  s_cmp_eq_u64 vcc, -1
  s_cbranch_scc0 .Lrslow27
.Lrback28:
  s_cmp_eq_u32 s3, 2
  s_cselect_b32 s55, 1.0, 0
  v_fma_mix_f32 v97, v96, 1.0, v100 op_sel:[0,0,0] op_sel_hi:[1,0,1]
  v_fma_mix_f32 v113, v112, 1.0, v116 op_sel:[0,0,0] op_sel_hi:[1,0,1]
  v_fma_mix_f32 v99, v96, 1.0, v100 op_sel:[1,0,1] op_sel_hi:[1,0,1]
  v_fma_mix_f32 v115, v112, 1.0, v116 op_sel:[1,0,1] op_sel_hi:[1,0,1]
  v_fma_mix_f32 v101, v98, 1.0, v102 op_sel:[0,0,0] op_sel_hi:[1,0,1]
  v_fma_mix_f32 v117, v114, 1.0, v118 op_sel:[0,0,0] op_sel_hi:[1,0,1]
  v_fma_mix_f32 v103, v98, 1.0, v102 op_sel:[1,0,1] op_sel_hi:[1,0,1]
  v_fma_mix_f32 v119, v114, 1.0, v118 op_sel:[1,0,1] op_sel_hi:[1,0,1]
  v_fma_mix_f32 v97, v104, 1.0, v97 op_sel:[0,0,0] op_sel_hi:[1,0,0]
  v_fma_mix_f32 v113, v120, 1.0, v113 op_sel:[0,0,0] op_sel_hi:[1,0,0]
  v_fma_mix_f32 v99, v104, 1.0, v99 op_sel:[1,0,0] op_sel_hi:[1,0,0]
  v_fma_mix_f32 v115, v120, 1.0, v115 op_sel:[1,0,0] op_sel_hi:[1,0,0]
  v_fma_mix_f32 v101, v106, 1.0, v101 op_sel:[0,0,0] op_sel_hi:[1,0,0]
  v_fma_mix_f32 v117, v122, 1.0, v117 op_sel:[0,0,0] op_sel_hi:[1,0,0]
  v_fma_mix_f32 v103, v106, 1.0, v103 op_sel:[1,0,0] op_sel_hi:[1,0,0]
  v_fma_mix_f32 v119, v122, 1.0, v119 op_sel:[1,0,0] op_sel_hi:[1,0,0]
  v_fma_mix_f32 v97, v108, 1.0, v97 op_sel:[0,0,0] op_sel_hi:[1,0,0]
  v_fma_mix_f32 v113, v124, 1.0, v113 op_sel:[0,0,0] op_sel_hi:[1,0,0]
  v_fma_mix_f32 v99, v108, 1.0, v99 op_sel:[1,0,0] op_sel_hi:[1,0,0]
  v_fma_mix_f32 v115, v124, 1.0, v115 op_sel:[1,0,0] op_sel_hi:[1,0,0]
  v_fma_mix_f32 v101, v110, 1.0, v101 op_sel:[0,0,0] op_sel_hi:[1,0,0]
  v_fma_mix_f32 v117, v126, 1.0, v117 op_sel:[0,0,0] op_sel_hi:[1,0,0]
  v_fma_mix_f32 v103, v110, 1.0, v103 op_sel:[1,0,0] op_sel_hi:[1,0,0]
  v_fma_mix_f32 v119, v126, 1.0, v119 op_sel:[1,0,0] op_sel_hi:[1,0,0]
  v_cvt_pk_bf16_f32 v96, v97, v99
  v_cvt_pk_bf16_f32 v112, v113, v115
  v_cvt_pk_bf16_f32 v98, v101, v103
  v_cvt_pk_bf16_f32 v114, v117, v119
  v_lshlrev_b32 v97, 16, v96
  v_lshlrev_b32 v113, 16, v112
  v_and_b32 v99, 0xffff0000, v96
  v_and_b32 v115, 0xffff0000, v112
  v_lshlrev_b32 v101, 16, v98
  v_lshlrev_b32 v117, 16, v114
  v_and_b32 v103, 0xffff0000, v98
  v_and_b32 v119, 0xffff0000, v114
  v_add_f32 v97, s55, v97
  v_add_f32 v113, s55, v113
  v_add_f32 v99, s55, v99
  v_add_f32 v115, s55, v115
  v_add_f32 v101, s55, v101
  v_add_f32 v117, s55, v117
  v_add_f32 v103, s55, v103
  v_add_f32 v119, s55, v119
  v_cvt_pk_bf16_f32 v96, v97, v99
  v_cvt_pk_bf16_f32 v112, v113, v115
  v_cvt_pk_bf16_f32 v98, v101, v103
  v_cvt_pk_bf16_f32 v114, v117, v119
  v_lshlrev_b32 v97, 16, v96
  v_lshlrev_b32 v113, 16, v112
  v_and_b32 v99, 0xffff0000, v96
  v_and_b32 v115, 0xffff0000, v112
  v_lshlrev_b32 v101, 16, v98
  v_lshlrev_b32 v117, 16, v114
  v_and_b32 v103, 0xffff0000, v98
  v_and_b32 v119, 0xffff0000, v114
  v_cvt_pk_f16_f32 v96, v97, v99
  v_cvt_pk_f16_f32 v112, v113, v115
  v_cvt_pk_f16_f32 v97, v101, v103
  v_cvt_pk_f16_f32 v113, v117, v119
  ds_write_b64 v15, v[96:97]
  ds_write_b64 v15, v[112:113] offset:448
  v_lshlrev_b32 v80, 16, v232
  v_and_b32 v81, 0xffff0000, v232
  v_lshlrev_b32 v82, 16, v233
  v_and_b32 v83, 0xffff0000, v233
  v_lshlrev_b32 v84, 16, v234
  v_and_b32 v85, 0xffff0000, v234
  v_lshlrev_b32 v86, 16, v235
  v_and_b32 v87, 0xffff0000, v235
  v_lshlrev_b32 v88, 16, v236
  v_and_b32 v89, 0xffff0000, v236
  v_lshlrev_b32 v90, 16, v237
  v_and_b32 v91, 0xffff0000, v237
  v_lshlrev_b32 v92, 16, v238
  v_and_b32 v93, 0xffff0000, v238
  v_lshlrev_b32 v94, 16, v239
  v_and_b32 v95, 0xffff0000, v239
  s_waitcnt vmcnt(0)
  s_waitcnt lgkmcnt(0)
  s_barrier
  ds_read_b128 v[176:179], v3 offset:20480
  ds_read_b128 v[180:183], v3 offset:21504
  ds_read_b128 v[184:187], v3 offset:22528
  ds_read_b128 v[188:191], v3 offset:23552
  ds_read_b128 v[192:195], v3 offset:24576
  ds_read_b128 v[196:199], v3 offset:25600
  s_waitcnt lgkmcnt(5)
  v_mfma_f32_32x32x16_bf16 v[128:143], a[0:3], v[176:179], 0
  ds_read_b128 v[200:203], v3 offset:26624
  s_add_u32 m0, s51, 28672
  s_add_u32 s65, s50, 57344
  buffer_load_dwordx4 v2, s[32:35], s65 offen sc1 lds
  s_waitcnt lgkmcnt(5)
  v_mfma_f32_32x32x16_bf16 v[128:143], a[4:7], v[180:183], v[128:143]
  ds_read_b128 v[204:207], v3 offset:27648
  s_waitcnt lgkmcnt(5)
  v_mfma_f32_32x32x16_bf16 v[128:143], a[8:11], v[184:187], v[128:143]
  ds_read_b128 v[176:179], v3 offset:28672
  s_add_u32 m0, s51, 32768
  s_add_u32 s65, s50, 61440
  buffer_load_dwordx4 v2, s[32:35], s65 offen sc1 lds
  s_waitcnt lgkmcnt(5)
  v_mfma_f32_32x32x16_bf16 v[128:143], a[12:15], v[188:191], v[128:143]
  ds_read_b128 v[180:183], v3 offset:29696
  s_waitcnt lgkmcnt(5)
  v_mfma_f32_32x32x16_bf16 v[128:143], a[16:19], v[192:195], v[128:143]
  ds_read_b128 v[184:187], v3 offset:30720
  s_add_u32 m0, s51, 36864
  s_add_u32 s65, s50, 65536
  buffer_load_dwordx4 v2, s[32:35], s65 offen sc1 lds
  s_waitcnt lgkmcnt(5)
  v_mfma_f32_32x32x16_bf16 v[128:143], a[20:23], v[196:199], v[128:143]
  ds_read_b128 v[188:191], v3 offset:31744
  s_waitcnt lgkmcnt(5)
  v_mfma_f32_32x32x16_bf16 v[128:143], a[24:27], v[200:203], v[128:143]
  ds_read_b128 v[192:195], v3 offset:32768
  s_add_u32 m0, s51, 40960
  s_add_u32 s65, s50, 69632
  buffer_load_dwordx4 v2, s[32:35], s65 offen sc1 lds
  s_waitcnt lgkmcnt(5)
  v_mfma_f32_32x32x16_bf16 v[128:143], a[28:31], v[204:207], v[128:143]
  ds_read_b128 v[196:199], v3 offset:33792
  s_waitcnt lgkmcnt(5)
  v_mfma_f32_32x32x16_bf16 v[128:143], a[32:35], v[176:179], v[128:143]
  ds_read_b128 v[200:203], v3 offset:34816
  s_add_u32 m0, s51, 45056
  s_add_u32 s65, s50, 73728
  buffer_load_dwordx4 v2, s[32:35], s65 offen sc1 lds
  s_waitcnt lgkmcnt(5)
  v_mfma_f32_32x32x16_bf16 v[128:143], a[36:39], v[180:183], v[128:143]
  ds_read_b128 v[204:207], v3 offset:35840
  s_waitcnt lgkmcnt(5)
  v_mfma_f32_32x32x16_bf16 v[128:143], a[40:43], v[184:187], v[128:143]
  ds_read_b128 v[176:179], v3 offset:36864
  s_add_u32 m0, s51, 49152
  s_add_u32 s65, s50, 77824
  buffer_load_dwordx4 v2, s[32:35], s65 offen sc1 lds
  s_waitcnt lgkmcnt(5)
  v_mfma_f32_32x32x16_bf16 v[128:143], a[44:47], v[188:191], v[128:143]
  ds_read_b128 v[180:183], v3 offset:37888
  s_waitcnt lgkmcnt(5)
  v_mfma_f32_32x32x16_bf16 v[128:143], a[48:51], v[192:195], v[128:143]
  ds_read_b128 v[184:187], v3 offset:38912
  s_add_u32 m0, s51, 53248
  s_add_u32 s65, s50, 81920
  buffer_load_dwordx4 v2, s[32:35], s65 offen sc1 lds
  s_waitcnt lgkmcnt(5)
  v_mfma_f32_32x32x16_bf16 v[128:143], a[52:55], v[196:199], v[128:143]
  ds_read_b128 v[188:191], v3 offset:39936
  s_waitcnt lgkmcnt(5)
  v_mfma_f32_32x32x16_bf16 v[128:143], a[56:59], v[200:203], v[128:143]
  ds_read_b128 v[192:195], v3 offset:40960
  s_add_u32 m0, s51, 57344
  s_add_u32 s65, s50, 86016
  buffer_load_dwordx4 v2, s[32:35], s65 offen sc1 lds
  s_waitcnt lgkmcnt(5)
  v_mfma_f32_32x32x16_bf16 v[128:143], a[60:63], v[204:207], v[128:143]
  ds_read_b128 v[196:199], v3 offset:41984
  s_waitcnt lgkmcnt(5)
  v_mfma_f32_32x32x16_bf16 v[128:143], a[64:67], v[176:179], v[128:143]
  ds_read_b128 v[200:203], v3 offset:43008
  s_add_u32 m0, s51, 61440
  s_add_u32 s65, s50, 90112
  buffer_load_dwordx4 v2, s[32:35], s65 offen sc1 lds
  s_waitcnt lgkmcnt(5)
  v_mfma_f32_32x32x16_bf16 v[128:143], a[68:71], v[180:183], v[128:143]
  ds_read_b128 v[204:207], v3 offset:44032
  s_waitcnt lgkmcnt(5)
  v_mfma_f32_32x32x16_bf16 v[128:143], a[72:75], v[184:187], v[128:143]
  ds_read_b128 v[176:179], v3 offset:45056
  s_add_u32 m0, s51, 65536
  s_add_u32 s65, s50, 94208
  buffer_load_dwordx4 v2, s[32:35], s65 offen sc1 lds
  s_waitcnt lgkmcnt(5)
  v_mfma_f32_32x32x16_bf16 v[128:143], a[76:79], v[188:191], v[128:143]
  ds_read_b128 v[180:183], v3 offset:46080
  s_waitcnt lgkmcnt(5)
  v_mfma_f32_32x32x16_bf16 v[128:143], a[80:83], v[192:195], v[128:143]
  ds_read_b128 v[184:187], v3 offset:47104
  s_add_u32 m0, s51, 69632
  s_add_u32 s65, s50, 98304
  buffer_load_dwordx4 v2, s[32:35], s65 offen sc1 lds
  s_waitcnt lgkmcnt(5)
  v_mfma_f32_32x32x16_bf16 v[128:143], a[84:87], v[196:199], v[128:143]
  ds_read_b128 v[188:191], v3 offset:48128
  s_waitcnt lgkmcnt(5)
  v_mfma_f32_32x32x16_bf16 v[128:143], a[88:91], v[200:203], v[128:143]
  ds_read_b128 v[192:195], v3 offset:49152
  s_add_u32 m0, s51, 73728
  s_add_u32 s65, s50, 102400
  buffer_load_dwordx4 v2, s[32:35], s65 offen sc1 lds
  s_waitcnt lgkmcnt(5)
  v_mfma_f32_32x32x16_bf16 v[128:143], a[92:95], v[204:207], v[128:143]
  ds_read_b128 v[196:199], v3 offset:50176
  s_waitcnt lgkmcnt(5)
  v_mfma_f32_32x32x16_bf16 v[128:143], a[96:99], v[176:179], v[128:143]
  ds_read_b128 v[200:203], v3 offset:51200
  s_add_u32 m0, s51, 77824
  s_add_u32 s65, s50, 106496
  buffer_load_dwordx4 v2, s[32:35], s65 offen sc1 lds
  s_waitcnt lgkmcnt(5)
  v_mfma_f32_32x32x16_bf16 v[128:143], a[100:103], v[180:183], v[128:143]
  ds_read_b128 v[204:207], v3 offset:52224
  s_waitcnt lgkmcnt(5)
  v_mfma_f32_32x32x16_bf16 v[128:143], a[104:107], v[184:187], v[128:143]
  s_add_u32 m0, s51, 81920
  s_add_u32 s65, s50, 110592
  buffer_load_dwordx4 v2, s[32:35], s65 offen sc1 lds
  s_waitcnt lgkmcnt(4)
  v_mfma_f32_32x32x16_bf16 v[128:143], a[108:111], v[188:191], v[128:143]
  s_waitcnt lgkmcnt(0)
  s_barrier
  v_mfma_f32_32x32x16_bf16 v[128:143], a[112:115], v[192:195], v[128:143]
  buffer_load_dwordx4 a[128:131], v2, s[32:35], s53 offen offset:0 sc1
  ds_read_b128 v[240:243], v12 offset:3584
  ds_read_b128 v[244:247], v12 offset:3616
  v_mfma_f32_32x32x16_bf16 v[128:143], a[116:119], v[196:199], v[128:143]
  v_mfma_f32_32x32x16_bf16 v[128:143], a[120:123], v[200:203], v[128:143]
  buffer_load_dwordx4 a[132:135], v2, s[32:35], s53 offen offset:1024 sc1
  v_mfma_f32_32x32x16_bf16 v[128:143], a[124:127], v[204:207], v[128:143]
  s_waitcnt lgkmcnt(1)
  s_nop 10
  v_fma_mix_f32 v128, v128, v240, v80 op_sel:[0,0,0] op_sel_hi:[0,1,0]
  v_fma_mix_f32 v129, v129, v240, v81 op_sel:[0,1,0] op_sel_hi:[0,1,0]
  v_fma_mix_f32 v130, v130, v241, v82 op_sel:[0,0,0] op_sel_hi:[0,1,0]
  v_fma_mix_f32 v131, v131, v241, v83 op_sel:[0,1,0] op_sel_hi:[0,1,0]
  v_fma_mix_f32 v132, v132, v242, v84 op_sel:[0,0,0] op_sel_hi:[0,1,0]
  v_fma_mix_f32 v133, v133, v242, v85 op_sel:[0,1,0] op_sel_hi:[0,1,0]
  v_fma_mix_f32 v134, v134, v243, v86 op_sel:[0,0,0] op_sel_hi:[0,1,0]
  v_fma_mix_f32 v135, v135, v243, v87 op_sel:[0,1,0] op_sel_hi:[0,1,0]
  v_cvt_pk_f16_f32 v144, v128, v129
  v_cvt_pk_f16_f32 v145, v130, v131
  v_cvt_pk_f16_f32 v146, v132, v133
  v_cvt_pk_f16_f32 v147, v134, v135
  buffer_store_dwordx4 v[144:147], v2, s[32:35], s49 offen offset:0 sc1
  v_mul_f32 v13, v128, v128
  v_fmac_f32 v13, v129, v129
  v_add_f32 v12, v128, v129
  v_fmac_f32 v13, v130, v130
  v_add_f32 v12, v12, v130
  v_fmac_f32 v13, v131, v131
  v_add_f32 v12, v12, v131
  v_fmac_f32 v13, v132, v132
  v_add_f32 v12, v12, v132
  v_fmac_f32 v13, v133, v133
  v_add_f32 v12, v12, v133
  v_fmac_f32 v13, v134, v134
  v_add_f32 v12, v12, v134
  v_fmac_f32 v13, v135, v135
  v_add_f32 v12, v12, v135
  s_cmp_eq_u32 s3, 3
  s_cbranch_scc1 .Lx1fin29
  s_waitcnt lgkmcnt(0)
  v_fma_mix_f32 v136, v136, v244, v88 op_sel:[0,0,0] op_sel_hi:[0,1,0]
  v_fma_mix_f32 v137, v137, v244, v89 op_sel:[0,1,0] op_sel_hi:[0,1,0]
  v_fma_mix_f32 v138, v138, v245, v90 op_sel:[0,0,0] op_sel_hi:[0,1,0]
  v_fma_mix_f32 v139, v139, v245, v91 op_sel:[0,1,0] op_sel_hi:[0,1,0]
  v_fma_mix_f32 v140, v140, v246, v92 op_sel:[0,0,0] op_sel_hi:[0,1,0]
  v_fma_mix_f32 v141, v141, v246, v93 op_sel:[0,1,0] op_sel_hi:[0,1,0]
  v_fma_mix_f32 v142, v142, v247, v94 op_sel:[0,0,0] op_sel_hi:[0,1,0]
  v_fma_mix_f32 v143, v143, v247, v95 op_sel:[0,1,0] op_sel_hi:[0,1,0]
  v_cvt_pk_f16_f32 v148, v136, v137
  v_cvt_pk_f16_f32 v149, v138, v139
  v_cvt_pk_f16_f32 v150, v140, v141
  v_cvt_pk_f16_f32 v151, v142, v143
  buffer_store_dwordx4 v[148:151], v2, s[32:35], s49 offen offset:1024 sc1
  v_fmac_f32 v13, v136, v136
  v_add_f32 v12, v12, v136
  v_fmac_f32 v13, v137, v137
  v_add_f32 v12, v12, v137
  v_fmac_f32 v13, v138, v138
  v_add_f32 v12, v12, v138
  v_fmac_f32 v13, v139, v139
  v_add_f32 v12, v12, v139
  v_fmac_f32 v13, v140, v140
  v_add_f32 v12, v12, v140
  v_fmac_f32 v13, v141, v141
  v_add_f32 v12, v12, v141
  v_fmac_f32 v13, v142, v142
  v_add_f32 v12, v12, v142
  v_fmac_f32 v13, v143, v143
  v_add_f32 v12, v12, v143
.Lx1fin29:
  s_nop 1
  v_permlane32_swap_b32 v12, v13
  v_add_f32 v12, v12, v13
  s_nop 1
  v_mov_b32_dpp v80, v12 quad_perm:[0,0,0,0] row_mask:0xf bank_mask:0xf
  v_mov_b32_dpp v81, v12 quad_perm:[1,1,1,1] row_mask:0xf bank_mask:0xf
  v_mov_b32_dpp v82, v12 quad_perm:[2,2,2,2] row_mask:0xf bank_mask:0xf
  v_mov_b32_dpp v83, v12 quad_perm:[3,3,3,3] row_mask:0xf bank_mask:0xf
  buffer_store_dwordx4 v[80:83], v11, s[32:35], s66 offen sc1
  v_lshlrev_b32 v14, 2, v1
  s_or_b32 s54, s2, s3
  s_cmp_eq_u32 s54, 0
  s_cselect_b32 s54, 0x1c000, s30
  buffer_store_dword v8, v6, s[32:35], s54 offen sc1
  s_lshl_b32 s58, s46, 7
  s_add_u32 s58, s58, 0x14000
  s_mul_i32 s47, s46, 28672
  s_add_u32 s47, s47, 0xe00000
  s_lshl_b32 s48, s46, 12
  s_add_u32 s48, s48, 0x40000
  s_waitcnt vmcnt(0)
  buffer_store_dword v8, v6, s[32:35], s57 offen
  s_add_u32 s9, s57, 0x16f0000
  buffer_store_dword v8, v6, s[32:35], s9 offen sc1
  s_barrier
  s_add_u32 m0, s51, 86016
  s_add_u32 s65, s50, 114688
  buffer_load_dwordx4 v2, s[32:35], s65 offen sc1 lds
  s_add_u32 m0, s51, 90112
  s_add_u32 s65, s50, 118784
  buffer_load_dwordx4 v2, s[32:35], s65 offen sc1 lds
  s_add_u32 m0, s51, 94208
  s_add_u32 s65, s50, 122880
  buffer_load_dwordx4 v2, s[32:35], s65 offen sc1 lds
  s_add_u32 m0, s51, 98304
  s_add_u32 s65, s50, 126976
  buffer_load_dwordx4 v2, s[32:35], s65 offen sc1 lds
  s_add_u32 m0, s51, 102400
  s_add_u32 s65, s50, 131072
  buffer_load_dwordx4 v2, s[32:35], s65 offen sc1 lds
  s_add_u32 m0, s51, 106496
  s_add_u32 s65, s50, 135168
  buffer_load_dwordx4 v2, s[32:35], s65 offen sc1 lds
  s_add_u32 m0, s51, 110592
  s_add_u32 s65, s50, 139264
  buffer_load_dwordx4 v2, s[32:35], s65 offen sc1 lds
  s_mul_i32 s66, s46, 112
  s_mul_i32 s54, s45, 7
  s_add_u32 s66, s66, s54
  s_lshl_b32 s66, s66, 10
  s_add_u32 s66, s66, 0x1000000
  s_add_u32 s67, s66, 4096
  s_lshr_b32 s54, s46, 1
  s_lshl_b32 s54, s54, 2
  s_lshr_b32 s55, s45, 2
  s_add_u32 s54, s54, s55
  s_lshl_b32 s57, s54, 7
  s_and_b32 s54, s45, 3
  s_lshl_b32 s54, s54, 1
  s_and_b32 s55, s3, 1
  s_add_u32 s54, s54, s55
  s_lshl_b32 s54, s54, 2
  s_add_u32 s57, s57, s54
  s_add_u32 s57, s57, 0x16000
  v_mov_b32 v11, 0xc09bc09b
  s_mov_b32 s26, 0xae97ae97
  s_mov_b32 s27, 0x3c003c00
  s_mul_i32 s10, s46, 112
  s_lshr_b32 s54, s45, 2
  s_mul_i32 s54, s54, 28
  s_add_u32 s10, s10, s54
  s_and_b32 s54, s45, 3
  s_add_u32 s10, s10, s54
  s_lshl_b32 s10, s10, 10
  s_add_u32 s10, s10, 0x1000000
  s_add_u32 s11, s10, 4096
  s_add_u32 s12, s10, 8192
  s_add_u32 s13, s10, 12288
  s_add_u32 s14, s10, 16384
  s_add_u32 s15, s10, 20480
  s_add_u32 s16, s10, 24576
  s_sub_u32 s57, s57, 0x16000
  s_and_b32 s54, s57, 0xffffff80
  s_add_u32 s57, s57, s54
  s_add_u32 s57, s57, 0x180000
  s_add_u32 s21, s57, 0x16f0000
  s_and_b32 s54, s45, 1
  s_lshl1_add_u32 s54, s44, s54
  s_lshl2_add_u32 s19, s54, s3
  s_lshl_b32 s19, s19, 8
  s_add_u32 s19, s19, 0x180000
  s_and_b32 s55, s3, 1
  s_lshl1_add_u32 s20, s54, s55
  s_mul_i32 s55, s3, 28
  s_mul_i32 s17, s20, 112
  s_add_u32 s17, s17, s55
  s_lshl_b32 s17, s17, 10
  s_add_u32 s17, s17, 0x1000000
  s_xor_b32 s54, s20, 1
  s_mul_i32 s18, s54, 112
  s_add_u32 s18, s18, s55
  s_lshl_b32 s18, s18, 10
  s_add_u32 s18, s18, 0x1000000
  v_lshlrev_b32 v15, 2, v1
  ds_read_b128 v[224:227], v5 offset:1792
  ds_read_b128 v[228:231], v5 offset:2688
  ds_read_b128 v[232:235], v5 offset:1824
  ds_read_b128 v[236:239], v5 offset:2720
  ds_read_b128 v[192:195], v3 offset:53248
  ds_read_b128 v[196:199], v2 offset:0
  ds_read_b128 v[200:203], v2 offset:28672
  ds_read_b128 v[204:207], v3 offset:54272
  ds_read_b128 v[208:211], v2 offset:1024
  ds_read_b128 v[212:215], v2 offset:29696
  s_mov_b32 s56, 30015
.Lpoll30:
  s_and_b32 s9, s56, 15
  s_cselect_b32 s9, 0, 0x16f0000
  s_add_u32 s9, s9, s58
  buffer_load_dword v9, v7, s[32:35], s9 offen sc1
  s_sub_u32 s56, s56, 1
  s_cbranch_scc1 .Lpolled31
  s_waitcnt vmcnt(0)
  v_cmp_eq_u32 vcc, s69, v9
  s_cmp_eq_u64 vcc, -1
  s_cbranch_scc0 .Lpoll30
.Lpolled31:
  buffer_load_dword v176, v14, s[32:35], s48 offen offset:0 sc1
  buffer_load_dword v177, v14, s[32:35], s48 offen offset:256 sc1
  buffer_load_dword v178, v14, s[32:35], s48 offen offset:512 sc1
  buffer_load_dword v179, v14, s[32:35], s48 offen offset:768 sc1
  buffer_load_dword v180, v14, s[32:35], s48 offen offset:1024 sc1
  buffer_load_dword v181, v14, s[32:35], s48 offen offset:1280 sc1
  buffer_load_dword v182, v14, s[32:35], s48 offen offset:1536 sc1
  buffer_load_dword v183, v14, s[32:35], s48 offen offset:1792 sc1
  buffer_load_dword v184, v14, s[32:35], s48 offen offset:2048 sc1
  buffer_load_dword v185, v14, s[32:35], s48 offen offset:2304 sc1
  buffer_load_dword v186, v14, s[32:35], s48 offen offset:2560 sc1
  buffer_load_dword v187, v14, s[32:35], s48 offen offset:2816 sc1
  buffer_load_dword v188, v14, s[32:35], s48 offen offset:3072 sc1
  buffer_load_dword v189, v14, s[32:35], s48 offen offset:3328 sc1
  buffer_load_dword v190, v14, s[32:35], s48 offen offset:3584 sc1
  buffer_load_dword v191, v14, s[32:35], s48 offen offset:3840 sc1
  buffer_load_dwordx4 v[16:19], v2, s[32:35], s47 offen offset:0 sc1
  buffer_load_dwordx4 v[20:23], v2, s[32:35], s47 offen offset:1024 sc1
  buffer_load_dwordx4 v[24:27], v2, s[32:35], s47 offen offset:2048 sc1
  buffer_load_dwordx4 v[28:31], v2, s[32:35], s47 offen offset:3072 sc1
  s_add_u32 s62, s47, 4096
  buffer_load_dwordx4 v[32:35], v2, s[32:35], s62 offen offset:0 sc1
  buffer_load_dwordx4 v[36:39], v2, s[32:35], s62 offen offset:1024 sc1
  buffer_load_dwordx4 v[40:43], v2, s[32:35], s62 offen offset:2048 sc1
  buffer_load_dwordx4 v[44:47], v2, s[32:35], s62 offen offset:3072 sc1
  s_add_u32 s62, s47, 8192
  buffer_load_dwordx4 v[48:51], v2, s[32:35], s62 offen offset:0 sc1
  buffer_load_dwordx4 v[52:55], v2, s[32:35], s62 offen offset:1024 sc1
  buffer_load_dwordx4 v[56:59], v2, s[32:35], s62 offen offset:2048 sc1
  buffer_load_dwordx4 v[60:63], v2, s[32:35], s62 offen offset:3072 sc1
  s_waitcnt vmcnt(19)
  v_add_f32 v176, v176, v184
  s_waitcnt vmcnt(18)
  v_add_f32 v177, v177, v185
  s_waitcnt vmcnt(17)
  v_add_f32 v178, v178, v186
  s_waitcnt vmcnt(16)
  v_add_f32 v179, v179, v187
  s_waitcnt vmcnt(15)
  v_add_f32 v180, v180, v188
  s_waitcnt vmcnt(14)
  v_add_f32 v181, v181, v189
  s_waitcnt vmcnt(13)
  v_add_f32 v182, v182, v190
  s_waitcnt vmcnt(12)
  v_add_f32 v183, v183, v191
  v_add_f32 v176, v176, v180
  v_add_f32 v177, v177, v181
  v_add_f32 v178, v178, v182
  v_add_f32 v179, v179, v183
  v_add_f32 v176, v176, v177
  v_add_f32 v178, v178, v179
  v_add_f32 v176, v176, v178
  v_mul_f32 v176, 0x3b124925, v176
  v_mov_b32 v177, v176
  s_nop 1
  v_permlane32_swap_b32 v176, v177
  v_fma_f32 v177, -v176, v176, v177
  v_add_f32 v177, 0x3727c5ac, v177
  v_rsq_f32 v177, v177
  s_nop 0
  v_mul_f32 v176, -v176, v177
  v_cvt_pk_f16_f32 v12, v177, v177
  v_cvt_pk_f16_f32 v13, v176, v176
  s_waitcnt vmcnt(11)
  v_pk_fma_f16 v16, v16, v12, v13
  v_pk_fma_f16 v17, v17, v12, v13
  v_pk_fma_f16 v18, v18, v12, v13
  v_pk_fma_f16 v19, v19, v12, v13
  s_waitcnt lgkmcnt(8)
  v_pk_fma_f16 v16, v16, v224, v228
  v_pk_fma_f16 v17, v17, v225, v229
  v_pk_fma_f16 v18, v18, v226, v230
  v_pk_fma_f16 v19, v19, v227, v231
  s_waitcnt lgkmcnt(5)
  s_nop 0
  v_mfma_f32_32x32x16_f16 v[128:143], v[192:195], v[16:19], 0
  ds_read_b128 v[216:219], v3 offset:55296
  s_add_u32 s62, s47, 12288
  buffer_load_dwordx4 v[64:67], v2, s[32:35], s62 offen offset:0 sc1
  s_waitcnt vmcnt(11)
  v_pk_fma_f16 v20, v20, v12, v13
  v_pk_fma_f16 v21, v21, v12, v13
  s_waitcnt lgkmcnt(5)
  v_mfma_f32_32x32x16_f16 v[144:159], v[196:199], v[16:19], 0
  ds_read_b128 v[220:223], v2 offset:2048
  v_pk_fma_f16 v22, v22, v12, v13
  v_pk_fma_f16 v23, v23, v12, v13
  v_pk_fma_f16 v20, v20, v232, v236
  s_waitcnt lgkmcnt(5)
  v_mfma_f32_32x32x16_f16 v[160:175], v[200:203], v[16:19], 0
  ds_read_b128 v[192:195], v2 offset:30720
  v_pk_fma_f16 v21, v21, v233, v237
  v_pk_fma_f16 v22, v22, v234, v238
  v_pk_fma_f16 v23, v23, v235, v239
  ds_read_b128 v[224:227], v5 offset:1856
  ds_read_b128 v[228:231], v5 offset:2752
  s_waitcnt lgkmcnt(7)
  v_mfma_f32_32x32x16_f16 v[128:143], v[204:207], v[20:23], v[128:143]
  ds_read_b128 v[196:199], v3 offset:56320
  buffer_load_dwordx4 v[68:71], v2, s[32:35], s62 offen offset:1024 sc1
  s_waitcnt vmcnt(11)
  v_pk_fma_f16 v24, v24, v12, v13
  v_pk_fma_f16 v25, v25, v12, v13
  s_waitcnt lgkmcnt(7)
  v_mfma_f32_32x32x16_f16 v[144:159], v[208:211], v[20:23], v[144:159]
  ds_read_b128 v[200:203], v2 offset:3072
  v_pk_fma_f16 v26, v26, v12, v13
  v_pk_fma_f16 v27, v27, v12, v13
  s_waitcnt lgkmcnt(2)
  v_pk_fma_f16 v24, v24, v224, v228
  v_mfma_f32_32x32x16_f16 v[160:175], v[212:215], v[20:23], v[160:175]
  ds_read_b128 v[204:207], v2 offset:31744
  v_pk_fma_f16 v25, v25, v225, v229
  v_pk_fma_f16 v26, v26, v226, v230
  v_pk_fma_f16 v27, v27, v227, v231
  ds_read_b128 v[232:235], v5 offset:1888
  ds_read_b128 v[236:239], v5 offset:2784
  v_mfma_f32_32x32x16_f16 v[128:143], v[216:219], v[24:27], v[128:143]
  ds_read_b128 v[208:211], v3 offset:57344
  buffer_load_dwordx4 v[72:75], v2, s[32:35], s62 offen offset:2048 sc1
  s_waitcnt vmcnt(11)
  v_pk_fma_f16 v28, v28, v12, v13
  v_pk_fma_f16 v29, v29, v12, v13
  v_mfma_f32_32x32x16_f16 v[144:159], v[220:223], v[24:27], v[144:159]
  ds_read_b128 v[212:215], v2 offset:4096
  v_pk_fma_f16 v30, v30, v12, v13
  v_pk_fma_f16 v31, v31, v12, v13
  s_waitcnt lgkmcnt(2)
  v_pk_fma_f16 v28, v28, v232, v236
  v_mfma_f32_32x32x16_f16 v[160:175], v[192:195], v[24:27], v[160:175]
  ds_read_b128 v[216:219], v2 offset:32768
  v_pk_fma_f16 v29, v29, v233, v237
  v_pk_fma_f16 v30, v30, v234, v238
  v_pk_fma_f16 v31, v31, v235, v239
  ds_read_b128 v[224:227], v5 offset:1920
  ds_read_b128 v[228:231], v5 offset:2816
  v_mfma_f32_32x32x16_f16 v[128:143], v[196:199], v[28:31], v[128:143]
  ds_read_b128 v[220:223], v3 offset:58368
  buffer_load_dwordx4 v[76:79], v2, s[32:35], s62 offen offset:3072 sc1
  s_waitcnt vmcnt(11)
  v_pk_fma_f16 v32, v32, v12, v13
  v_pk_fma_f16 v33, v33, v12, v13
  v_mfma_f32_32x32x16_f16 v[144:159], v[200:203], v[28:31], v[144:159]
  ds_read_b128 v[192:195], v2 offset:5120
  v_pk_fma_f16 v34, v34, v12, v13
  v_pk_fma_f16 v35, v35, v12, v13
  s_waitcnt lgkmcnt(2)
  v_pk_fma_f16 v32, v32, v224, v228
  v_mfma_f32_32x32x16_f16 v[160:175], v[204:207], v[28:31], v[160:175]
  ds_read_b128 v[196:199], v2 offset:33792
  v_pk_fma_f16 v33, v33, v225, v229
  v_pk_fma_f16 v34, v34, v226, v230
  v_pk_fma_f16 v35, v35, v227, v231
  ds_read_b128 v[232:235], v5 offset:1952
  ds_read_b128 v[236:239], v5 offset:2848
  v_mfma_f32_32x32x16_f16 v[128:143], v[208:211], v[32:35], v[128:143]
  ds_read_b128 v[200:203], v3 offset:59392
  s_add_u32 s62, s47, 16384
  buffer_load_dwordx4 v[80:83], v2, s[32:35], s62 offen offset:0 sc1
  s_waitcnt vmcnt(11)
  v_pk_fma_f16 v36, v36, v12, v13
  v_pk_fma_f16 v37, v37, v12, v13
  v_mfma_f32_32x32x16_f16 v[144:159], v[212:215], v[32:35], v[144:159]
  ds_read_b128 v[204:207], v2 offset:6144
  v_pk_fma_f16 v38, v38, v12, v13
  v_pk_fma_f16 v39, v39, v12, v13
  s_waitcnt lgkmcnt(2)
  v_pk_fma_f16 v36, v36, v232, v236
  v_mfma_f32_32x32x16_f16 v[160:175], v[216:219], v[32:35], v[160:175]
  ds_read_b128 v[208:211], v2 offset:34816
  v_pk_fma_f16 v37, v37, v233, v237
  v_pk_fma_f16 v38, v38, v234, v238
  v_pk_fma_f16 v39, v39, v235, v239
  ds_read_b128 v[224:227], v5 offset:1984
  ds_read_b128 v[228:231], v5 offset:2880
  v_mfma_f32_32x32x16_f16 v[128:143], v[220:223], v[36:39], v[128:143]
  ds_read_b128 v[212:215], v3 offset:60416
  buffer_load_dwordx4 v[84:87], v2, s[32:35], s62 offen offset:1024 sc1
  s_waitcnt vmcnt(11)
  v_pk_fma_f16 v40, v40, v12, v13
  v_pk_fma_f16 v41, v41, v12, v13
  v_mfma_f32_32x32x16_f16 v[144:159], v[192:195], v[36:39], v[144:159]
  ds_read_b128 v[216:219], v2 offset:7168
  v_pk_fma_f16 v42, v42, v12, v13
  v_pk_fma_f16 v43, v43, v12, v13
  s_waitcnt lgkmcnt(2)
  v_pk_fma_f16 v40, v40, v224, v228
  v_mfma_f32_32x32x16_f16 v[160:175], v[196:199], v[36:39], v[160:175]
  ds_read_b128 v[220:223], v2 offset:35840
  v_pk_fma_f16 v41, v41, v225, v229
  v_pk_fma_f16 v42, v42, v226, v230
  v_pk_fma_f16 v43, v43, v227, v231
  ds_read_b128 v[232:235], v5 offset:2016
  ds_read_b128 v[236:239], v5 offset:2912
  v_mfma_f32_32x32x16_f16 v[128:143], v[200:203], v[40:43], v[128:143]
  ds_read_b128 v[192:195], v3 offset:61440
  buffer_load_dwordx4 v[88:91], v2, s[32:35], s62 offen offset:2048 sc1
  s_waitcnt vmcnt(11)
  v_pk_fma_f16 v44, v44, v12, v13
  v_pk_fma_f16 v45, v45, v12, v13
  v_mfma_f32_32x32x16_f16 v[144:159], v[204:207], v[40:43], v[144:159]
  ds_read_b128 v[196:199], v2 offset:8192
  v_pk_fma_f16 v46, v46, v12, v13
  v_pk_fma_f16 v47, v47, v12, v13
  s_waitcnt lgkmcnt(2)
  v_pk_fma_f16 v44, v44, v232, v236
  v_mfma_f32_32x32x16_f16 v[160:175], v[208:211], v[40:43], v[160:175]
  ds_read_b128 v[200:203], v2 offset:36864
  v_pk_fma_f16 v45, v45, v233, v237
  v_pk_fma_f16 v46, v46, v234, v238
  v_pk_fma_f16 v47, v47, v235, v239
  ds_read_b128 v[224:227], v5 offset:2048
  ds_read_b128 v[228:231], v5 offset:2944
  v_mfma_f32_32x32x16_f16 v[128:143], v[212:215], v[44:47], v[128:143]
  ds_read_b128 v[204:207], v3 offset:62464
  buffer_load_dwordx4 v[92:95], v2, s[32:35], s62 offen offset:3072 sc1
  s_waitcnt vmcnt(11)
  v_pk_fma_f16 v48, v48, v12, v13
  v_pk_fma_f16 v49, v49, v12, v13
  v_mfma_f32_32x32x16_f16 v[144:159], v[216:219], v[44:47], v[144:159]
  ds_read_b128 v[208:211], v2 offset:9216
  v_pk_fma_f16 v50, v50, v12, v13
  v_pk_fma_f16 v51, v51, v12, v13
  s_waitcnt lgkmcnt(2)
  v_pk_fma_f16 v48, v48, v224, v228
  v_mfma_f32_32x32x16_f16 v[160:175], v[220:223], v[44:47], v[160:175]
  ds_read_b128 v[212:215], v2 offset:37888
  v_pk_fma_f16 v49, v49, v225, v229
  v_pk_fma_f16 v50, v50, v226, v230
  v_pk_fma_f16 v51, v51, v227, v231
  ds_read_b128 v[232:235], v5 offset:2080
  ds_read_b128 v[236:239], v5 offset:2976
  v_mfma_f32_32x32x16_f16 v[128:143], v[192:195], v[48:51], v[128:143]
  ds_read_b128 v[216:219], v3 offset:63488
  s_add_u32 s62, s47, 20480
  buffer_load_dwordx4 v[96:99], v2, s[32:35], s62 offen offset:0 sc1
  s_waitcnt vmcnt(11)
  v_pk_fma_f16 v52, v52, v12, v13
  v_pk_fma_f16 v53, v53, v12, v13
  v_mfma_f32_32x32x16_f16 v[144:159], v[196:199], v[48:51], v[144:159]
  ds_read_b128 v[220:223], v2 offset:10240
  v_pk_fma_f16 v54, v54, v12, v13
  v_pk_fma_f16 v55, v55, v12, v13
  s_waitcnt lgkmcnt(2)
  v_pk_fma_f16 v52, v52, v232, v236
  v_mfma_f32_32x32x16_f16 v[160:175], v[200:203], v[48:51], v[160:175]
  ds_read_b128 v[192:195], v2 offset:38912
  v_pk_fma_f16 v53, v53, v233, v237
  v_pk_fma_f16 v54, v54, v234, v238
  v_pk_fma_f16 v55, v55, v235, v239
  ds_read_b128 v[224:227], v5 offset:2112
  ds_read_b128 v[228:231], v5 offset:3008
  v_mfma_f32_32x32x16_f16 v[128:143], v[204:207], v[52:55], v[128:143]
  ds_read_b128 v[196:199], v3 offset:64512
  buffer_load_dwordx4 v[100:103], v2, s[32:35], s62 offen offset:1024 sc1
  s_waitcnt vmcnt(11)
  v_pk_fma_f16 v56, v56, v12, v13
  v_pk_fma_f16 v57, v57, v12, v13
  v_mfma_f32_32x32x16_f16 v[144:159], v[208:211], v[52:55], v[144:159]
  ds_read_b128 v[200:203], v2 offset:11264
  v_pk_fma_f16 v58, v58, v12, v13
  v_pk_fma_f16 v59, v59, v12, v13
  s_waitcnt lgkmcnt(2)
  v_pk_fma_f16 v56, v56, v224, v228
  v_mfma_f32_32x32x16_f16 v[160:175], v[212:215], v[52:55], v[160:175]
  ds_read_b128 v[204:207], v2 offset:39936
  v_pk_fma_f16 v57, v57, v225, v229
  v_pk_fma_f16 v58, v58, v226, v230
  v_pk_fma_f16 v59, v59, v227, v231
  ds_read_b128 v[232:235], v5 offset:2144
  ds_read_b128 v[236:239], v5 offset:3040
  v_mfma_f32_32x32x16_f16 v[128:143], v[216:219], v[56:59], v[128:143]
  ds_read_b128 v[208:211], v4 offset:0
  buffer_load_dwordx4 v[104:107], v2, s[32:35], s62 offen offset:2048 sc1
  s_waitcnt vmcnt(11)
  v_pk_fma_f16 v60, v60, v12, v13
  v_pk_fma_f16 v61, v61, v12, v13
  v_mfma_f32_32x32x16_f16 v[144:159], v[220:223], v[56:59], v[144:159]
  ds_read_b128 v[212:215], v2 offset:12288
  v_pk_fma_f16 v62, v62, v12, v13
  v_pk_fma_f16 v63, v63, v12, v13
  s_waitcnt lgkmcnt(2)
  v_pk_fma_f16 v60, v60, v232, v236
  v_mfma_f32_32x32x16_f16 v[160:175], v[192:195], v[56:59], v[160:175]
  ds_read_b128 v[216:219], v2 offset:40960
  v_pk_fma_f16 v61, v61, v233, v237
  v_pk_fma_f16 v62, v62, v234, v238
  v_pk_fma_f16 v63, v63, v235, v239
  ds_read_b128 v[224:227], v5 offset:2176
  ds_read_b128 v[228:231], v5 offset:3072
  v_mfma_f32_32x32x16_f16 v[128:143], v[196:199], v[60:63], v[128:143]
  ds_read_b128 v[220:223], v4 offset:1024
  buffer_load_dwordx4 v[108:111], v2, s[32:35], s62 offen offset:3072 sc1
  s_waitcnt vmcnt(11)
  v_pk_fma_f16 v64, v64, v12, v13
  v_pk_fma_f16 v65, v65, v12, v13
  v_mfma_f32_32x32x16_f16 v[144:159], v[200:203], v[60:63], v[144:159]
  ds_read_b128 v[192:195], v2 offset:13312
  v_pk_fma_f16 v66, v66, v12, v13
  v_pk_fma_f16 v67, v67, v12, v13
  s_waitcnt lgkmcnt(2)
  v_pk_fma_f16 v64, v64, v224, v228
  v_mfma_f32_32x32x16_f16 v[160:175], v[204:207], v[60:63], v[160:175]
  ds_read_b128 v[196:199], v2 offset:41984
  v_pk_fma_f16 v65, v65, v225, v229
  v_pk_fma_f16 v66, v66, v226, v230
  v_pk_fma_f16 v67, v67, v227, v231
  ds_read_b128 v[232:235], v5 offset:2208
  ds_read_b128 v[236:239], v5 offset:3104
  v_mfma_f32_32x32x16_f16 v[128:143], v[208:211], v[64:67], v[128:143]
  ds_read_b128 v[200:203], v4 offset:2048
  s_add_u32 s62, s47, 24576
  buffer_load_dwordx4 v[112:115], v2, s[32:35], s62 offen offset:0 sc1
  s_waitcnt vmcnt(11)
  v_pk_fma_f16 v68, v68, v12, v13
  v_pk_fma_f16 v69, v69, v12, v13
  v_mfma_f32_32x32x16_f16 v[144:159], v[212:215], v[64:67], v[144:159]
  ds_read_b128 v[204:207], v2 offset:14336
  v_pk_fma_f16 v70, v70, v12, v13
  v_pk_fma_f16 v71, v71, v12, v13
  s_waitcnt lgkmcnt(2)
  v_pk_fma_f16 v68, v68, v232, v236
  v_mfma_f32_32x32x16_f16 v[160:175], v[216:219], v[64:67], v[160:175]
  ds_read_b128 v[208:211], v2 offset:43008
  v_pk_fma_f16 v69, v69, v233, v237
  v_pk_fma_f16 v70, v70, v234, v238
  v_pk_fma_f16 v71, v71, v235, v239
  ds_read_b128 v[224:227], v5 offset:2240
  ds_read_b128 v[228:231], v5 offset:3136
  v_mfma_f32_32x32x16_f16 v[128:143], v[220:223], v[68:71], v[128:143]
  ds_read_b128 v[212:215], v4 offset:3072
  buffer_load_dwordx4 v[116:119], v2, s[32:35], s62 offen offset:1024 sc1
  s_waitcnt vmcnt(11)
  v_pk_fma_f16 v72, v72, v12, v13
  v_pk_fma_f16 v73, v73, v12, v13
  v_mfma_f32_32x32x16_f16 v[144:159], v[192:195], v[68:71], v[144:159]
  ds_read_b128 v[216:219], v2 offset:15360
  v_pk_fma_f16 v74, v74, v12, v13
  v_pk_fma_f16 v75, v75, v12, v13
  s_waitcnt lgkmcnt(2)
  v_pk_fma_f16 v72, v72, v224, v228
  v_mfma_f32_32x32x16_f16 v[160:175], v[196:199], v[68:71], v[160:175]
  ds_read_b128 v[220:223], v2 offset:44032
  v_pk_fma_f16 v73, v73, v225, v229
  v_pk_fma_f16 v74, v74, v226, v230
  v_pk_fma_f16 v75, v75, v227, v231
  ds_read_b128 v[232:235], v5 offset:2272
  ds_read_b128 v[236:239], v5 offset:3168
  v_mfma_f32_32x32x16_f16 v[128:143], v[200:203], v[72:75], v[128:143]
  ds_read_b128 v[192:195], v4 offset:4096
  buffer_load_dwordx4 v[120:123], v2, s[32:35], s62 offen offset:2048 sc1
  s_waitcnt vmcnt(11)
  v_pk_fma_f16 v76, v76, v12, v13
  v_pk_fma_f16 v77, v77, v12, v13
  v_mfma_f32_32x32x16_f16 v[144:159], v[204:207], v[72:75], v[144:159]
  ds_read_b128 v[196:199], v2 offset:16384
  v_pk_fma_f16 v78, v78, v12, v13
  v_pk_fma_f16 v79, v79, v12, v13
  s_waitcnt lgkmcnt(2)
  v_pk_fma_f16 v76, v76, v232, v236
  v_mfma_f32_32x32x16_f16 v[160:175], v[208:211], v[72:75], v[160:175]
  ds_read_b128 v[200:203], v2 offset:45056
  v_pk_fma_f16 v77, v77, v233, v237
  v_pk_fma_f16 v78, v78, v234, v238
  v_pk_fma_f16 v79, v79, v235, v239
  ds_read_b128 v[224:227], v5 offset:2304
  ds_read_b128 v[228:231], v5 offset:3200
  v_mfma_f32_32x32x16_f16 v[128:143], v[212:215], v[76:79], v[128:143]
  ds_read_b128 v[204:207], v4 offset:5120
  buffer_load_dwordx4 v[124:127], v2, s[32:35], s62 offen offset:3072 sc1
  s_waitcnt vmcnt(11)
  v_pk_fma_f16 v80, v80, v12, v13
  v_pk_fma_f16 v81, v81, v12, v13
  v_mfma_f32_32x32x16_f16 v[144:159], v[216:219], v[76:79], v[144:159]
  ds_read_b128 v[208:211], v2 offset:17408
  v_pk_fma_f16 v82, v82, v12, v13
  v_pk_fma_f16 v83, v83, v12, v13
  s_waitcnt lgkmcnt(2)
  v_pk_fma_f16 v80, v80, v224, v228
  v_mfma_f32_32x32x16_f16 v[160:175], v[220:223], v[76:79], v[160:175]
  ds_read_b128 v[212:215], v2 offset:46080
  v_pk_fma_f16 v81, v81, v225, v229
  v_pk_fma_f16 v82, v82, v226, v230
  v_pk_fma_f16 v83, v83, v227, v231
  ds_read_b128 v[232:235], v5 offset:2336
  ds_read_b128 v[236:239], v5 offset:3232
  v_mfma_f32_32x32x16_f16 v[128:143], v[192:195], v[80:83], v[128:143]
  ds_read_b128 v[216:219], v4 offset:6144
  buffer_load_dwordx4 a[136:139], v2, s[32:35], s53 offen offset:2048 sc1
  s_waitcnt vmcnt(11)
  v_pk_fma_f16 v84, v84, v12, v13
  v_pk_fma_f16 v85, v85, v12, v13
  v_mfma_f32_32x32x16_f16 v[144:159], v[196:199], v[80:83], v[144:159]
  ds_read_b128 v[220:223], v2 offset:18432
  v_pk_fma_f16 v86, v86, v12, v13
  v_pk_fma_f16 v87, v87, v12, v13
  s_waitcnt lgkmcnt(2)
  v_pk_fma_f16 v84, v84, v232, v236
  v_mfma_f32_32x32x16_f16 v[160:175], v[200:203], v[80:83], v[160:175]
  ds_read_b128 v[192:195], v2 offset:47104
  buffer_load_dwordx4 a[140:143], v2, s[32:35], s53 offen offset:3072 sc1
  v_pk_fma_f16 v85, v85, v233, v237
  v_pk_fma_f16 v86, v86, v234, v238
  v_pk_fma_f16 v87, v87, v235, v239
  ds_read_b128 v[224:227], v5 offset:2368
  ds_read_b128 v[228:231], v5 offset:3264
  v_mfma_f32_32x32x16_f16 v[128:143], v[204:207], v[84:87], v[128:143]
  ds_read_b128 v[196:199], v4 offset:7168
  s_add_u32 s64, s53, 4096
  buffer_load_dwordx4 a[144:147], v2, s[32:35], s64 offen offset:0 sc1
  s_waitcnt vmcnt(12)
  v_pk_fma_f16 v88, v88, v12, v13
  v_pk_fma_f16 v89, v89, v12, v13
  v_mfma_f32_32x32x16_f16 v[144:159], v[208:211], v[84:87], v[144:159]
  ds_read_b128 v[200:203], v2 offset:19456
  v_pk_fma_f16 v90, v90, v12, v13
  v_pk_fma_f16 v91, v91, v12, v13
  s_waitcnt lgkmcnt(2)
  v_pk_fma_f16 v88, v88, v224, v228
  v_mfma_f32_32x32x16_f16 v[160:175], v[212:215], v[84:87], v[160:175]
  ds_read_b128 v[204:207], v2 offset:48128
  buffer_load_dwordx4 a[148:151], v2, s[32:35], s64 offen offset:1024 sc1
  v_pk_fma_f16 v89, v89, v225, v229
  v_pk_fma_f16 v90, v90, v226, v230
  v_pk_fma_f16 v91, v91, v227, v231
  ds_read_b128 v[232:235], v5 offset:2400
  ds_read_b128 v[236:239], v5 offset:3296
  v_mfma_f32_32x32x16_f16 v[128:143], v[216:219], v[88:91], v[128:143]
  ds_read_b128 v[208:211], v4 offset:8192
  buffer_load_dwordx4 a[152:155], v2, s[32:35], s64 offen offset:2048 sc1
  s_waitcnt vmcnt(13)
  v_pk_fma_f16 v92, v92, v12, v13
  v_pk_fma_f16 v93, v93, v12, v13
  v_mfma_f32_32x32x16_f16 v[144:159], v[220:223], v[88:91], v[144:159]
  ds_read_b128 v[212:215], v2 offset:20480
  v_pk_fma_f16 v94, v94, v12, v13
  v_pk_fma_f16 v95, v95, v12, v13
  s_waitcnt lgkmcnt(2)
  v_pk_fma_f16 v92, v92, v232, v236
  v_mfma_f32_32x32x16_f16 v[160:175], v[192:195], v[88:91], v[160:175]
  ds_read_b128 v[216:219], v2 offset:49152
  buffer_load_dwordx4 a[156:159], v2, s[32:35], s64 offen offset:3072 sc1
  v_pk_fma_f16 v93, v93, v233, v237
  v_pk_fma_f16 v94, v94, v234, v238
  v_pk_fma_f16 v95, v95, v235, v239
  ds_read_b128 v[224:227], v5 offset:2432
  ds_read_b128 v[228:231], v5 offset:3328
  v_mfma_f32_32x32x16_f16 v[128:143], v[196:199], v[92:95], v[128:143]
  ds_read_b128 v[220:223], v4 offset:9216
  s_add_u32 s64, s53, 8192
  buffer_load_dwordx4 a[160:163], v2, s[32:35], s64 offen offset:0 sc1
  s_waitcnt vmcnt(14)
  v_pk_fma_f16 v96, v96, v12, v13
  v_pk_fma_f16 v97, v97, v12, v13
  v_mfma_f32_32x32x16_f16 v[144:159], v[200:203], v[92:95], v[144:159]
  ds_read_b128 v[192:195], v2 offset:21504
  v_pk_fma_f16 v98, v98, v12, v13
  v_pk_fma_f16 v99, v99, v12, v13
  s_waitcnt lgkmcnt(2)
  v_pk_fma_f16 v96, v96, v224, v228
  v_mfma_f32_32x32x16_f16 v[160:175], v[204:207], v[92:95], v[160:175]
  ds_read_b128 v[196:199], v2 offset:50176
  buffer_load_dwordx4 a[164:167], v2, s[32:35], s64 offen offset:1024 sc1
  v_pk_fma_f16 v97, v97, v225, v229
  v_pk_fma_f16 v98, v98, v226, v230
  v_pk_fma_f16 v99, v99, v227, v231
  ds_read_b128 v[232:235], v5 offset:2464
  ds_read_b128 v[236:239], v5 offset:3360
  v_mfma_f32_32x32x16_f16 v[128:143], v[208:211], v[96:99], v[128:143]
  ds_read_b128 v[200:203], v4 offset:10240
  buffer_load_dwordx4 a[168:171], v2, s[32:35], s64 offen offset:2048 sc1
  s_waitcnt vmcnt(15)
  v_pk_fma_f16 v100, v100, v12, v13
  v_pk_fma_f16 v101, v101, v12, v13
  v_mfma_f32_32x32x16_f16 v[144:159], v[212:215], v[96:99], v[144:159]
  ds_read_b128 v[204:207], v2 offset:22528
  v_pk_fma_f16 v102, v102, v12, v13
  v_pk_fma_f16 v103, v103, v12, v13
  s_waitcnt lgkmcnt(2)
  v_pk_fma_f16 v100, v100, v232, v236
  v_mfma_f32_32x32x16_f16 v[160:175], v[216:219], v[96:99], v[160:175]
  ds_read_b128 v[208:211], v2 offset:51200
  buffer_load_dwordx4 a[172:175], v2, s[32:35], s64 offen offset:3072 sc1
  v_pk_fma_f16 v101, v101, v233, v237
  v_pk_fma_f16 v102, v102, v234, v238
  v_pk_fma_f16 v103, v103, v235, v239
  ds_read_b128 v[224:227], v5 offset:2496
  ds_read_b128 v[228:231], v5 offset:3392
  v_mfma_f32_32x32x16_f16 v[128:143], v[220:223], v[100:103], v[128:143]
  ds_read_b128 v[212:215], v4 offset:11264
  s_add_u32 s64, s53, 12288
  buffer_load_dwordx4 a[176:179], v2, s[32:35], s64 offen offset:0 sc1
  s_waitcnt vmcnt(16)
  v_pk_fma_f16 v104, v104, v12, v13
  v_pk_fma_f16 v105, v105, v12, v13
  v_mfma_f32_32x32x16_f16 v[144:159], v[192:195], v[100:103], v[144:159]
  ds_read_b128 v[216:219], v2 offset:23552
  v_pk_fma_f16 v106, v106, v12, v13
  v_pk_fma_f16 v107, v107, v12, v13
  s_waitcnt lgkmcnt(2)
  v_pk_fma_f16 v104, v104, v224, v228
  v_mfma_f32_32x32x16_f16 v[160:175], v[196:199], v[100:103], v[160:175]
  ds_read_b128 v[220:223], v2 offset:52224
  buffer_load_dwordx4 a[180:183], v2, s[32:35], s64 offen offset:1024 sc1
  v_pk_fma_f16 v105, v105, v225, v229
  v_pk_fma_f16 v106, v106, v226, v230
  v_pk_fma_f16 v107, v107, v227, v231
  ds_read_b128 v[232:235], v5 offset:2528
  ds_read_b128 v[236:239], v5 offset:3424
  v_mfma_f32_32x32x16_f16 v[128:143], v[200:203], v[104:107], v[128:143]
  ds_read_b128 v[192:195], v4 offset:12288
  buffer_load_dwordx4 a[184:187], v2, s[32:35], s64 offen offset:2048 sc1
  s_waitcnt vmcnt(17)
  v_pk_fma_f16 v108, v108, v12, v13
  v_pk_fma_f16 v109, v109, v12, v13
  v_mfma_f32_32x32x16_f16 v[144:159], v[204:207], v[104:107], v[144:159]
  ds_read_b128 v[196:199], v2 offset:24576
  v_pk_fma_f16 v110, v110, v12, v13
  v_pk_fma_f16 v111, v111, v12, v13
  s_waitcnt lgkmcnt(2)
  v_pk_fma_f16 v108, v108, v232, v236
  v_mfma_f32_32x32x16_f16 v[160:175], v[208:211], v[104:107], v[160:175]
  ds_read_b128 v[200:203], v2 offset:53248
  buffer_load_dwordx4 a[188:191], v2, s[32:35], s64 offen offset:3072 sc1
  v_pk_fma_f16 v109, v109, v233, v237
  v_pk_fma_f16 v110, v110, v234, v238
  v_pk_fma_f16 v111, v111, v235, v239
  ds_read_b128 v[224:227], v5 offset:2560
  ds_read_b128 v[228:231], v5 offset:3456
  v_mfma_f32_32x32x16_f16 v[128:143], v[212:215], v[108:111], v[128:143]
  ds_read_b128 v[204:207], v4 offset:13312
  s_add_u32 s64, s53, 16384
  buffer_load_dwordx4 a[192:195], v2, s[32:35], s64 offen offset:0 sc1
  s_waitcnt vmcnt(18)
  v_pk_fma_f16 v112, v112, v12, v13
  v_pk_fma_f16 v113, v113, v12, v13
  v_mfma_f32_32x32x16_f16 v[144:159], v[216:219], v[108:111], v[144:159]
  ds_read_b128 v[208:211], v2 offset:25600
  v_pk_fma_f16 v114, v114, v12, v13
  v_pk_fma_f16 v115, v115, v12, v13
  s_waitcnt lgkmcnt(2)
  v_pk_fma_f16 v112, v112, v224, v228
  v_mfma_f32_32x32x16_f16 v[160:175], v[220:223], v[108:111], v[160:175]
  ds_read_b128 v[212:215], v2 offset:54272
  buffer_load_dwordx4 a[196:199], v2, s[32:35], s64 offen offset:1024 sc1
  v_pk_fma_f16 v113, v113, v225, v229
  v_pk_fma_f16 v114, v114, v226, v230
  v_pk_fma_f16 v115, v115, v227, v231
  ds_read_b128 v[232:235], v5 offset:2592
  ds_read_b128 v[236:239], v5 offset:3488
  v_mfma_f32_32x32x16_f16 v[128:143], v[192:195], v[112:115], v[128:143]
  ds_read_b128 v[216:219], v4 offset:14336
  buffer_load_dwordx4 a[200:203], v2, s[32:35], s64 offen offset:2048 sc1
  s_waitcnt vmcnt(19)
  v_pk_fma_f16 v116, v116, v12, v13
  v_pk_fma_f16 v117, v117, v12, v13
  v_mfma_f32_32x32x16_f16 v[144:159], v[196:199], v[112:115], v[144:159]
  ds_read_b128 v[220:223], v2 offset:26624
  v_pk_fma_f16 v118, v118, v12, v13
  v_pk_fma_f16 v119, v119, v12, v13
  s_waitcnt lgkmcnt(2)
  v_pk_fma_f16 v116, v116, v232, v236
  v_mfma_f32_32x32x16_f16 v[160:175], v[200:203], v[112:115], v[160:175]
  ds_read_b128 v[192:195], v2 offset:55296
  buffer_load_dwordx4 a[204:207], v2, s[32:35], s64 offen offset:3072 sc1
  v_pk_fma_f16 v117, v117, v233, v237
  v_pk_fma_f16 v118, v118, v234, v238
  v_pk_fma_f16 v119, v119, v235, v239
  ds_read_b128 v[224:227], v5 offset:2624
  ds_read_b128 v[228:231], v5 offset:3520
  v_mfma_f32_32x32x16_f16 v[128:143], v[204:207], v[116:119], v[128:143]
  ds_read_b128 v[196:199], v4 offset:15360
  s_add_u32 s64, s53, 20480
  buffer_load_dwordx4 a[208:211], v2, s[32:35], s64 offen offset:0 sc1
  s_waitcnt vmcnt(20)
  v_pk_fma_f16 v120, v120, v12, v13
  v_pk_fma_f16 v121, v121, v12, v13
  v_mfma_f32_32x32x16_f16 v[144:159], v[208:211], v[116:119], v[144:159]
  ds_read_b128 v[200:203], v2 offset:27648
  v_pk_fma_f16 v122, v122, v12, v13
  v_pk_fma_f16 v123, v123, v12, v13
  s_waitcnt lgkmcnt(2)
  v_pk_fma_f16 v120, v120, v224, v228
  v_mfma_f32_32x32x16_f16 v[160:175], v[212:215], v[116:119], v[160:175]
  ds_read_b128 v[204:207], v2 offset:56320
  buffer_load_dwordx4 a[212:215], v2, s[32:35], s64 offen offset:1024 sc1
  v_pk_fma_f16 v121, v121, v225, v229
  v_pk_fma_f16 v122, v122, v226, v230
  v_pk_fma_f16 v123, v123, v227, v231
  ds_read_b128 v[232:235], v5 offset:2656
  ds_read_b128 v[236:239], v5 offset:3552
  v_mfma_f32_32x32x16_f16 v[128:143], v[216:219], v[120:123], v[128:143]
  buffer_load_dwordx4 a[216:219], v2, s[32:35], s64 offen offset:2048 sc1
  s_waitcnt vmcnt(21)
  v_pk_fma_f16 v124, v124, v12, v13
  v_pk_fma_f16 v125, v125, v12, v13
  v_mfma_f32_32x32x16_f16 v[144:159], v[220:223], v[120:123], v[144:159]
  v_pk_fma_f16 v126, v126, v12, v13
  v_pk_fma_f16 v127, v127, v12, v13
  s_waitcnt lgkmcnt(0)
  v_pk_fma_f16 v124, v124, v232, v236
  v_mfma_f32_32x32x16_f16 v[160:175], v[192:195], v[120:123], v[160:175]
  buffer_load_dwordx4 a[220:223], v2, s[32:35], s64 offen offset:3072 sc1
  v_pk_fma_f16 v125, v125, v233, v237
  v_pk_fma_f16 v126, v126, v234, v238
  v_pk_fma_f16 v127, v127, v235, v239
  s_nop 1
  v_mfma_f32_32x32x16_f16 v[128:143], v[196:199], v[124:127], v[128:143]
  s_add_u32 s64, s53, 24576
  buffer_load_dwordx4 a[224:227], v2, s[32:35], s64 offen offset:0 sc1
  v_mfma_f32_32x32x16_f16 v[144:159], v[200:203], v[124:127], v[144:159]
  v_mfma_f32_32x32x16_f16 v[160:175], v[204:207], v[124:127], v[160:175]
  buffer_load_dwordx4 a[228:231], v2, s[32:35], s64 offen offset:1024 sc1
  s_mov_b32 s22, 0xfff8fff8
  s_mov_b32 s23, 0x00070007
  v_and_b32 v14, 3, v1
  v_lshlrev_b32 v14, 3, v14
  v_lshrrev_b32 v14, v14, v8
  v_bfi_b32 v14, 1, v8, v14
  v_lshlrev_b32 v9, 1, v1
  v_bfi_b32 v14, 2, v9, v14
  v_and_b32 v14, 63, v14
  v_lshl_or_b32 v14, v14, 13, v14
  v_and_b32 v14, s23, v14
  s_barrier
  ds_read_b128 v[208:211], v2 offset:57344
  ds_read_b128 v[212:215], v2 offset:58368
  ds_read_b128 v[216:219], v2 offset:59392
  ds_read_b128 v[220:223], v2 offset:60416
  ds_read_b128 v[192:195], v2 offset:61440
  ds_read_b128 v[196:199], v2 offset:62464
  s_waitcnt lgkmcnt(4)
  v_mfma_f32_32x32x16_f16 v[176:191], v[208:211], v[16:19], 0
  ds_read_b128 v[200:203], v2 offset:63488
  v_cvt_pk_f16_f32 v128, v128, v129
  v_cvt_pk_f16_f32 v129, v130, v131
  v_cvt_pk_f16_f32 v130, v132, v133
  v_cvt_pk_f16_f32 v131, v134, v135
  v_mfma_f32_32x32x16_f16 v[176:191], v[212:215], v[20:23], v[176:191]
  ds_read_b128 v[204:207], v2 offset:64512
  s_add_u32 m0, s51, 118784
  s_add_u32 s65, s50, 143360
  buffer_load_dwordx4 v2, s[32:35], s65 offen sc1 lds
  v_pk_mul_f16 v240, v128, v128
  s_waitcnt lgkmcnt(4)
  v_mfma_f32_32x32x16_f16 v[176:191], v[216:219], v[24:27], v[176:191]
  ds_read_b128 v[208:211], v3 offset:0
  v_pk_mul_f16 v241, v129, v129
  v_pk_mul_f16 v242, v130, v130
  v_pk_mul_f16 v243, v131, v131
  v_pk_fma_f16 v240, v240, s26, v11
  v_mfma_f32_32x32x16_f16 v[176:191], v[220:223], v[28:31], v[176:191]
  ds_read_b128 v[212:215], v3 offset:1024
  s_add_u32 m0, s51, 122880
  s_add_u32 s65, s50, 147456
  buffer_load_dwordx4 v2, s[32:35], s65 offen sc1 lds
  v_pk_fma_f16 v241, v241, s26, v11
  s_waitcnt lgkmcnt(4)
  v_mfma_f32_32x32x16_f16 v[176:191], v[192:195], v[32:35], v[176:191]
  ds_read_b128 v[216:219], v3 offset:2048
  v_pk_fma_f16 v242, v242, s26, v11
  v_pk_fma_f16 v243, v243, s26, v11
  v_pk_mul_f16 v240, v240, v128
  v_pk_mul_f16 v241, v241, v129
  v_mfma_f32_32x32x16_f16 v[176:191], v[196:199], v[36:39], v[176:191]
  ds_read_b128 v[220:223], v3 offset:3072
  s_add_u32 m0, s51, 126976
  s_add_u32 s65, s50, 151552
  buffer_load_dwordx4 v2, s[32:35], s65 offen sc1 lds
  v_pk_mul_f16 v242, v242, v130
  s_waitcnt lgkmcnt(4)
  v_mfma_f32_32x32x16_f16 v[176:191], v[200:203], v[40:43], v[176:191]
  ds_read_b128 v[192:195], v3 offset:4096
  v_pk_mul_f16 v243, v243, v131
  v_exp_f16_sdwa v240, v240 dst_sel:WORD_0 dst_unused:UNUSED_PRESERVE src0_sel:WORD_0
  v_cvt_pk_f16_f32 v136, v136, v137
  v_mfma_f32_32x32x16_f16 v[176:191], v[204:207], v[44:47], v[176:191]
  ds_read_b128 v[196:199], v3 offset:5120
  s_add_u32 m0, s51, 131072
  s_add_u32 s65, s50, 155648
  buffer_load_dwordx4 v2, s[32:35], s65 offen sc1 lds
  s_waitcnt lgkmcnt(4)
  v_mfma_f32_32x32x16_f16 v[176:191], v[208:211], v[48:51], v[176:191]
  ds_read_b128 v[200:203], v3 offset:6144
  v_exp_f16_sdwa v241, v241 dst_sel:WORD_0 dst_unused:UNUSED_PRESERVE src0_sel:WORD_0
  v_cvt_pk_f16_f32 v137, v138, v139
  v_mfma_f32_32x32x16_f16 v[176:191], v[212:215], v[52:55], v[176:191]
  ds_read_b128 v[204:207], v3 offset:7168
  s_add_u32 m0, s51, 135168
  s_add_u32 s65, s50, 159744
  buffer_load_dwordx4 v2, s[32:35], s65 offen sc1 lds
  s_waitcnt lgkmcnt(4)
  v_mfma_f32_32x32x16_f16 v[176:191], v[216:219], v[56:59], v[176:191]
  ds_read_b128 v[208:211], v3 offset:8192
  v_exp_f16_sdwa v242, v242 dst_sel:WORD_0 dst_unused:UNUSED_PRESERVE src0_sel:WORD_0
  v_cvt_pk_f16_f32 v138, v140, v141
  v_mfma_f32_32x32x16_f16 v[176:191], v[220:223], v[60:63], v[176:191]
  ds_read_b128 v[212:215], v3 offset:9216
  s_add_u32 m0, s51, 139264
  s_add_u32 s65, s50, 163840
  buffer_load_dwordx4 v2, s[32:35], s65 offen sc1 lds
  s_waitcnt lgkmcnt(4)
  v_mfma_f32_32x32x16_f16 v[176:191], v[192:195], v[64:67], v[176:191]
  ds_read_b128 v[216:219], v3 offset:10240
  v_exp_f16_sdwa v243, v243 dst_sel:WORD_0 dst_unused:UNUSED_PRESERVE src0_sel:WORD_0
  v_cvt_pk_f16_f32 v139, v142, v143
  v_mfma_f32_32x32x16_f16 v[176:191], v[196:199], v[68:71], v[176:191]
  ds_read_b128 v[220:223], v3 offset:11264
  s_add_u32 m0, s51, 143360
  s_add_u32 s65, s50, 167936
  buffer_load_dwordx4 v2, s[32:35], s65 offen sc1 lds
  s_waitcnt lgkmcnt(4)
  v_mfma_f32_32x32x16_f16 v[176:191], v[200:203], v[72:75], v[176:191]
  ds_read_b128 v[192:195], v3 offset:12288
  v_exp_f16_sdwa v240, v240 dst_sel:WORD_1 dst_unused:UNUSED_PRESERVE src0_sel:WORD_1
  v_pk_mul_f16 v128, v128, v136
  v_mfma_f32_32x32x16_f16 v[176:191], v[204:207], v[76:79], v[176:191]
  ds_read_b128 v[196:199], v3 offset:13312
  s_add_u32 m0, s51, 0
  s_add_u32 s65, s50, 172032
  buffer_load_dwordx4 v2, s[32:35], s65 offen sc1 lds
  s_waitcnt lgkmcnt(4)
  v_mfma_f32_32x32x16_f16 v[176:191], v[208:211], v[80:83], v[176:191]
  ds_read_b128 v[200:203], v3 offset:14336
  v_exp_f16_sdwa v241, v241 dst_sel:WORD_1 dst_unused:UNUSED_PRESERVE src0_sel:WORD_1
  v_pk_mul_f16 v129, v129, v137
  v_mfma_f32_32x32x16_f16 v[176:191], v[212:215], v[84:87], v[176:191]
  ds_read_b128 v[204:207], v3 offset:15360
  s_add_u32 m0, s51, 4096
  s_add_u32 s65, s50, 176128
  buffer_load_dwordx4 v2, s[32:35], s65 offen sc1 lds
  s_waitcnt lgkmcnt(4)
  v_mfma_f32_32x32x16_f16 v[176:191], v[216:219], v[88:91], v[176:191]
  ds_read_b128 v[208:211], v3 offset:16384
  v_exp_f16_sdwa v242, v242 dst_sel:WORD_1 dst_unused:UNUSED_PRESERVE src0_sel:WORD_1
  v_pk_mul_f16 v130, v130, v138
  v_mfma_f32_32x32x16_f16 v[176:191], v[220:223], v[92:95], v[176:191]
  ds_read_b128 v[212:215], v3 offset:17408
  s_add_u32 m0, s51, 8192
  s_add_u32 s65, s50, 180224
  buffer_load_dwordx4 v2, s[32:35], s65 offen sc1 lds
  s_waitcnt lgkmcnt(4)
  v_mfma_f32_32x32x16_f16 v[176:191], v[192:195], v[96:99], v[176:191]
  ds_read_b128 v[216:219], v3 offset:18432
  v_exp_f16_sdwa v243, v243 dst_sel:WORD_1 dst_unused:UNUSED_PRESERVE src0_sel:WORD_1
  v_pk_mul_f16 v131, v131, v139
  v_pk_add_f16 v240, v240, s27
  v_mfma_f32_32x32x16_f16 v[176:191], v[196:199], v[100:103], v[176:191]
  ds_read_b128 v[220:223], v3 offset:19456
  s_add_u32 m0, s51, 12288
  s_add_u32 s65, s50, 184320
  buffer_load_dwordx4 v2, s[32:35], s65 offen sc1 lds
  v_pk_add_f16 v241, v241, s27
  s_waitcnt lgkmcnt(4)
  v_mfma_f32_32x32x16_f16 v[176:191], v[200:203], v[104:107], v[176:191]
  ds_read_b128 v[192:195], v3 offset:20480
  v_pk_add_f16 v242, v242, s27
  v_pk_add_f16 v243, v243, s27
  v_rcp_f16_sdwa v240, v240 dst_sel:WORD_0 dst_unused:UNUSED_PRESERVE src0_sel:WORD_0
  v_mfma_f32_32x32x16_f16 v[176:191], v[204:207], v[108:111], v[176:191]
  ds_read_b128 v[196:199], v3 offset:21504
  s_add_u32 m0, s51, 16384
  s_add_u32 s65, s50, 188416
  buffer_load_dwordx4 v2, s[32:35], s65 offen sc1 lds
  s_waitcnt lgkmcnt(4)
  v_mfma_f32_32x32x16_f16 v[176:191], v[208:211], v[112:115], v[176:191]
  ds_read_b128 v[200:203], v3 offset:22528
  v_rcp_f16_sdwa v241, v241 dst_sel:WORD_0 dst_unused:UNUSED_PRESERVE src0_sel:WORD_0
  v_rcp_f16_sdwa v242, v242 dst_sel:WORD_0 dst_unused:UNUSED_PRESERVE src0_sel:WORD_0
  v_mfma_f32_32x32x16_f16 v[176:191], v[212:215], v[116:119], v[176:191]
  ds_read_b128 v[204:207], v3 offset:23552
  s_add_u32 m0, s51, 20480
  s_add_u32 s65, s50, 192512
  buffer_load_dwordx4 v2, s[32:35], s65 offen sc1 lds
  s_waitcnt lgkmcnt(4)
  v_mfma_f32_32x32x16_f16 v[176:191], v[216:219], v[120:123], v[176:191]
  ds_read_b128 v[208:211], v3 offset:24576
  v_rcp_f16_sdwa v243, v243 dst_sel:WORD_0 dst_unused:UNUSED_PRESERVE src0_sel:WORD_0
  v_rcp_f16_sdwa v240, v240 dst_sel:WORD_1 dst_unused:UNUSED_PRESERVE src0_sel:WORD_1
  v_mfma_f32_32x32x16_f16 v[176:191], v[220:223], v[124:127], v[176:191]
  ds_read_b128 v[212:215], v3 offset:25600
  s_add_u32 m0, s51, 24576
  s_add_u32 s65, s50, 196608
  buffer_load_dwordx4 v2, s[32:35], s65 offen sc1 lds
  v_rcp_f16_sdwa v241, v241 dst_sel:WORD_1 dst_unused:UNUSED_PRESERVE src0_sel:WORD_1
  v_rcp_f16_sdwa v242, v242 dst_sel:WORD_1 dst_unused:UNUSED_PRESERVE src0_sel:WORD_1
  v_rcp_f16_sdwa v243, v243 dst_sel:WORD_1 dst_unused:UNUSED_PRESERVE src0_sel:WORD_1
  v_pk_mul_f16 v248, v128, v240
  v_pk_mul_f16 v249, v129, v241
  v_pk_mul_f16 v250, v130, v242
  v_pk_mul_f16 v251, v131, v243
  v_and_or_b32 v248, v248, s22, v14
  buffer_store_dwordx4 v[248:251], v2, s[32:35], s10 offen sc1
  s_waitcnt lgkmcnt(4)
  v_mfma_f32_32x32x16_f16 v[128:143], v[192:195], v[16:19], 0
  ds_read_b128 v[216:219], v3 offset:26624
  v_cvt_pk_f16_f32 v144, v144, v145
  v_cvt_pk_f16_f32 v145, v146, v147
  v_cvt_pk_f16_f32 v146, v148, v149
  v_cvt_pk_f16_f32 v147, v150, v151
  v_mfma_f32_32x32x16_f16 v[128:143], v[196:199], v[20:23], v[128:143]
  ds_read_b128 v[220:223], v3 offset:27648
  buffer_load_dwordx4 a[232:235], v2, s[32:35], s64 offen offset:2048 sc1
  v_pk_mul_f16 v240, v144, v144
  v_pk_mul_f16 v241, v145, v145
  s_waitcnt lgkmcnt(4)
  v_mfma_f32_32x32x16_f16 v[128:143], v[200:203], v[24:27], v[128:143]
  ds_read_b128 v[192:195], v3 offset:28672
  v_pk_mul_f16 v242, v146, v146
  v_pk_mul_f16 v243, v147, v147
  v_pk_fma_f16 v240, v240, s26, v11
  v_pk_fma_f16 v241, v241, s26, v11
  v_mfma_f32_32x32x16_f16 v[128:143], v[204:207], v[28:31], v[128:143]
  ds_read_b128 v[196:199], v3 offset:29696
  buffer_load_dwordx4 a[236:239], v2, s[32:35], s64 offen offset:3072 sc1
  v_pk_fma_f16 v242, v242, s26, v11
  v_pk_fma_f16 v243, v243, s26, v11
  s_waitcnt lgkmcnt(4)
  v_mfma_f32_32x32x16_f16 v[128:143], v[208:211], v[32:35], v[128:143]
  ds_read_b128 v[200:203], v3 offset:30720
  v_pk_mul_f16 v240, v240, v144
  v_pk_mul_f16 v241, v241, v145
  v_pk_mul_f16 v242, v242, v146
  v_pk_mul_f16 v243, v243, v147
  v_mfma_f32_32x32x16_f16 v[128:143], v[212:215], v[36:39], v[128:143]
  ds_read_b128 v[204:207], v3 offset:31744
  s_add_u32 s64, s53, 28672
  buffer_load_dwordx4 a[240:243], v2, s[32:35], s64 offen offset:0 sc1
  v_exp_f16_sdwa v240, v240 dst_sel:WORD_0 dst_unused:UNUSED_PRESERVE src0_sel:WORD_0
  s_waitcnt lgkmcnt(4)
  v_mfma_f32_32x32x16_f16 v[128:143], v[216:219], v[40:43], v[128:143]
  ds_read_b128 v[208:211], v3 offset:32768
  v_cvt_pk_f16_f32 v152, v152, v153
  v_exp_f16_sdwa v241, v241 dst_sel:WORD_0 dst_unused:UNUSED_PRESERVE src0_sel:WORD_0
  v_cvt_pk_f16_f32 v153, v154, v155
  v_mfma_f32_32x32x16_f16 v[128:143], v[220:223], v[44:47], v[128:143]
  ds_read_b128 v[212:215], v3 offset:33792
  buffer_load_dwordx4 a[244:247], v2, s[32:35], s64 offen offset:1024 sc1
  v_exp_f16_sdwa v242, v242 dst_sel:WORD_0 dst_unused:UNUSED_PRESERVE src0_sel:WORD_0
  s_waitcnt lgkmcnt(4)
  v_mfma_f32_32x32x16_f16 v[128:143], v[192:195], v[48:51], v[128:143]
  ds_read_b128 v[216:219], v3 offset:34816
  v_cvt_pk_f16_f32 v154, v156, v157
  v_exp_f16_sdwa v243, v243 dst_sel:WORD_0 dst_unused:UNUSED_PRESERVE src0_sel:WORD_0
  v_cvt_pk_f16_f32 v155, v158, v159
  v_mfma_f32_32x32x16_f16 v[128:143], v[196:199], v[52:55], v[128:143]
  ds_read_b128 v[220:223], v3 offset:35840
  buffer_load_dwordx4 a[248:251], v2, s[32:35], s64 offen offset:2048 sc1
  v_exp_f16_sdwa v240, v240 dst_sel:WORD_1 dst_unused:UNUSED_PRESERVE src0_sel:WORD_1
  s_waitcnt lgkmcnt(4)
  v_mfma_f32_32x32x16_f16 v[128:143], v[200:203], v[56:59], v[128:143]
  ds_read_b128 v[192:195], v3 offset:36864
  v_pk_mul_f16 v144, v144, v152
  v_exp_f16_sdwa v241, v241 dst_sel:WORD_1 dst_unused:UNUSED_PRESERVE src0_sel:WORD_1
  v_pk_mul_f16 v145, v145, v153
  v_mfma_f32_32x32x16_f16 v[128:143], v[204:207], v[60:63], v[128:143]
  ds_read_b128 v[196:199], v3 offset:37888
  buffer_load_dwordx4 a[252:255], v2, s[32:35], s64 offen offset:3072 sc1
  v_exp_f16_sdwa v242, v242 dst_sel:WORD_1 dst_unused:UNUSED_PRESERVE src0_sel:WORD_1
  s_waitcnt lgkmcnt(4)
  v_mfma_f32_32x32x16_f16 v[128:143], v[208:211], v[64:67], v[128:143]
  ds_read_b128 v[200:203], v3 offset:38912
  v_pk_mul_f16 v146, v146, v154
  v_exp_f16_sdwa v243, v243 dst_sel:WORD_1 dst_unused:UNUSED_PRESERVE src0_sel:WORD_1
  v_pk_mul_f16 v147, v147, v155
  v_mfma_f32_32x32x16_f16 v[128:143], v[212:215], v[68:71], v[128:143]
  ds_read_b128 v[204:207], v3 offset:39936
  s_add_u32 s64, s53, 32768
  buffer_load_dwordx4 a[0:3], v2, s[32:35], s64 offen offset:0 sc1
  v_pk_add_f16 v240, v240, s27
  v_pk_add_f16 v241, v241, s27
  s_waitcnt lgkmcnt(4)
  v_mfma_f32_32x32x16_f16 v[128:143], v[216:219], v[72:75], v[128:143]
  ds_read_b128 v[208:211], v3 offset:40960
  v_pk_add_f16 v242, v242, s27
  v_pk_add_f16 v243, v243, s27
  v_rcp_f16_sdwa v240, v240 dst_sel:WORD_0 dst_unused:UNUSED_PRESERVE src0_sel:WORD_0
  v_mfma_f32_32x32x16_f16 v[128:143], v[220:223], v[76:79], v[128:143]
  ds_read_b128 v[212:215], v3 offset:41984
  buffer_load_dwordx4 a[4:7], v2, s[32:35], s64 offen offset:1024 sc1
  v_rcp_f16_sdwa v241, v241 dst_sel:WORD_0 dst_unused:UNUSED_PRESERVE src0_sel:WORD_0
  s_waitcnt lgkmcnt(4)
  v_mfma_f32_32x32x16_f16 v[128:143], v[192:195], v[80:83], v[128:143]
  ds_read_b128 v[216:219], v3 offset:43008
  v_rcp_f16_sdwa v242, v242 dst_sel:WORD_0 dst_unused:UNUSED_PRESERVE src0_sel:WORD_0
  v_rcp_f16_sdwa v243, v243 dst_sel:WORD_0 dst_unused:UNUSED_PRESERVE src0_sel:WORD_0
  v_mfma_f32_32x32x16_f16 v[128:143], v[196:199], v[84:87], v[128:143]
  ds_read_b128 v[220:223], v3 offset:44032
  buffer_load_dwordx4 a[8:11], v2, s[32:35], s64 offen offset:2048 sc1
  v_rcp_f16_sdwa v240, v240 dst_sel:WORD_1 dst_unused:UNUSED_PRESERVE src0_sel:WORD_1
  s_waitcnt lgkmcnt(4)
  v_mfma_f32_32x32x16_f16 v[128:143], v[200:203], v[88:91], v[128:143]
  ds_read_b128 v[192:195], v3 offset:45056
  v_rcp_f16_sdwa v241, v241 dst_sel:WORD_1 dst_unused:UNUSED_PRESERVE src0_sel:WORD_1
  v_rcp_f16_sdwa v242, v242 dst_sel:WORD_1 dst_unused:UNUSED_PRESERVE src0_sel:WORD_1
  v_mfma_f32_32x32x16_f16 v[128:143], v[204:207], v[92:95], v[128:143]
  ds_read_b128 v[196:199], v3 offset:46080
  buffer_load_dwordx4 a[12:15], v2, s[32:35], s64 offen offset:3072 sc1
  v_rcp_f16_sdwa v243, v243 dst_sel:WORD_1 dst_unused:UNUSED_PRESERVE src0_sel:WORD_1
  s_waitcnt lgkmcnt(4)
  v_mfma_f32_32x32x16_f16 v[128:143], v[208:211], v[96:99], v[128:143]
  ds_read_b128 v[200:203], v3 offset:47104
  v_pk_mul_f16 v248, v144, v240
  v_pk_mul_f16 v249, v145, v241
  v_pk_mul_f16 v250, v146, v242
  v_pk_mul_f16 v251, v147, v243
  v_mfma_f32_32x32x16_f16 v[128:143], v[212:215], v[100:103], v[128:143]
  ds_read_b128 v[204:207], v3 offset:48128
  s_add_u32 s64, s53, 36864
  buffer_load_dwordx4 a[16:19], v2, s[32:35], s64 offen offset:0 sc1
  v_and_or_b32 v248, v248, s22, v14
  buffer_store_dwordx4 v[248:251], v2, s[32:35], s11 offen sc1
  s_waitcnt lgkmcnt(4)
  v_mfma_f32_32x32x16_f16 v[128:143], v[216:219], v[104:107], v[128:143]
  v_cvt_pk_f16_f32 v160, v160, v161
  v_cvt_pk_f16_f32 v161, v162, v163
  v_cvt_pk_f16_f32 v162, v164, v165
  v_cvt_pk_f16_f32 v163, v166, v167
  v_mfma_f32_32x32x16_f16 v[128:143], v[220:223], v[108:111], v[128:143]
  buffer_load_dwordx4 a[20:23], v2, s[32:35], s64 offen offset:1024 sc1
  v_pk_mul_f16 v240, v160, v160
  v_pk_mul_f16 v241, v161, v161
  s_waitcnt lgkmcnt(2)
  v_mfma_f32_32x32x16_f16 v[128:143], v[192:195], v[112:115], v[128:143]
  v_pk_mul_f16 v242, v162, v162
  v_pk_mul_f16 v243, v163, v163
  v_pk_fma_f16 v240, v240, s26, v11
  v_pk_fma_f16 v241, v241, s26, v11
  v_mfma_f32_32x32x16_f16 v[128:143], v[196:199], v[116:119], v[128:143]
  buffer_load_dwordx4 a[24:27], v2, s[32:35], s64 offen offset:2048 sc1
  v_pk_fma_f16 v242, v242, s26, v11
  v_pk_fma_f16 v243, v243, s26, v11
  s_waitcnt lgkmcnt(0)
  v_mfma_f32_32x32x16_f16 v[128:143], v[200:203], v[120:123], v[128:143]
  v_pk_mul_f16 v240, v240, v160
  v_pk_mul_f16 v241, v241, v161
  v_pk_mul_f16 v242, v242, v162
  v_pk_mul_f16 v243, v243, v163
  v_mfma_f32_32x32x16_f16 v[128:143], v[204:207], v[124:127], v[128:143]
  buffer_load_dwordx4 a[28:31], v2, s[32:35], s64 offen offset:3072 sc1
  v_exp_f16_sdwa v240, v240 dst_sel:WORD_0 dst_unused:UNUSED_PRESERVE src0_sel:WORD_0
  s_waitcnt vmcnt(16)
  s_barrier
  ds_read_b128 v[208:211], v3 offset:53248
  ds_read_b128 v[212:215], v3 offset:54272
  ds_read_b128 v[216:219], v3 offset:55296
  ds_read_b128 v[220:223], v3 offset:56320
  ds_read_b128 v[192:195], v3 offset:57344
  ds_read_b128 v[196:199], v3 offset:58368
  s_waitcnt lgkmcnt(4)
  v_mfma_f32_32x32x16_f16 v[144:159], v[208:211], v[16:19], 0
  ds_read_b128 v[200:203], v3 offset:59392
  v_cvt_pk_f16_f32 v168, v168, v169
  v_exp_f16_sdwa v241, v241 dst_sel:WORD_0 dst_unused:UNUSED_PRESERVE src0_sel:WORD_0
  v_cvt_pk_f16_f32 v169, v170, v171
  v_mfma_f32_32x32x16_f16 v[144:159], v[212:215], v[20:23], v[144:159]
  ds_read_b128 v[204:207], v3 offset:60416
  s_add_u32 s64, s53, 40960
  buffer_load_dwordx4 a[32:35], v2, s[32:35], s64 offen offset:0 sc1
  v_exp_f16_sdwa v242, v242 dst_sel:WORD_0 dst_unused:UNUSED_PRESERVE src0_sel:WORD_0
  s_waitcnt lgkmcnt(4)
  v_mfma_f32_32x32x16_f16 v[144:159], v[216:219], v[24:27], v[144:159]
  ds_read_b128 v[208:211], v3 offset:61440
  v_cvt_pk_f16_f32 v170, v172, v173
  v_exp_f16_sdwa v243, v243 dst_sel:WORD_0 dst_unused:UNUSED_PRESERVE src0_sel:WORD_0
  v_cvt_pk_f16_f32 v171, v174, v175
  v_mfma_f32_32x32x16_f16 v[144:159], v[220:223], v[28:31], v[144:159]
  ds_read_b128 v[212:215], v3 offset:62464
  buffer_load_dwordx4 a[36:39], v2, s[32:35], s64 offen offset:1024 sc1
  v_exp_f16_sdwa v240, v240 dst_sel:WORD_1 dst_unused:UNUSED_PRESERVE src0_sel:WORD_1
  s_waitcnt lgkmcnt(4)
  v_mfma_f32_32x32x16_f16 v[144:159], v[192:195], v[32:35], v[144:159]
  ds_read_b128 v[216:219], v3 offset:63488
  v_pk_mul_f16 v160, v160, v168
  v_exp_f16_sdwa v241, v241 dst_sel:WORD_1 dst_unused:UNUSED_PRESERVE src0_sel:WORD_1
  v_pk_mul_f16 v161, v161, v169
  v_mfma_f32_32x32x16_f16 v[144:159], v[196:199], v[36:39], v[144:159]
  ds_read_b128 v[220:223], v3 offset:64512
  buffer_load_dwordx4 a[40:43], v2, s[32:35], s64 offen offset:2048 sc1
  v_exp_f16_sdwa v242, v242 dst_sel:WORD_1 dst_unused:UNUSED_PRESERVE src0_sel:WORD_1
  s_waitcnt lgkmcnt(4)
  v_mfma_f32_32x32x16_f16 v[144:159], v[200:203], v[40:43], v[144:159]
  ds_read_b128 v[192:195], v4 offset:0
  v_pk_mul_f16 v162, v162, v170
  v_exp_f16_sdwa v243, v243 dst_sel:WORD_1 dst_unused:UNUSED_PRESERVE src0_sel:WORD_1
  v_pk_mul_f16 v163, v163, v171
  v_mfma_f32_32x32x16_f16 v[144:159], v[204:207], v[44:47], v[144:159]
  ds_read_b128 v[196:199], v4 offset:1024
  buffer_load_dwordx4 a[44:47], v2, s[32:35], s64 offen offset:3072 sc1
  v_pk_add_f16 v240, v240, s27
  v_pk_add_f16 v241, v241, s27
  s_waitcnt lgkmcnt(4)
  v_mfma_f32_32x32x16_f16 v[144:159], v[208:211], v[48:51], v[144:159]
  ds_read_b128 v[200:203], v4 offset:2048
  v_pk_add_f16 v242, v242, s27
  v_pk_add_f16 v243, v243, s27
  v_rcp_f16_sdwa v240, v240 dst_sel:WORD_0 dst_unused:UNUSED_PRESERVE src0_sel:WORD_0
  v_mfma_f32_32x32x16_f16 v[144:159], v[212:215], v[52:55], v[144:159]
  ds_read_b128 v[204:207], v4 offset:3072
  s_add_u32 s64, s53, 45056
  buffer_load_dwordx4 a[48:51], v2, s[32:35], s64 offen offset:0 sc1
  v_rcp_f16_sdwa v241, v241 dst_sel:WORD_0 dst_unused:UNUSED_PRESERVE src0_sel:WORD_0
  s_waitcnt lgkmcnt(4)
  v_mfma_f32_32x32x16_f16 v[144:159], v[216:219], v[56:59], v[144:159]
  ds_read_b128 v[208:211], v4 offset:4096
  v_rcp_f16_sdwa v242, v242 dst_sel:WORD_0 dst_unused:UNUSED_PRESERVE src0_sel:WORD_0
  v_rcp_f16_sdwa v243, v243 dst_sel:WORD_0 dst_unused:UNUSED_PRESERVE src0_sel:WORD_0
  v_mfma_f32_32x32x16_f16 v[144:159], v[220:223], v[60:63], v[144:159]
  ds_read_b128 v[212:215], v4 offset:5120
  buffer_load_dwordx4 a[52:55], v2, s[32:35], s64 offen offset:1024 sc1
  v_rcp_f16_sdwa v240, v240 dst_sel:WORD_1 dst_unused:UNUSED_PRESERVE src0_sel:WORD_1
  s_waitcnt lgkmcnt(4)
  v_mfma_f32_32x32x16_f16 v[144:159], v[192:195], v[64:67], v[144:159]
  ds_read_b128 v[216:219], v4 offset:6144
  v_rcp_f16_sdwa v241, v241 dst_sel:WORD_1 dst_unused:UNUSED_PRESERVE src0_sel:WORD_1
  v_rcp_f16_sdwa v242, v242 dst_sel:WORD_1 dst_unused:UNUSED_PRESERVE src0_sel:WORD_1
  v_mfma_f32_32x32x16_f16 v[144:159], v[196:199], v[68:71], v[144:159]
  ds_read_b128 v[220:223], v4 offset:7168
  buffer_load_dwordx4 a[56:59], v2, s[32:35], s64 offen offset:2048 sc1
  v_rcp_f16_sdwa v243, v243 dst_sel:WORD_1 dst_unused:UNUSED_PRESERVE src0_sel:WORD_1
  s_waitcnt lgkmcnt(4)
  v_mfma_f32_32x32x16_f16 v[144:159], v[200:203], v[72:75], v[144:159]
  ds_read_b128 v[192:195], v4 offset:8192
  v_pk_mul_f16 v248, v160, v240
  v_pk_mul_f16 v249, v161, v241
  v_pk_mul_f16 v250, v162, v242
  v_pk_mul_f16 v251, v163, v243
  v_mfma_f32_32x32x16_f16 v[144:159], v[204:207], v[76:79], v[144:159]
  ds_read_b128 v[196:199], v4 offset:9216
  buffer_load_dwordx4 a[60:63], v2, s[32:35], s64 offen offset:3072 sc1
  v_and_or_b32 v248, v248, s22, v14
  buffer_store_dwordx4 v[248:251], v2, s[32:35], s12 offen sc1
  s_waitcnt lgkmcnt(4)
  v_mfma_f32_32x32x16_f16 v[144:159], v[208:211], v[80:83], v[144:159]
  ds_read_b128 v[200:203], v4 offset:10240
  v_cvt_pk_f16_f32 v176, v176, v177
  v_cvt_pk_f16_f32 v177, v178, v179
  v_cvt_pk_f16_f32 v178, v180, v181
  v_cvt_pk_f16_f32 v179, v182, v183
  v_mfma_f32_32x32x16_f16 v[144:159], v[212:215], v[84:87], v[144:159]
  ds_read_b128 v[204:207], v4 offset:11264
  s_add_u32 s64, s53, 49152
  buffer_load_dwordx4 a[64:67], v2, s[32:35], s64 offen offset:0 sc1
  v_pk_mul_f16 v240, v176, v176
  v_pk_mul_f16 v241, v177, v177
  s_waitcnt lgkmcnt(4)
  v_mfma_f32_32x32x16_f16 v[144:159], v[216:219], v[88:91], v[144:159]
  ds_read_b128 v[208:211], v4 offset:12288
  v_pk_mul_f16 v242, v178, v178
  v_pk_mul_f16 v243, v179, v179
  v_pk_fma_f16 v240, v240, s26, v11
  v_pk_fma_f16 v241, v241, s26, v11
  v_mfma_f32_32x32x16_f16 v[144:159], v[220:223], v[92:95], v[144:159]
  ds_read_b128 v[212:215], v4 offset:13312
  buffer_load_dwordx4 a[68:71], v2, s[32:35], s64 offen offset:1024 sc1
  v_pk_fma_f16 v242, v242, s26, v11
  v_pk_fma_f16 v243, v243, s26, v11
  s_waitcnt lgkmcnt(4)
  v_mfma_f32_32x32x16_f16 v[144:159], v[192:195], v[96:99], v[144:159]
  ds_read_b128 v[216:219], v4 offset:14336
  v_pk_mul_f16 v240, v240, v176
  v_pk_mul_f16 v241, v241, v177
  v_pk_mul_f16 v242, v242, v178
  v_pk_mul_f16 v243, v243, v179
  v_mfma_f32_32x32x16_f16 v[144:159], v[196:199], v[100:103], v[144:159]
  ds_read_b128 v[220:223], v4 offset:15360
  buffer_load_dwordx4 a[72:75], v2, s[32:35], s64 offen offset:2048 sc1
  v_exp_f16_sdwa v240, v240 dst_sel:WORD_0 dst_unused:UNUSED_PRESERVE src0_sel:WORD_0
  s_waitcnt lgkmcnt(4)
  v_mfma_f32_32x32x16_f16 v[144:159], v[200:203], v[104:107], v[144:159]
  ds_read_b128 v[192:195], v2 offset:0
  v_cvt_pk_f16_f32 v184, v184, v185
  v_exp_f16_sdwa v241, v241 dst_sel:WORD_0 dst_unused:UNUSED_PRESERVE src0_sel:WORD_0
  v_cvt_pk_f16_f32 v185, v186, v187
  v_mfma_f32_32x32x16_f16 v[144:159], v[204:207], v[108:111], v[144:159]
  ds_read_b128 v[196:199], v2 offset:1024
  buffer_load_dwordx4 a[76:79], v2, s[32:35], s64 offen offset:3072 sc1
  v_exp_f16_sdwa v242, v242 dst_sel:WORD_0 dst_unused:UNUSED_PRESERVE src0_sel:WORD_0
  s_waitcnt lgkmcnt(4)
  v_mfma_f32_32x32x16_f16 v[144:159], v[208:211], v[112:115], v[144:159]
  ds_read_b128 v[200:203], v2 offset:2048
  v_cvt_pk_f16_f32 v186, v188, v189
  v_exp_f16_sdwa v243, v243 dst_sel:WORD_0 dst_unused:UNUSED_PRESERVE src0_sel:WORD_0
  v_cvt_pk_f16_f32 v187, v190, v191
  v_mfma_f32_32x32x16_f16 v[144:159], v[212:215], v[116:119], v[144:159]
  ds_read_b128 v[204:207], v2 offset:3072
  s_add_u32 s64, s53, 53248
  buffer_load_dwordx4 a[80:83], v2, s[32:35], s64 offen offset:0 sc1
  v_exp_f16_sdwa v240, v240 dst_sel:WORD_1 dst_unused:UNUSED_PRESERVE src0_sel:WORD_1
  s_waitcnt lgkmcnt(4)
  v_mfma_f32_32x32x16_f16 v[144:159], v[216:219], v[120:123], v[144:159]
  ds_read_b128 v[208:211], v2 offset:4096
  v_pk_mul_f16 v176, v176, v184
  v_exp_f16_sdwa v241, v241 dst_sel:WORD_1 dst_unused:UNUSED_PRESERVE src0_sel:WORD_1
  v_pk_mul_f16 v177, v177, v185
  v_mfma_f32_32x32x16_f16 v[144:159], v[220:223], v[124:127], v[144:159]
  ds_read_b128 v[212:215], v2 offset:5120
  buffer_load_dwordx4 a[84:87], v2, s[32:35], s64 offen offset:1024 sc1
  v_exp_f16_sdwa v242, v242 dst_sel:WORD_1 dst_unused:UNUSED_PRESERVE src0_sel:WORD_1
  s_waitcnt lgkmcnt(4)
  v_mfma_f32_32x32x16_f16 v[160:175], v[192:195], v[16:19], 0
  ds_read_b128 v[216:219], v2 offset:6144
  v_pk_mul_f16 v178, v178, v186
  v_exp_f16_sdwa v243, v243 dst_sel:WORD_1 dst_unused:UNUSED_PRESERVE src0_sel:WORD_1
  v_pk_mul_f16 v179, v179, v187
  v_mfma_f32_32x32x16_f16 v[160:175], v[196:199], v[20:23], v[160:175]
  ds_read_b128 v[220:223], v2 offset:7168
  buffer_load_dwordx4 v[16:19], v2, s[32:35], s17 offen offset:0 sc1
  v_pk_add_f16 v240, v240, s27
  v_pk_add_f16 v241, v241, s27
  s_waitcnt lgkmcnt(4)
  v_mfma_f32_32x32x16_f16 v[160:175], v[200:203], v[24:27], v[160:175]
  ds_read_b128 v[192:195], v2 offset:8192
  v_pk_add_f16 v242, v242, s27
  v_pk_add_f16 v243, v243, s27
  v_rcp_f16_sdwa v240, v240 dst_sel:WORD_0 dst_unused:UNUSED_PRESERVE src0_sel:WORD_0
  v_mfma_f32_32x32x16_f16 v[160:175], v[204:207], v[28:31], v[160:175]
  ds_read_b128 v[196:199], v2 offset:9216
  buffer_load_dwordx4 v[20:23], v2, s[32:35], s18 offen offset:0 sc1
  v_rcp_f16_sdwa v241, v241 dst_sel:WORD_0 dst_unused:UNUSED_PRESERVE src0_sel:WORD_0
  s_waitcnt lgkmcnt(4)
  v_mfma_f32_32x32x16_f16 v[160:175], v[208:211], v[32:35], v[160:175]
  ds_read_b128 v[200:203], v2 offset:10240
  v_rcp_f16_sdwa v242, v242 dst_sel:WORD_0 dst_unused:UNUSED_PRESERVE src0_sel:WORD_0
  v_rcp_f16_sdwa v243, v243 dst_sel:WORD_0 dst_unused:UNUSED_PRESERVE src0_sel:WORD_0
  v_mfma_f32_32x32x16_f16 v[160:175], v[212:215], v[36:39], v[160:175]
  ds_read_b128 v[204:207], v2 offset:11264
  buffer_load_dwordx4 v[24:27], v2, s[32:35], s17 offen offset:1024 sc1
  v_rcp_f16_sdwa v240, v240 dst_sel:WORD_1 dst_unused:UNUSED_PRESERVE src0_sel:WORD_1
  s_waitcnt lgkmcnt(4)
  v_mfma_f32_32x32x16_f16 v[160:175], v[216:219], v[40:43], v[160:175]
  ds_read_b128 v[208:211], v2 offset:12288
  v_rcp_f16_sdwa v241, v241 dst_sel:WORD_1 dst_unused:UNUSED_PRESERVE src0_sel:WORD_1
  v_rcp_f16_sdwa v242, v242 dst_sel:WORD_1 dst_unused:UNUSED_PRESERVE src0_sel:WORD_1
  v_mfma_f32_32x32x16_f16 v[160:175], v[220:223], v[44:47], v[160:175]
  ds_read_b128 v[212:215], v2 offset:13312
  buffer_load_dwordx4 v[28:31], v2, s[32:35], s18 offen offset:1024 sc1
  v_rcp_f16_sdwa v243, v243 dst_sel:WORD_1 dst_unused:UNUSED_PRESERVE src0_sel:WORD_1
  s_waitcnt lgkmcnt(4)
  v_mfma_f32_32x32x16_f16 v[160:175], v[192:195], v[48:51], v[160:175]
  ds_read_b128 v[216:219], v2 offset:14336
  v_pk_mul_f16 v248, v176, v240
  v_pk_mul_f16 v249, v177, v241
  v_pk_mul_f16 v250, v178, v242
  v_pk_mul_f16 v251, v179, v243
  v_mfma_f32_32x32x16_f16 v[160:175], v[196:199], v[52:55], v[160:175]
  ds_read_b128 v[220:223], v2 offset:15360
  buffer_load_dwordx4 v[32:35], v2, s[32:35], s17 offen offset:2048 sc1
  v_and_or_b32 v248, v248, s22, v14
  buffer_store_dwordx4 v[248:251], v2, s[32:35], s13 offen sc1
  s_waitcnt lgkmcnt(4)
  v_mfma_f32_32x32x16_f16 v[160:175], v[200:203], v[56:59], v[160:175]
  ds_read_b128 v[192:195], v2 offset:16384
  v_cvt_pk_f16_f32 v128, v128, v129
  v_cvt_pk_f16_f32 v129, v130, v131
  v_cvt_pk_f16_f32 v130, v132, v133
  v_cvt_pk_f16_f32 v131, v134, v135
  v_mfma_f32_32x32x16_f16 v[160:175], v[204:207], v[60:63], v[160:175]
  ds_read_b128 v[196:199], v2 offset:17408
  buffer_load_dwordx4 v[36:39], v2, s[32:35], s18 offen offset:2048 sc1
  v_pk_mul_f16 v240, v128, v128
  v_pk_mul_f16 v241, v129, v129
  s_waitcnt lgkmcnt(4)
  v_mfma_f32_32x32x16_f16 v[160:175], v[208:211], v[64:67], v[160:175]
  ds_read_b128 v[200:203], v2 offset:18432
  v_pk_mul_f16 v242, v130, v130
  v_pk_mul_f16 v243, v131, v131
  v_pk_fma_f16 v240, v240, s26, v11
  v_pk_fma_f16 v241, v241, s26, v11
  v_mfma_f32_32x32x16_f16 v[160:175], v[212:215], v[68:71], v[160:175]
  ds_read_b128 v[204:207], v2 offset:19456
  buffer_load_dwordx4 v[40:43], v2, s[32:35], s17 offen offset:3072 sc1
  v_pk_fma_f16 v242, v242, s26, v11
  v_pk_fma_f16 v243, v243, s26, v11
  s_waitcnt lgkmcnt(4)
  v_mfma_f32_32x32x16_f16 v[160:175], v[216:219], v[72:75], v[160:175]
  ds_read_b128 v[208:211], v2 offset:20480
  v_pk_mul_f16 v240, v240, v128
  v_pk_mul_f16 v241, v241, v129
  v_pk_mul_f16 v242, v242, v130
  v_pk_mul_f16 v243, v243, v131
  v_mfma_f32_32x32x16_f16 v[160:175], v[220:223], v[76:79], v[160:175]
  ds_read_b128 v[212:215], v2 offset:21504
  buffer_load_dwordx4 v[44:47], v2, s[32:35], s18 offen offset:3072 sc1
  v_exp_f16_sdwa v240, v240 dst_sel:WORD_0 dst_unused:UNUSED_PRESERVE src0_sel:WORD_0
  s_waitcnt lgkmcnt(4)
  v_mfma_f32_32x32x16_f16 v[160:175], v[192:195], v[80:83], v[160:175]
  ds_read_b128 v[216:219], v2 offset:22528
  v_cvt_pk_f16_f32 v136, v136, v137
  v_exp_f16_sdwa v241, v241 dst_sel:WORD_0 dst_unused:UNUSED_PRESERVE src0_sel:WORD_0
  v_cvt_pk_f16_f32 v137, v138, v139
  v_mfma_f32_32x32x16_f16 v[160:175], v[196:199], v[84:87], v[160:175]
  ds_read_b128 v[220:223], v2 offset:23552
  s_add_u32 s62, s17, 4096
  buffer_load_dwordx4 v[48:51], v2, s[32:35], s62 offen offset:0 sc1
  v_exp_f16_sdwa v242, v242 dst_sel:WORD_0 dst_unused:UNUSED_PRESERVE src0_sel:WORD_0
  s_waitcnt lgkmcnt(4)
  v_mfma_f32_32x32x16_f16 v[160:175], v[200:203], v[88:91], v[160:175]
  ds_read_b128 v[192:195], v2 offset:24576
  v_cvt_pk_f16_f32 v138, v140, v141
  v_exp_f16_sdwa v243, v243 dst_sel:WORD_0 dst_unused:UNUSED_PRESERVE src0_sel:WORD_0
  v_cvt_pk_f16_f32 v139, v142, v143
  v_mfma_f32_32x32x16_f16 v[160:175], v[204:207], v[92:95], v[160:175]
  ds_read_b128 v[196:199], v2 offset:25600
  s_add_u32 s63, s18, 4096
  buffer_load_dwordx4 v[52:55], v2, s[32:35], s63 offen offset:0 sc1
  v_exp_f16_sdwa v240, v240 dst_sel:WORD_1 dst_unused:UNUSED_PRESERVE src0_sel:WORD_1
  s_waitcnt lgkmcnt(4)
  v_mfma_f32_32x32x16_f16 v[160:175], v[208:211], v[96:99], v[160:175]
  ds_read_b128 v[200:203], v2 offset:26624
  v_pk_mul_f16 v128, v128, v136
  v_exp_f16_sdwa v241, v241 dst_sel:WORD_1 dst_unused:UNUSED_PRESERVE src0_sel:WORD_1
  v_pk_mul_f16 v129, v129, v137
  v_mfma_f32_32x32x16_f16 v[160:175], v[212:215], v[100:103], v[160:175]
  ds_read_b128 v[204:207], v2 offset:27648
  buffer_load_dwordx4 v[56:59], v2, s[32:35], s62 offen offset:1024 sc1
  v_exp_f16_sdwa v242, v242 dst_sel:WORD_1 dst_unused:UNUSED_PRESERVE src0_sel:WORD_1
  s_waitcnt lgkmcnt(4)
  v_mfma_f32_32x32x16_f16 v[160:175], v[216:219], v[104:107], v[160:175]
  v_pk_mul_f16 v130, v130, v138
  v_exp_f16_sdwa v243, v243 dst_sel:WORD_1 dst_unused:UNUSED_PRESERVE src0_sel:WORD_1
  v_pk_mul_f16 v131, v131, v139
  v_mfma_f32_32x32x16_f16 v[160:175], v[220:223], v[108:111], v[160:175]
  buffer_load_dwordx4 v[60:63], v2, s[32:35], s63 offen offset:1024 sc1
  v_pk_add_f16 v240, v240, s27
  v_pk_add_f16 v241, v241, s27
  s_waitcnt lgkmcnt(2)
  v_mfma_f32_32x32x16_f16 v[160:175], v[192:195], v[112:115], v[160:175]
  v_pk_add_f16 v242, v242, s27
  v_pk_add_f16 v243, v243, s27
  v_rcp_f16_sdwa v240, v240 dst_sel:WORD_0 dst_unused:UNUSED_PRESERVE src0_sel:WORD_0
  v_mfma_f32_32x32x16_f16 v[160:175], v[196:199], v[116:119], v[160:175]
  buffer_load_dwordx4 v[64:67], v2, s[32:35], s62 offen offset:2048 sc1
  v_rcp_f16_sdwa v241, v241 dst_sel:WORD_0 dst_unused:UNUSED_PRESERVE src0_sel:WORD_0
  s_waitcnt lgkmcnt(0)
  v_mfma_f32_32x32x16_f16 v[160:175], v[200:203], v[120:123], v[160:175]
  v_rcp_f16_sdwa v242, v242 dst_sel:WORD_0 dst_unused:UNUSED_PRESERVE src0_sel:WORD_0
  v_rcp_f16_sdwa v243, v243 dst_sel:WORD_0 dst_unused:UNUSED_PRESERVE src0_sel:WORD_0
  v_mfma_f32_32x32x16_f16 v[160:175], v[204:207], v[124:127], v[160:175]
  s_waitcnt vmcnt(13)
  v_xor_b32 v9, v16, v14
  s_waitcnt vmcnt(12)
  v_bitop3_b32 v9, v9, v20, v14 bitop3:0xf6
  s_waitcnt vmcnt(11)
  v_bitop3_b32 v9, v9, v24, v14 bitop3:0xf6
  s_waitcnt vmcnt(10)
  v_bitop3_b32 v9, v9, v28, v14 bitop3:0xf6
  v_and_b32 v9, s23, v9
  v_cmp_ne_u32 vcc, 0, v9
  s_cbranch_vccnz .Lvslow34
.Lvback35:
  buffer_load_dwordx4 v[68:71], v2, s[32:35], s63 offen offset:2048 sc1
  v_mfma_f32_32x32x16_f16 v[192:207], a[128:131], v[16:19], 0
  v_rcp_f16_sdwa v240, v240 dst_sel:WORD_1 dst_unused:UNUSED_PRESERVE src0_sel:WORD_1
  v_rcp_f16_sdwa v241, v241 dst_sel:WORD_1 dst_unused:UNUSED_PRESERVE src0_sel:WORD_1
  v_rcp_f16_sdwa v242, v242 dst_sel:WORD_1 dst_unused:UNUSED_PRESERVE src0_sel:WORD_1
  v_rcp_f16_sdwa v243, v243 dst_sel:WORD_1 dst_unused:UNUSED_PRESERVE src0_sel:WORD_1
  v_pk_mul_f16 v248, v128, v240
  v_pk_mul_f16 v249, v129, v241
  v_pk_mul_f16 v250, v130, v242
  v_pk_mul_f16 v251, v131, v243
  v_and_or_b32 v248, v248, s22, v14
  buffer_store_dwordx4 v[248:251], v2, s[32:35], s14 offen sc1
  v_mfma_f32_32x32x16_f16 v[208:223], a[128:131], v[20:23], 0
  buffer_load_dwordx4 v[72:75], v2, s[32:35], s62 offen offset:3072 sc1
  v_cvt_pk_f16_f32 v144, v144, v145
  v_cvt_pk_f16_f32 v145, v146, v147
  v_cvt_pk_f16_f32 v146, v148, v149
  v_cvt_pk_f16_f32 v147, v150, v151
  v_pk_mul_f16 v240, v144, v144
  v_pk_mul_f16 v241, v145, v145
  v_pk_mul_f16 v242, v146, v146
  v_pk_mul_f16 v243, v147, v147
  v_pk_fma_f16 v240, v240, s26, v11
  v_pk_fma_f16 v241, v241, s26, v11
  v_pk_fma_f16 v242, v242, s26, v11
  v_mfma_f32_32x32x16_f16 v[224:239], a[132:135], v[16:19], 0
  v_pk_fma_f16 v243, v243, s26, v11
  v_pk_mul_f16 v240, v240, v144
  v_pk_mul_f16 v241, v241, v145
  v_pk_mul_f16 v242, v242, v146
  v_pk_mul_f16 v243, v243, v147
  v_exp_f16_sdwa v240, v240 dst_sel:WORD_0 dst_unused:UNUSED_PRESERVE src0_sel:WORD_0
  v_cvt_pk_f16_f32 v152, v152, v153
  v_exp_f16_sdwa v241, v241 dst_sel:WORD_0 dst_unused:UNUSED_PRESERVE src0_sel:WORD_0
  v_cvt_pk_f16_f32 v153, v154, v155
  v_exp_f16_sdwa v242, v242 dst_sel:WORD_0 dst_unused:UNUSED_PRESERVE src0_sel:WORD_0
  v_cvt_pk_f16_f32 v154, v156, v157
  v_exp_f16_sdwa v243, v243 dst_sel:WORD_0 dst_unused:UNUSED_PRESERVE src0_sel:WORD_0
  v_mfma_f32_32x32x16_f16 v[112:127], a[132:135], v[20:23], 0
  buffer_load_dwordx4 v[76:79], v2, s[32:35], s63 offen offset:3072 sc1
  v_cvt_pk_f16_f32 v155, v158, v159
  v_exp_f16_sdwa v240, v240 dst_sel:WORD_1 dst_unused:UNUSED_PRESERVE src0_sel:WORD_1
  v_pk_mul_f16 v144, v144, v152
  v_exp_f16_sdwa v241, v241 dst_sel:WORD_1 dst_unused:UNUSED_PRESERVE src0_sel:WORD_1
  v_pk_mul_f16 v145, v145, v153
  v_exp_f16_sdwa v242, v242 dst_sel:WORD_1 dst_unused:UNUSED_PRESERVE src0_sel:WORD_1
  v_pk_mul_f16 v146, v146, v154
  v_mfma_f32_32x32x16_f16 v[192:207], a[136:139], v[24:27], v[192:207]
  v_exp_f16_sdwa v243, v243 dst_sel:WORD_1 dst_unused:UNUSED_PRESERVE src0_sel:WORD_1
  v_pk_mul_f16 v147, v147, v155
  v_pk_add_f16 v240, v240, s27
  v_pk_add_f16 v241, v241, s27
  v_pk_add_f16 v242, v242, s27
  v_pk_add_f16 v243, v243, s27
  v_rcp_f16_sdwa v240, v240 dst_sel:WORD_0 dst_unused:UNUSED_PRESERVE src0_sel:WORD_0
  v_rcp_f16_sdwa v241, v241 dst_sel:WORD_0 dst_unused:UNUSED_PRESERVE src0_sel:WORD_0
  v_rcp_f16_sdwa v242, v242 dst_sel:WORD_0 dst_unused:UNUSED_PRESERVE src0_sel:WORD_0
  v_rcp_f16_sdwa v243, v243 dst_sel:WORD_0 dst_unused:UNUSED_PRESERVE src0_sel:WORD_0
  v_mfma_f32_32x32x16_f16 v[208:223], a[136:139], v[28:31], v[208:223]
  s_add_u32 s62, s17, 8192
  buffer_load_dwordx4 v[80:83], v2, s[32:35], s62 offen offset:0 sc1
  v_rcp_f16_sdwa v240, v240 dst_sel:WORD_1 dst_unused:UNUSED_PRESERVE src0_sel:WORD_1
  v_rcp_f16_sdwa v241, v241 dst_sel:WORD_1 dst_unused:UNUSED_PRESERVE src0_sel:WORD_1
  v_rcp_f16_sdwa v242, v242 dst_sel:WORD_1 dst_unused:UNUSED_PRESERVE src0_sel:WORD_1
  v_rcp_f16_sdwa v243, v243 dst_sel:WORD_1 dst_unused:UNUSED_PRESERVE src0_sel:WORD_1
  v_pk_mul_f16 v248, v144, v240
  v_pk_mul_f16 v249, v145, v241
  v_pk_mul_f16 v250, v146, v242
  v_mfma_f32_32x32x16_f16 v[224:239], a[140:143], v[24:27], v[224:239]
  v_pk_mul_f16 v251, v147, v243
  v_and_or_b32 v248, v248, s22, v14
  buffer_store_dwordx4 v[248:251], v2, s[32:35], s15 offen sc1
  v_mfma_f32_32x32x16_f16 v[112:127], a[140:143], v[28:31], v[112:127]
  s_waitcnt vmcnt(15)
  v_xor_b32 v9, v32, v14
  s_waitcnt vmcnt(13)
  v_bitop3_b32 v9, v9, v36, v14 bitop3:0xf6
  s_waitcnt vmcnt(12)
  v_bitop3_b32 v9, v9, v40, v14 bitop3:0xf6
  s_waitcnt vmcnt(11)
  v_bitop3_b32 v9, v9, v44, v14 bitop3:0xf6
  v_and_b32 v9, s23, v9
  v_cmp_ne_u32 vcc, 0, v9
  s_cbranch_vccnz .Lvslow36
.Lvback37:
  s_add_u32 s63, s18, 8192
  buffer_load_dwordx4 v[84:87], v2, s[32:35], s63 offen offset:0 sc1
  v_cvt_pk_f16_f32 v160, v160, v161
  v_cvt_pk_f16_f32 v161, v162, v163
  v_cvt_pk_f16_f32 v162, v164, v165
  v_cvt_pk_f16_f32 v163, v166, v167
  v_pk_mul_f16 v240, v160, v160
  v_pk_mul_f16 v241, v161, v161
  v_pk_mul_f16 v242, v162, v162
  v_pk_mul_f16 v243, v163, v163
  v_pk_fma_f16 v240, v240, s26, v11
  v_mfma_f32_32x32x16_f16 v[192:207], a[144:147], v[32:35], v[192:207]
  v_pk_fma_f16 v241, v241, s26, v11
  v_pk_fma_f16 v242, v242, s26, v11
  v_pk_fma_f16 v243, v243, s26, v11
  v_pk_mul_f16 v240, v240, v160
  v_pk_mul_f16 v241, v241, v161
  v_pk_mul_f16 v242, v242, v162
  v_pk_mul_f16 v243, v243, v163
  v_exp_f16_sdwa v240, v240 dst_sel:WORD_0 dst_unused:UNUSED_PRESERVE src0_sel:WORD_0
  v_cvt_pk_f16_f32 v168, v168, v169
  v_exp_f16_sdwa v241, v241 dst_sel:WORD_0 dst_unused:UNUSED_PRESERVE src0_sel:WORD_0
  v_cvt_pk_f16_f32 v169, v170, v171
  v_exp_f16_sdwa v242, v242 dst_sel:WORD_0 dst_unused:UNUSED_PRESERVE src0_sel:WORD_0
  v_cvt_pk_f16_f32 v170, v172, v173
  v_mfma_f32_32x32x16_f16 v[208:223], a[144:147], v[36:39], v[208:223]
  buffer_load_dwordx4 v[88:91], v2, s[32:35], s62 offen offset:1024 sc1
  v_exp_f16_sdwa v243, v243 dst_sel:WORD_0 dst_unused:UNUSED_PRESERVE src0_sel:WORD_0
  v_cvt_pk_f16_f32 v171, v174, v175
  v_exp_f16_sdwa v240, v240 dst_sel:WORD_1 dst_unused:UNUSED_PRESERVE src0_sel:WORD_1
  v_pk_mul_f16 v160, v160, v168
  v_exp_f16_sdwa v241, v241 dst_sel:WORD_1 dst_unused:UNUSED_PRESERVE src0_sel:WORD_1
  v_pk_mul_f16 v161, v161, v169
  v_exp_f16_sdwa v242, v242 dst_sel:WORD_1 dst_unused:UNUSED_PRESERVE src0_sel:WORD_1
  v_mfma_f32_32x32x16_f16 v[224:239], a[148:151], v[32:35], v[224:239]
  v_pk_mul_f16 v162, v162, v170
  v_exp_f16_sdwa v243, v243 dst_sel:WORD_1 dst_unused:UNUSED_PRESERVE src0_sel:WORD_1
  v_pk_mul_f16 v163, v163, v171
  v_pk_add_f16 v240, v240, s27
  v_pk_add_f16 v241, v241, s27
  v_pk_add_f16 v242, v242, s27
  v_pk_add_f16 v243, v243, s27
  v_rcp_f16_sdwa v240, v240 dst_sel:WORD_0 dst_unused:UNUSED_PRESERVE src0_sel:WORD_0
  v_rcp_f16_sdwa v241, v241 dst_sel:WORD_0 dst_unused:UNUSED_PRESERVE src0_sel:WORD_0
  v_rcp_f16_sdwa v242, v242 dst_sel:WORD_0 dst_unused:UNUSED_PRESERVE src0_sel:WORD_0
  v_rcp_f16_sdwa v243, v243 dst_sel:WORD_0 dst_unused:UNUSED_PRESERVE src0_sel:WORD_0
  v_mfma_f32_32x32x16_f16 v[112:127], a[148:151], v[36:39], v[112:127]
  buffer_load_dwordx4 v[92:95], v2, s[32:35], s63 offen offset:1024 sc1
  v_rcp_f16_sdwa v240, v240 dst_sel:WORD_1 dst_unused:UNUSED_PRESERVE src0_sel:WORD_1
  v_rcp_f16_sdwa v241, v241 dst_sel:WORD_1 dst_unused:UNUSED_PRESERVE src0_sel:WORD_1
  v_rcp_f16_sdwa v242, v242 dst_sel:WORD_1 dst_unused:UNUSED_PRESERVE src0_sel:WORD_1
  v_rcp_f16_sdwa v243, v243 dst_sel:WORD_1 dst_unused:UNUSED_PRESERVE src0_sel:WORD_1
  v_pk_mul_f16 v248, v160, v240
  v_pk_mul_f16 v249, v161, v241
  v_pk_mul_f16 v250, v162, v242
  v_mfma_f32_32x32x16_f16 v[192:207], a[152:155], v[40:43], v[192:207]
  v_pk_mul_f16 v251, v163, v243
  v_and_or_b32 v248, v248, s22, v14
  buffer_store_dwordx4 v[248:251], v2, s[32:35], s16 offen sc1
  v_mfma_f32_32x32x16_f16 v[208:223], a[152:155], v[44:47], v[208:223]
  buffer_load_dwordx4 v[96:99], v2, s[32:35], s62 offen offset:2048 sc1
  s_lshr_b32 s10, s45, 1
  s_mul_i32 s10, s10, 7
  s_lshr_b32 s55, s3, 1
  s_lshl2_add_u32 s10, s55, s10
  s_mul_i32 s12, s20, 28672
  s_add_u32 s12, s12, 0xe00000
  s_add_u32 s55, s10, 0
  s_and_b32 s11, s55, 1
  s_lshl_b32 s11, s11, 3
  s_lshr_b32 s55, s55, 1
  s_lshl_b32 s55, s55, 10
  v_mfma_f32_32x32x16_f16 v[224:239], a[156:159], v[40:43], v[224:239]
  s_add_u32 s55, s55, s11
  s_add_u32 s13, s55, s12
  buffer_load_dwordx2 v[128:129], v2, s[32:35], s13 offen sc1
  s_lshr_b32 s55, s55, 5
  s_or_b32 s55, s55, s11
  v_add_u32 v13, s55, v5
  ds_read_b64 v[136:137], v13 offset:4480
  s_add_u32 s55, s10, 1
  s_and_b32 s11, s55, 1
  s_lshl_b32 s11, s11, 3
  s_lshr_b32 s55, s55, 1
  s_lshl_b32 s55, s55, 10
  v_mfma_f32_32x32x16_f16 v[112:127], a[156:159], v[44:47], v[112:127]
  s_waitcnt vmcnt(16)
  v_xor_b32 v9, v48, v14
  s_waitcnt vmcnt(15)
  v_bitop3_b32 v9, v9, v52, v14 bitop3:0xf6
  s_waitcnt vmcnt(14)
  v_bitop3_b32 v9, v9, v56, v14 bitop3:0xf6
  s_waitcnt vmcnt(13)
  v_bitop3_b32 v9, v9, v60, v14 bitop3:0xf6
  v_and_b32 v9, s23, v9
  v_cmp_ne_u32 vcc, 0, v9
  s_cbranch_vccnz .Lvslow38
.Lvback39:
  buffer_load_dwordx4 v[100:103], v2, s[32:35], s63 offen offset:2048 sc1
  s_add_u32 s55, s55, s11
  s_add_u32 s13, s55, s12
  v_mfma_f32_32x32x16_f16 v[192:207], a[160:163], v[48:51], v[192:207]
  buffer_load_dwordx2 v[130:131], v2, s[32:35], s13 offen sc1
  s_lshr_b32 s55, s55, 5
  s_or_b32 s55, s55, s11
  v_add_u32 v13, s55, v5
  ds_read_b64 v[138:139], v13 offset:4480
  s_add_u32 s55, s10, 2
  s_and_b32 s11, s55, 1
  s_lshl_b32 s11, s11, 3
  s_lshr_b32 s55, s55, 1
  s_lshl_b32 s55, s55, 10
  s_add_u32 s55, s55, s11
  s_add_u32 s13, s55, s12
  v_mfma_f32_32x32x16_f16 v[208:223], a[160:163], v[52:55], v[208:223]
  buffer_load_dwordx4 v[104:107], v2, s[32:35], s62 offen offset:3072 sc1
  v_mfma_f32_32x32x16_f16 v[224:239], a[164:167], v[48:51], v[224:239]
  buffer_load_dwordx2 v[132:133], v2, s[32:35], s13 offen sc1
  s_lshr_b32 s55, s55, 5
  s_or_b32 s55, s55, s11
  v_add_u32 v13, s55, v5
  ds_read_b64 v[140:141], v13 offset:4480
  s_add_u32 s55, s10, 3
  s_and_b32 s11, s55, 1
  s_lshl_b32 s11, s11, 3
  s_lshr_b32 s55, s55, 1
  s_lshl_b32 s55, s55, 10
  s_add_u32 s55, s55, s11
  s_add_u32 s13, s55, s12
  v_mfma_f32_32x32x16_f16 v[112:127], a[164:167], v[52:55], v[112:127]
  buffer_load_dwordx4 v[108:111], v2, s[32:35], s63 offen offset:3072 sc1
  v_mfma_f32_32x32x16_f16 v[192:207], a[168:171], v[56:59], v[192:207]
  buffer_load_dwordx2 v[134:135], v2, s[32:35], s13 offen sc1
  s_lshr_b32 s55, s55, 5
  s_or_b32 s55, s55, s11
  v_add_u32 v13, s55, v5
  ds_read_b64 v[142:143], v13 offset:4480
  v_and_b32 v12, 31, v1
  v_mul_u32_u24 v12, 896, v12
  v_lshl_add_u32 v12, v10, 4, v12
  s_mul_i32 s68, s20, 28672
  s_lshl4_add_u32 s68, s10, s68
  s_xor_b32 s55, s3, 1
  s_mul_i32 s55, s55, 12288
  v_mfma_f32_32x32x16_f16 v[208:223], a[168:171], v[60:63], v[208:223]
  s_add_u32 s62, s17, 12288
  buffer_load_dwordx4 v[16:19], v2, s[32:35], s62 offen offset:0 sc1
  s_add_u32 s55, s55, 28672
  v_add_u32 v253, s55, v2
  s_xor_b32 s55, s3, 2
  s_mul_i32 s55, s55, 12288
  s_add_u32 s55, s55, 32768
  v_add_u32 v254, s55, v2
  s_xor_b32 s55, s3, 3
  s_mul_i32 s55, s55, 12288
  s_add_u32 s55, s55, 36864
  v_add_u32 v255, s55, v2
  s_mul_i32 s55, s3, 12288
  v_mfma_f32_32x32x16_f16 v[224:239], a[172:175], v[56:59], v[224:239]
  s_add_u32 s55, s55, 28672
  v_add_u32 v252, s55, v2
  v_mfma_f32_32x32x16_f16 v[112:127], a[172:175], v[60:63], v[112:127]
  s_waitcnt vmcnt(19)
  v_xor_b32 v9, v64, v14
  s_waitcnt vmcnt(18)
  v_bitop3_b32 v9, v9, v68, v14 bitop3:0xf6
  s_waitcnt vmcnt(16)
  v_bitop3_b32 v9, v9, v72, v14 bitop3:0xf6
  s_waitcnt vmcnt(15)
  v_bitop3_b32 v9, v9, v76, v14 bitop3:0xf6
  v_and_b32 v9, s23, v9
  v_cmp_ne_u32 vcc, 0, v9
  s_cbranch_vccnz .Lvslow40
.Lvback41:
  s_add_u32 s63, s18, 12288
  buffer_load_dwordx4 v[20:23], v2, s[32:35], s63 offen offset:0 sc1
  v_mfma_f32_32x32x16_f16 v[192:207], a[176:179], v[64:67], v[192:207]
  v_mfma_f32_32x32x16_f16 v[208:223], a[176:179], v[68:71], v[208:223]
  buffer_load_dwordx4 v[24:27], v2, s[32:35], s62 offen offset:1024 sc1
  v_mfma_f32_32x32x16_f16 v[224:239], a[180:183], v[64:67], v[224:239]
  v_mfma_f32_32x32x16_f16 v[112:127], a[180:183], v[68:71], v[112:127]
  buffer_load_dwordx4 v[28:31], v2, s[32:35], s63 offen offset:1024 sc1
  v_mfma_f32_32x32x16_f16 v[192:207], a[184:187], v[72:75], v[192:207]
  v_mfma_f32_32x32x16_f16 v[208:223], a[184:187], v[76:79], v[208:223]
  buffer_load_dwordx4 v[32:35], v2, s[32:35], s62 offen offset:2048 sc1
  v_mfma_f32_32x32x16_f16 v[224:239], a[188:191], v[72:75], v[224:239]
  v_mfma_f32_32x32x16_f16 v[112:127], a[188:191], v[76:79], v[112:127]
  s_waitcnt vmcnt(18)
  v_xor_b32 v9, v80, v14
  s_waitcnt vmcnt(16)
  v_bitop3_b32 v9, v9, v84, v14 bitop3:0xf6
  s_waitcnt vmcnt(15)
  v_bitop3_b32 v9, v9, v88, v14 bitop3:0xf6
  s_waitcnt vmcnt(14)
  v_bitop3_b32 v9, v9, v92, v14 bitop3:0xf6
  v_and_b32 v9, s23, v9
  v_cmp_ne_u32 vcc, 0, v9
  s_cbranch_vccnz .Lvslow42
.Lvback43:
  buffer_load_dwordx4 v[36:39], v2, s[32:35], s63 offen offset:2048 sc1
  v_mfma_f32_32x32x16_f16 v[192:207], a[192:195], v[80:83], v[192:207]
  v_mfma_f32_32x32x16_f16 v[208:223], a[192:195], v[84:87], v[208:223]
  buffer_load_dwordx4 v[40:43], v2, s[32:35], s62 offen offset:3072 sc1
  v_mfma_f32_32x32x16_f16 v[224:239], a[196:199], v[80:83], v[224:239]
  v_mfma_f32_32x32x16_f16 v[112:127], a[196:199], v[84:87], v[112:127]
  buffer_load_dwordx4 v[44:47], v2, s[32:35], s63 offen offset:3072 sc1
  v_mfma_f32_32x32x16_f16 v[192:207], a[200:203], v[88:91], v[192:207]
  v_mfma_f32_32x32x16_f16 v[208:223], a[200:203], v[92:95], v[208:223]
  s_add_u32 s62, s17, 16384
  buffer_load_dwordx4 v[48:51], v2, s[32:35], s62 offen offset:0 sc1
  v_mfma_f32_32x32x16_f16 v[224:239], a[204:207], v[88:91], v[224:239]
  v_mfma_f32_32x32x16_f16 v[112:127], a[204:207], v[92:95], v[112:127]
  s_waitcnt vmcnt(16)
  v_xor_b32 v9, v96, v14
  s_waitcnt vmcnt(14)
  v_bitop3_b32 v9, v9, v100, v14 bitop3:0xf6
  s_waitcnt vmcnt(12)
  v_bitop3_b32 v9, v9, v104, v14 bitop3:0xf6
  s_waitcnt vmcnt(10)
  v_bitop3_b32 v9, v9, v108, v14 bitop3:0xf6
  v_and_b32 v9, s23, v9
  v_cmp_ne_u32 vcc, 0, v9
  s_cbranch_vccnz .Lvslow44
.Lvback45:
  s_add_u32 s63, s18, 16384
  buffer_load_dwordx4 v[52:55], v2, s[32:35], s63 offen offset:0 sc1
  v_mfma_f32_32x32x16_f16 v[192:207], a[208:211], v[96:99], v[192:207]
  v_mfma_f32_32x32x16_f16 v[208:223], a[208:211], v[100:103], v[208:223]
  buffer_load_dwordx4 v[56:59], v2, s[32:35], s62 offen offset:1024 sc1
  v_mfma_f32_32x32x16_f16 v[224:239], a[212:215], v[96:99], v[224:239]
  v_mfma_f32_32x32x16_f16 v[112:127], a[212:215], v[100:103], v[112:127]
  buffer_load_dwordx4 v[60:63], v2, s[32:35], s63 offen offset:1024 sc1
  v_mfma_f32_32x32x16_f16 v[192:207], a[216:219], v[104:107], v[192:207]
  v_mfma_f32_32x32x16_f16 v[208:223], a[216:219], v[108:111], v[208:223]
  buffer_load_dwordx4 v[64:67], v2, s[32:35], s62 offen offset:2048 sc1
  v_mfma_f32_32x32x16_f16 v[224:239], a[220:223], v[104:107], v[224:239]
  v_mfma_f32_32x32x16_f16 v[112:127], a[220:223], v[108:111], v[112:127]
  s_waitcnt vmcnt(12)
  v_xor_b32 v9, v16, v14
  s_waitcnt vmcnt(11)
  v_bitop3_b32 v9, v9, v20, v14 bitop3:0xf6
  s_waitcnt vmcnt(10)
  v_bitop3_b32 v9, v9, v24, v14 bitop3:0xf6
  s_waitcnt vmcnt(9)
  v_bitop3_b32 v9, v9, v28, v14 bitop3:0xf6
  v_and_b32 v9, s23, v9
  v_cmp_ne_u32 vcc, 0, v9
  s_cbranch_vccnz .Lvslow46
.Lvback47:
  buffer_load_dwordx4 v[68:71], v2, s[32:35], s63 offen offset:2048 sc1
  v_mfma_f32_32x32x16_f16 v[192:207], a[224:227], v[16:19], v[192:207]
  v_mfma_f32_32x32x16_f16 v[208:223], a[224:227], v[20:23], v[208:223]
  buffer_load_dwordx4 v[72:75], v2, s[32:35], s62 offen offset:3072 sc1
  v_mfma_f32_32x32x16_f16 v[224:239], a[228:231], v[16:19], v[224:239]
  v_mfma_f32_32x32x16_f16 v[112:127], a[228:231], v[20:23], v[112:127]
  buffer_load_dwordx4 v[76:79], v2, s[32:35], s63 offen offset:3072 sc1
  v_mfma_f32_32x32x16_f16 v[192:207], a[232:235], v[24:27], v[192:207]
  v_mfma_f32_32x32x16_f16 v[208:223], a[232:235], v[28:31], v[208:223]
  s_add_u32 s62, s17, 20480
  buffer_load_dwordx4 v[80:83], v2, s[32:35], s62 offen offset:0 sc1
  v_mfma_f32_32x32x16_f16 v[224:239], a[236:239], v[24:27], v[224:239]
  v_mfma_f32_32x32x16_f16 v[112:127], a[236:239], v[28:31], v[112:127]
  s_waitcnt vmcnt(12)
  v_xor_b32 v9, v32, v14
  s_waitcnt vmcnt(11)
  v_bitop3_b32 v9, v9, v36, v14 bitop3:0xf6
  s_waitcnt vmcnt(10)
  v_bitop3_b32 v9, v9, v40, v14 bitop3:0xf6
  s_waitcnt vmcnt(9)
  v_bitop3_b32 v9, v9, v44, v14 bitop3:0xf6
  v_and_b32 v9, s23, v9
  v_cmp_ne_u32 vcc, 0, v9
  s_cbranch_vccnz .Lvslow48
.Lvback49:
  s_add_u32 s63, s18, 20480
  buffer_load_dwordx4 v[84:87], v2, s[32:35], s63 offen offset:0 sc1
  v_mfma_f32_32x32x16_f16 v[192:207], a[240:243], v[32:35], v[192:207]
  v_mfma_f32_32x32x16_f16 v[208:223], a[240:243], v[36:39], v[208:223]
  buffer_load_dwordx4 v[88:91], v2, s[32:35], s62 offen offset:1024 sc1
  v_mfma_f32_32x32x16_f16 v[224:239], a[244:247], v[32:35], v[224:239]
  v_mfma_f32_32x32x16_f16 v[112:127], a[244:247], v[36:39], v[112:127]
  buffer_load_dwordx4 v[92:95], v2, s[32:35], s63 offen offset:1024 sc1
  v_mfma_f32_32x32x16_f16 v[192:207], a[248:251], v[40:43], v[192:207]
  v_mfma_f32_32x32x16_f16 v[208:223], a[248:251], v[44:47], v[208:223]
  buffer_load_dwordx4 v[96:99], v2, s[32:35], s62 offen offset:2048 sc1
  v_mfma_f32_32x32x16_f16 v[224:239], a[252:255], v[40:43], v[224:239]
  v_mfma_f32_32x32x16_f16 v[112:127], a[252:255], v[44:47], v[112:127]
  s_waitcnt vmcnt(12)
  v_xor_b32 v9, v48, v14
  s_waitcnt vmcnt(11)
  v_bitop3_b32 v9, v9, v52, v14 bitop3:0xf6
  s_waitcnt vmcnt(10)
  v_bitop3_b32 v9, v9, v56, v14 bitop3:0xf6
  s_waitcnt vmcnt(9)
  v_bitop3_b32 v9, v9, v60, v14 bitop3:0xf6
  v_and_b32 v9, s23, v9
  v_cmp_ne_u32 vcc, 0, v9
  s_cbranch_vccnz .Lvslow50
.Lvback51:
  buffer_load_dwordx4 v[100:103], v2, s[32:35], s63 offen offset:2048 sc1
  v_mfma_f32_32x32x16_f16 v[192:207], a[0:3], v[48:51], v[192:207]
  v_mfma_f32_32x32x16_f16 v[208:223], a[0:3], v[52:55], v[208:223]
  buffer_load_dwordx4 v[104:107], v2, s[32:35], s62 offen offset:3072 sc1
  v_mfma_f32_32x32x16_f16 v[224:239], a[4:7], v[48:51], v[224:239]
  v_mfma_f32_32x32x16_f16 v[112:127], a[4:7], v[52:55], v[112:127]
  buffer_load_dwordx4 v[108:111], v2, s[32:35], s63 offen offset:3072 sc1
  v_mfma_f32_32x32x16_f16 v[192:207], a[8:11], v[56:59], v[192:207]
  v_mfma_f32_32x32x16_f16 v[208:223], a[8:11], v[60:63], v[208:223]
  s_add_u32 s62, s17, 24576
  buffer_load_dwordx4 v[16:19], v2, s[32:35], s62 offen offset:0 sc1
  v_mfma_f32_32x32x16_f16 v[224:239], a[12:15], v[56:59], v[224:239]
  v_mfma_f32_32x32x16_f16 v[112:127], a[12:15], v[60:63], v[112:127]
  s_waitcnt vmcnt(12)
  v_xor_b32 v9, v64, v14
  s_waitcnt vmcnt(11)
  v_bitop3_b32 v9, v9, v68, v14 bitop3:0xf6
  s_waitcnt vmcnt(10)
  v_bitop3_b32 v9, v9, v72, v14 bitop3:0xf6
  s_waitcnt vmcnt(9)
  v_bitop3_b32 v9, v9, v76, v14 bitop3:0xf6
  v_and_b32 v9, s23, v9
  v_cmp_ne_u32 vcc, 0, v9
  s_cbranch_vccnz .Lvslow52
.Lvback53:
  s_add_u32 s63, s18, 24576
  buffer_load_dwordx4 v[20:23], v2, s[32:35], s63 offen offset:0 sc1
  v_mfma_f32_32x32x16_f16 v[192:207], a[16:19], v[64:67], v[192:207]
  v_mfma_f32_32x32x16_f16 v[208:223], a[16:19], v[68:71], v[208:223]
  buffer_load_dwordx4 v[24:27], v2, s[32:35], s62 offen offset:1024 sc1
  v_mfma_f32_32x32x16_f16 v[224:239], a[20:23], v[64:67], v[224:239]
  v_mfma_f32_32x32x16_f16 v[112:127], a[20:23], v[68:71], v[112:127]
  buffer_load_dwordx4 v[28:31], v2, s[32:35], s63 offen offset:1024 sc1
  v_mfma_f32_32x32x16_f16 v[192:207], a[24:27], v[72:75], v[192:207]
  v_mfma_f32_32x32x16_f16 v[208:223], a[24:27], v[76:79], v[208:223]
  buffer_load_dwordx4 v[32:35], v2, s[32:35], s62 offen offset:2048 sc1
  v_mfma_f32_32x32x16_f16 v[224:239], a[28:31], v[72:75], v[224:239]
  v_mfma_f32_32x32x16_f16 v[112:127], a[28:31], v[76:79], v[112:127]
  s_waitcnt vmcnt(12)
  v_xor_b32 v9, v80, v14
  s_waitcnt vmcnt(11)
  v_bitop3_b32 v9, v9, v84, v14 bitop3:0xf6
  s_waitcnt vmcnt(10)
  v_bitop3_b32 v9, v9, v88, v14 bitop3:0xf6
  s_waitcnt vmcnt(9)
  v_bitop3_b32 v9, v9, v92, v14 bitop3:0xf6
  v_and_b32 v9, s23, v9
  v_cmp_ne_u32 vcc, 0, v9
  s_cbranch_vccnz .Lvslow54
.Lvback55:
  buffer_load_dwordx4 v[36:39], v2, s[32:35], s63 offen offset:2048 sc1
  v_mfma_f32_32x32x16_f16 v[192:207], a[32:35], v[80:83], v[192:207]
  v_mfma_f32_32x32x16_f16 v[208:223], a[32:35], v[84:87], v[208:223]
  buffer_load_dwordx4 v[40:43], v2, s[32:35], s62 offen offset:3072 sc1
  v_mfma_f32_32x32x16_f16 v[224:239], a[36:39], v[80:83], v[224:239]
  v_mfma_f32_32x32x16_f16 v[112:127], a[36:39], v[84:87], v[112:127]
  buffer_load_dwordx4 a[88:91], v2, s[32:35], s64 offen offset:2048 sc1
  v_mfma_f32_32x32x16_f16 v[192:207], a[40:43], v[88:91], v[192:207]
  v_mfma_f32_32x32x16_f16 v[208:223], a[40:43], v[92:95], v[208:223]
  buffer_load_dwordx4 v[44:47], v2, s[32:35], s63 offen offset:3072 sc1
  v_mfma_f32_32x32x16_f16 v[224:239], a[44:47], v[88:91], v[224:239]
  v_mfma_f32_32x32x16_f16 v[112:127], a[44:47], v[92:95], v[112:127]
  s_waitcnt vmcnt(12)
  v_xor_b32 v9, v96, v14
  s_waitcnt vmcnt(11)
  v_bitop3_b32 v9, v9, v100, v14 bitop3:0xf6
  s_waitcnt vmcnt(10)
  v_bitop3_b32 v9, v9, v104, v14 bitop3:0xf6
  s_waitcnt vmcnt(9)
  v_bitop3_b32 v9, v9, v108, v14 bitop3:0xf6
  v_and_b32 v9, s23, v9
  v_cmp_ne_u32 vcc, 0, v9
  s_cbranch_vccnz .Lvslow56
.Lvback57:
  buffer_load_dwordx4 a[92:95], v2, s[32:35], s64 offen offset:3072 sc1
  v_mfma_f32_32x32x16_f16 v[192:207], a[48:51], v[96:99], v[192:207]
  v_mfma_f32_32x32x16_f16 v[208:223], a[48:51], v[100:103], v[208:223]
  v_mfma_f32_32x32x16_f16 v[224:239], a[52:55], v[96:99], v[224:239]
  v_mfma_f32_32x32x16_f16 v[112:127], a[52:55], v[100:103], v[112:127]
  v_mfma_f32_32x32x16_f16 v[192:207], a[56:59], v[104:107], v[192:207]
  v_mfma_f32_32x32x16_f16 v[208:223], a[56:59], v[108:111], v[208:223]
  v_mfma_f32_32x32x16_f16 v[224:239], a[60:63], v[104:107], v[224:239]
  v_mfma_f32_32x32x16_f16 v[112:127], a[60:63], v[108:111], v[112:127]
  s_waitcnt vmcnt(9)
  v_xor_b32 v9, v16, v14
  s_waitcnt vmcnt(8)
  v_bitop3_b32 v9, v9, v20, v14 bitop3:0xf6
  s_waitcnt vmcnt(7)
  v_bitop3_b32 v9, v9, v24, v14 bitop3:0xf6
  s_waitcnt vmcnt(6)
  v_bitop3_b32 v9, v9, v28, v14 bitop3:0xf6
  v_and_b32 v9, s23, v9
  v_cmp_ne_u32 vcc, 0, v9
  s_cbranch_vccnz .Lvslow58
.Lvback59:
  v_mfma_f32_32x32x16_f16 v[192:207], a[64:67], v[16:19], v[192:207]
  v_mfma_f32_32x32x16_f16 v[208:223], a[64:67], v[20:23], v[208:223]
  v_mfma_f32_32x32x16_f16 v[224:239], a[68:71], v[16:19], v[224:239]
  v_mfma_f32_32x32x16_f16 v[112:127], a[68:71], v[20:23], v[112:127]
  v_mfma_f32_32x32x16_f16 v[192:207], a[72:75], v[24:27], v[192:207]
  v_mfma_f32_32x32x16_f16 v[208:223], a[72:75], v[28:31], v[208:223]
  v_mfma_f32_32x32x16_f16 v[224:239], a[76:79], v[24:27], v[224:239]
  v_cvt_f32_f16 v144, v128
  v_cvt_f32_f16_sdwa v145, v128 dst_sel:DWORD dst_unused:UNUSED_PAD src0_sel:WORD_1
  v_cvt_f32_f16 v146, v129
  v_cvt_f32_f16_sdwa v147, v129 dst_sel:DWORD dst_unused:UNUSED_PAD src0_sel:WORD_1
  v_cvt_f32_f16 v148, v130
  v_cvt_f32_f16_sdwa v149, v130 dst_sel:DWORD dst_unused:UNUSED_PAD src0_sel:WORD_1
  v_cvt_f32_f16 v150, v131
  v_cvt_f32_f16_sdwa v151, v131 dst_sel:DWORD dst_unused:UNUSED_PAD src0_sel:WORD_1
  v_cvt_f32_f16 v152, v132
  v_cvt_f32_f16_sdwa v153, v132 dst_sel:DWORD dst_unused:UNUSED_PAD src0_sel:WORD_1
  v_cvt_f32_f16 v154, v133
  v_cvt_f32_f16_sdwa v155, v133 dst_sel:DWORD dst_unused:UNUSED_PAD src0_sel:WORD_1
  v_cvt_f32_f16 v156, v134
  v_cvt_f32_f16_sdwa v157, v134 dst_sel:DWORD dst_unused:UNUSED_PAD src0_sel:WORD_1
  v_cvt_f32_f16 v158, v135
  v_cvt_f32_f16_sdwa v159, v135 dst_sel:DWORD dst_unused:UNUSED_PAD src0_sel:WORD_1
  v_mfma_f32_32x32x16_f16 v[112:127], a[76:79], v[28:31], v[112:127]
  s_waitcnt vmcnt(5)
  v_xor_b32 v9, v32, v14
  s_waitcnt vmcnt(4)
  v_bitop3_b32 v9, v9, v36, v14 bitop3:0xf6
  s_waitcnt vmcnt(3)
  v_bitop3_b32 v9, v9, v40, v14 bitop3:0xf6
  s_waitcnt vmcnt(1)
  v_bitop3_b32 v9, v9, v44, v14 bitop3:0xf6
  v_and_b32 v9, s23, v9
  v_cmp_ne_u32 vcc, 0, v9
  s_cbranch_vccnz .Lvslow60
.Lvback61:
  v_mfma_f32_32x32x16_f16 v[192:207], a[80:83], v[32:35], v[192:207]
  v_mfma_f32_32x32x16_f16 v[208:223], a[80:83], v[36:39], v[208:223]
  v_mfma_f32_32x32x16_f16 v[224:239], a[84:87], v[32:35], v[224:239]
  v_mfma_f32_32x32x16_f16 v[112:127], a[84:87], v[36:39], v[112:127]
  v_mfma_f32_32x32x16_f16 v[192:207], a[88:91], v[40:43], v[192:207]
  v_mfma_f32_32x32x16_f16 v[208:223], a[88:91], v[44:47], v[208:223]
  s_waitcnt vmcnt(0)
  v_mfma_f32_32x32x16_f16 v[224:239], a[92:95], v[40:43], v[224:239]
  v_mfma_f32_32x32x16_f16 v[112:127], a[92:95], v[44:47], v[112:127]
  s_cmp_ge_u32 s3, 2
  s_nop 9
  s_cbranch_scc1 .Lt162
  ds_write_b128 v253, v[208:211] offset:0
  ds_write_b128 v253, v[212:215] offset:1024
  ds_write_b128 v253, v[216:219] offset:2048
  ds_write_b128 v253, v[220:223] offset:3072
  ds_write_b128 v254, v[224:227] offset:0
  ds_write_b128 v254, v[228:231] offset:1024
  ds_write_b128 v254, v[232:235] offset:2048
  ds_write_b128 v254, v[236:239] offset:3072
  ds_write_b128 v255, v[112:115] offset:0
  ds_write_b128 v255, v[116:119] offset:1024
  ds_write_b128 v255, v[120:123] offset:2048
  ds_write_b128 v255, v[124:127] offset:3072
  s_waitcnt lgkmcnt(0)
  s_barrier
  ds_read_b128 v[16:19], v252 offset:0
  ds_read_b128 v[32:35], v252 offset:4096
  ds_read_b128 v[48:51], v252 offset:8192
  ds_read_b128 v[20:23], v252 offset:1024
  ds_read_b128 v[36:39], v252 offset:5120
  ds_read_b128 v[52:55], v252 offset:9216
  ds_read_b128 v[24:27], v252 offset:2048
  ds_read_b128 v[40:43], v252 offset:6144
  ds_read_b128 v[56:59], v252 offset:10240
  ds_read_b128 v[28:31], v252 offset:3072
  ds_read_b128 v[44:47], v252 offset:7168
  ds_read_b128 v[60:63], v252 offset:11264
  s_waitcnt lgkmcnt(11)
  v_add_f32 v192, v192, v16
  s_waitcnt lgkmcnt(9)
  v_add_f32 v32, v32, v48
  v_add_f32 v193, v193, v17
  v_add_f32 v33, v33, v49
  v_add_f32 v194, v194, v18
  v_add_f32 v34, v34, v50
  v_add_f32 v195, v195, v19
  v_add_f32 v35, v35, v51
  s_waitcnt lgkmcnt(8)
  v_add_f32 v196, v196, v20
  s_waitcnt lgkmcnt(6)
  v_add_f32 v36, v36, v52
  v_add_f32 v197, v197, v21
  v_add_f32 v37, v37, v53
  v_add_f32 v198, v198, v22
  v_add_f32 v38, v38, v54
  v_add_f32 v199, v199, v23
  v_add_f32 v39, v39, v55
  v_add_f32 v192, v192, v32
  v_add_f32 v193, v193, v33
  v_add_f32 v194, v194, v34
  v_add_f32 v195, v195, v35
  v_add_f32 v196, v196, v36
  v_add_f32 v197, v197, v37
  v_add_f32 v198, v198, v38
  v_add_f32 v199, v199, v39
  v_fma_mix_f32 v192, v192, v136, v144 op_sel:[0,0,0] op_sel_hi:[0,1,0]
  v_fma_mix_f32 v193, v193, v136, v145 op_sel:[0,1,0] op_sel_hi:[0,1,0]
  v_fma_mix_f32 v194, v194, v137, v146 op_sel:[0,0,0] op_sel_hi:[0,1,0]
  v_fma_mix_f32 v195, v195, v137, v147 op_sel:[0,1,0] op_sel_hi:[0,1,0]
  v_fma_mix_f32 v196, v196, v138, v148 op_sel:[0,0,0] op_sel_hi:[0,1,0]
  v_fma_mix_f32 v197, v197, v138, v149 op_sel:[0,1,0] op_sel_hi:[0,1,0]
  v_fma_mix_f32 v198, v198, v139, v150 op_sel:[0,0,0] op_sel_hi:[0,1,0]
  v_fma_mix_f32 v199, v199, v139, v151 op_sel:[0,1,0] op_sel_hi:[0,1,0]
  v_cvt_pk_bf16_f32 v128, v192, v193
  v_cvt_pk_bf16_f32 v129, v194, v195
  v_cvt_pk_bf16_f32 v130, v196, v197
  v_cvt_pk_bf16_f32 v131, v198, v199
  s_nop 0
  v_permlane32_swap_b32 v128, v130
  v_permlane32_swap_b32 v129, v131
  buffer_store_dwordx4 v[128:131], v12, s[40:43], s68 offen offset:0
  s_waitcnt lgkmcnt(5)
  v_add_f32 v200, v200, v24
  s_waitcnt lgkmcnt(3)
  v_add_f32 v40, v40, v56
  v_add_f32 v201, v201, v25
  v_add_f32 v41, v41, v57
  v_add_f32 v202, v202, v26
  v_add_f32 v42, v42, v58
  v_add_f32 v203, v203, v27
  v_add_f32 v43, v43, v59
  s_waitcnt lgkmcnt(2)
  v_add_f32 v204, v204, v28
  s_waitcnt lgkmcnt(0)
  v_add_f32 v44, v44, v60
  v_add_f32 v205, v205, v29
  v_add_f32 v45, v45, v61
  v_add_f32 v206, v206, v30
  v_add_f32 v46, v46, v62
  v_add_f32 v207, v207, v31
  v_add_f32 v47, v47, v63
  v_add_f32 v200, v200, v40
  v_add_f32 v201, v201, v41
  v_add_f32 v202, v202, v42
  v_add_f32 v203, v203, v43
  v_add_f32 v204, v204, v44
  v_add_f32 v205, v205, v45
  v_add_f32 v206, v206, v46
  v_add_f32 v207, v207, v47
  v_fma_mix_f32 v200, v200, v140, v152 op_sel:[0,0,0] op_sel_hi:[0,1,0]
  v_fma_mix_f32 v201, v201, v140, v153 op_sel:[0,1,0] op_sel_hi:[0,1,0]
  v_fma_mix_f32 v202, v202, v141, v154 op_sel:[0,0,0] op_sel_hi:[0,1,0]
  v_fma_mix_f32 v203, v203, v141, v155 op_sel:[0,1,0] op_sel_hi:[0,1,0]
  v_fma_mix_f32 v204, v204, v142, v156 op_sel:[0,0,0] op_sel_hi:[0,1,0]
  v_fma_mix_f32 v205, v205, v142, v157 op_sel:[0,1,0] op_sel_hi:[0,1,0]
  v_fma_mix_f32 v206, v206, v143, v158 op_sel:[0,0,0] op_sel_hi:[0,1,0]
  v_fma_mix_f32 v207, v207, v143, v159 op_sel:[0,1,0] op_sel_hi:[0,1,0]
  v_cvt_pk_bf16_f32 v132, v200, v201
  v_cvt_pk_bf16_f32 v133, v202, v203
  v_cvt_pk_bf16_f32 v134, v204, v205
  v_cvt_pk_bf16_f32 v135, v206, v207
  s_nop 0
  v_permlane32_swap_b32 v132, v134
  v_permlane32_swap_b32 v133, v135
  buffer_store_dwordx4 v[132:135], v12, s[40:43], s68 offen offset:32
  s_endpgm
.Lt162:
  ds_write_b128 v254, v[192:195] offset:0
  ds_write_b128 v254, v[196:199] offset:1024
  ds_write_b128 v254, v[200:203] offset:2048
  ds_write_b128 v254, v[204:207] offset:3072
  ds_write_b128 v255, v[208:211] offset:0
  ds_write_b128 v255, v[212:215] offset:1024
  ds_write_b128 v255, v[216:219] offset:2048
  ds_write_b128 v255, v[220:223] offset:3072
  ds_write_b128 v253, v[112:115] offset:0
  ds_write_b128 v253, v[116:119] offset:1024
  ds_write_b128 v253, v[120:123] offset:2048
  ds_write_b128 v253, v[124:127] offset:3072
  s_waitcnt lgkmcnt(0)
  s_barrier
  ds_read_b128 v[16:19], v252 offset:0
  ds_read_b128 v[32:35], v252 offset:4096
  ds_read_b128 v[48:51], v252 offset:8192
  ds_read_b128 v[20:23], v252 offset:1024
  ds_read_b128 v[36:39], v252 offset:5120
  ds_read_b128 v[52:55], v252 offset:9216
  ds_read_b128 v[24:27], v252 offset:2048
  ds_read_b128 v[40:43], v252 offset:6144
  ds_read_b128 v[56:59], v252 offset:10240
  ds_read_b128 v[28:31], v252 offset:3072
  ds_read_b128 v[44:47], v252 offset:7168
  ds_read_b128 v[60:63], v252 offset:11264
  s_waitcnt lgkmcnt(11)
  v_add_f32 v224, v224, v16
  s_waitcnt lgkmcnt(9)
  v_add_f32 v32, v32, v48
  v_add_f32 v225, v225, v17
  v_add_f32 v33, v33, v49
  v_add_f32 v226, v226, v18
  v_add_f32 v34, v34, v50
  v_add_f32 v227, v227, v19
  v_add_f32 v35, v35, v51
  s_waitcnt lgkmcnt(8)
  v_add_f32 v228, v228, v20
  s_waitcnt lgkmcnt(6)
  v_add_f32 v36, v36, v52
  v_add_f32 v229, v229, v21
  v_add_f32 v37, v37, v53
  v_add_f32 v230, v230, v22
  v_add_f32 v38, v38, v54
  v_add_f32 v231, v231, v23
  v_add_f32 v39, v39, v55
  v_add_f32 v224, v224, v32
  v_add_f32 v225, v225, v33
  v_add_f32 v226, v226, v34
  v_add_f32 v227, v227, v35
  v_add_f32 v228, v228, v36
  v_add_f32 v229, v229, v37
  v_add_f32 v230, v230, v38
  v_add_f32 v231, v231, v39
  v_fma_mix_f32 v224, v224, v136, v144 op_sel:[0,0,0] op_sel_hi:[0,1,0]
  v_fma_mix_f32 v225, v225, v136, v145 op_sel:[0,1,0] op_sel_hi:[0,1,0]
  v_fma_mix_f32 v226, v226, v137, v146 op_sel:[0,0,0] op_sel_hi:[0,1,0]
  v_fma_mix_f32 v227, v227, v137, v147 op_sel:[0,1,0] op_sel_hi:[0,1,0]
  v_fma_mix_f32 v228, v228, v138, v148 op_sel:[0,0,0] op_sel_hi:[0,1,0]
  v_fma_mix_f32 v229, v229, v138, v149 op_sel:[0,1,0] op_sel_hi:[0,1,0]
  v_fma_mix_f32 v230, v230, v139, v150 op_sel:[0,0,0] op_sel_hi:[0,1,0]
  v_fma_mix_f32 v231, v231, v139, v151 op_sel:[0,1,0] op_sel_hi:[0,1,0]
  v_cvt_pk_bf16_f32 v128, v224, v225
  v_cvt_pk_bf16_f32 v129, v226, v227
  v_cvt_pk_bf16_f32 v130, v228, v229
  v_cvt_pk_bf16_f32 v131, v230, v231
  s_nop 0
  v_permlane32_swap_b32 v128, v130
  v_permlane32_swap_b32 v129, v131
  buffer_store_dwordx4 v[128:131], v12, s[40:43], s68 offen offset:0
  s_waitcnt lgkmcnt(5)
  v_add_f32 v232, v232, v24
  s_waitcnt lgkmcnt(3)
  v_add_f32 v40, v40, v56
  v_add_f32 v233, v233, v25
  v_add_f32 v41, v41, v57
  v_add_f32 v234, v234, v26
  v_add_f32 v42, v42, v58
  v_add_f32 v235, v235, v27
  v_add_f32 v43, v43, v59
  s_waitcnt lgkmcnt(2)
  v_add_f32 v236, v236, v28
  s_waitcnt lgkmcnt(0)
  v_add_f32 v44, v44, v60
  v_add_f32 v237, v237, v29
  v_add_f32 v45, v45, v61
  v_add_f32 v238, v238, v30
  v_add_f32 v46, v46, v62
  v_add_f32 v239, v239, v31
  v_add_f32 v47, v47, v63
  v_add_f32 v232, v232, v40
  v_add_f32 v233, v233, v41
  v_add_f32 v234, v234, v42
  v_add_f32 v235, v235, v43
  v_add_f32 v236, v236, v44
  v_add_f32 v237, v237, v45
  v_add_f32 v238, v238, v46
  v_add_f32 v239, v239, v47
  v_fma_mix_f32 v232, v232, v140, v152 op_sel:[0,0,0] op_sel_hi:[0,1,0]
  v_fma_mix_f32 v233, v233, v140, v153 op_sel:[0,1,0] op_sel_hi:[0,1,0]
  v_fma_mix_f32 v234, v234, v141, v154 op_sel:[0,0,0] op_sel_hi:[0,1,0]
  v_fma_mix_f32 v235, v235, v141, v155 op_sel:[0,1,0] op_sel_hi:[0,1,0]
  v_fma_mix_f32 v236, v236, v142, v156 op_sel:[0,0,0] op_sel_hi:[0,1,0]
  v_fma_mix_f32 v237, v237, v142, v157 op_sel:[0,1,0] op_sel_hi:[0,1,0]
  v_fma_mix_f32 v238, v238, v143, v158 op_sel:[0,0,0] op_sel_hi:[0,1,0]
  v_fma_mix_f32 v239, v239, v143, v159 op_sel:[0,1,0] op_sel_hi:[0,1,0]
  v_cvt_pk_bf16_f32 v132, v232, v233
  v_cvt_pk_bf16_f32 v133, v234, v235
  v_cvt_pk_bf16_f32 v134, v236, v237
  v_cvt_pk_bf16_f32 v135, v238, v239
  s_nop 0
  v_permlane32_swap_b32 v132, v134
  v_permlane32_swap_b32 v133, v135
  s_mov_b32 exec_hi, 0
  buffer_store_dwordx4 v[132:135], v12, s[40:43], s68 offen offset:32
  s_endpgm
.Lexit1:
  s_endpgm
.Lwfslow21:
  s_mov_b32 s56, 30000
.Lpoll63:
  buffer_load_dword v9, v15, s[32:35], s47 offen sc1
  s_sub_u32 s56, s56, 1
  s_cbranch_scc1 .Lpolled64
  s_waitcnt vmcnt(0)
  v_cmp_eq_u32 vcc, s69, v9
  s_cmp_eq_u64 vcc, -1
  s_cbranch_scc0 .Lpoll63
.Lpolled64:
  s_branch .Lwfback22
.Lrslow27:
  s_mov_b32 s56, 30000
.Lrpoll65:
  buffer_load_dwordx4 v[96:99], v14, s[32:35], s68 offen offset:0 sc1
  buffer_load_dwordx4 v[100:103], v14, s[32:35], s68 offen offset:896 sc1
  buffer_load_dwordx4 v[104:107], v14, s[32:35], s68 offen offset:1792 sc1
  buffer_load_dwordx4 v[108:111], v14, s[32:35], s68 offen offset:2688 sc1
  buffer_load_dwordx4 v[112:115], v14, s[32:35], s67 offen offset:0 sc1
  buffer_load_dwordx4 v[116:119], v14, s[32:35], s67 offen offset:896 sc1
  buffer_load_dwordx4 v[120:123], v14, s[32:35], s67 offen offset:1792 sc1
  buffer_load_dwordx4 v[124:127], v14, s[32:35], s67 offen offset:2688 sc1
  s_sub_u32 s56, s56, 1
  s_cbranch_scc1 .Lrback28
  s_waitcnt vmcnt(0)
  v_cmp_eq_u32 vcc, s69, v97
  v_cmp_eq_u32 s[54:55], s69, v99
  s_and_b64 vcc, vcc, s[54:55]
  v_cmp_eq_u32 s[54:55], s69, v101
  s_and_b64 vcc, vcc, s[54:55]
  v_cmp_eq_u32 s[54:55], s69, v103
  s_and_b64 vcc, vcc, s[54:55]
  v_cmp_eq_u32 s[54:55], s69, v105
  s_and_b64 vcc, vcc, s[54:55]
  v_cmp_eq_u32 s[54:55], s69, v107
  s_and_b64 vcc, vcc, s[54:55]
  v_cmp_eq_u32 s[54:55], s69, v109
  s_and_b64 vcc, vcc, s[54:55]
  v_cmp_eq_u32 s[54:55], s69, v111
  s_and_b64 vcc, vcc, s[54:55]
  v_cmp_eq_u32 s[54:55], s69, v113
  s_and_b64 vcc, vcc, s[54:55]
  v_cmp_eq_u32 s[54:55], s69, v115
  s_and_b64 vcc, vcc, s[54:55]
  v_cmp_eq_u32 s[54:55], s69, v117
  s_and_b64 vcc, vcc, s[54:55]
  v_cmp_eq_u32 s[54:55], s69, v119
  s_and_b64 vcc, vcc, s[54:55]
  v_cmp_eq_u32 s[54:55], s69, v121
  s_and_b64 vcc, vcc, s[54:55]
  v_cmp_eq_u32 s[54:55], s69, v123
  s_and_b64 vcc, vcc, s[54:55]
  v_cmp_eq_u32 s[54:55], s69, v125
  s_and_b64 vcc, vcc, s[54:55]
  v_cmp_eq_u32 s[54:55], s69, v127
  s_and_b64 vcc, vcc, s[54:55]
  s_cmp_eq_u64 vcc, -1
  s_cbranch_scc0 .Lrpoll65
  s_branch .Lrback28
.Lvslow34:
  s_mov_b32 s56, 30000
.Lvpoll66:
  s_sub_u32 s56, s56, 1
  s_cbranch_scc1 .Lvback35
  buffer_load_dwordx4 v[16:19], v2, s[32:35], s17 offen offset:0 sc1
  buffer_load_dwordx4 v[20:23], v2, s[32:35], s18 offen offset:0 sc1
  buffer_load_dwordx4 v[24:27], v2, s[32:35], s17 offen offset:1024 sc1
  buffer_load_dwordx4 v[28:31], v2, s[32:35], s18 offen offset:1024 sc1
  buffer_load_dwordx4 v[32:35], v2, s[32:35], s17 offen offset:2048 sc1
  buffer_load_dwordx4 v[36:39], v2, s[32:35], s18 offen offset:2048 sc1
  buffer_load_dwordx4 v[40:43], v2, s[32:35], s17 offen offset:3072 sc1
  buffer_load_dwordx4 v[44:47], v2, s[32:35], s18 offen offset:3072 sc1
  s_add_u32 s24, s17, 4096
  buffer_load_dwordx4 v[48:51], v2, s[32:35], s24 offen offset:0 sc1
  s_add_u32 s25, s18, 4096
  buffer_load_dwordx4 v[52:55], v2, s[32:35], s25 offen offset:0 sc1
  buffer_load_dwordx4 v[56:59], v2, s[32:35], s24 offen offset:1024 sc1
  buffer_load_dwordx4 v[60:63], v2, s[32:35], s25 offen offset:1024 sc1
  buffer_load_dwordx4 v[64:67], v2, s[32:35], s24 offen offset:2048 sc1
  s_waitcnt vmcnt(0)
  v_xor_b32 v9, v16, v14
  v_bitop3_b32 v9, v9, v20, v14 bitop3:0xf6
  v_bitop3_b32 v9, v9, v24, v14 bitop3:0xf6
  v_bitop3_b32 v9, v9, v28, v14 bitop3:0xf6
  v_and_b32 v9, s23, v9
  v_cmp_ne_u32 vcc, 0, v9
  s_cbranch_vccnz .Lvpoll66
  s_branch .Lvback35
.Lvslow36:
  s_mov_b32 s56, 30000
.Lvpoll67:
  s_sub_u32 s56, s56, 1
  s_cbranch_scc1 .Lvback37
  buffer_load_dwordx4 v[32:35], v2, s[32:35], s17 offen offset:2048 sc1
  buffer_load_dwordx4 v[36:39], v2, s[32:35], s18 offen offset:2048 sc1
  buffer_load_dwordx4 v[40:43], v2, s[32:35], s17 offen offset:3072 sc1
  buffer_load_dwordx4 v[44:47], v2, s[32:35], s18 offen offset:3072 sc1
  s_add_u32 s24, s17, 4096
  buffer_load_dwordx4 v[48:51], v2, s[32:35], s24 offen offset:0 sc1
  s_add_u32 s25, s18, 4096
  buffer_load_dwordx4 v[52:55], v2, s[32:35], s25 offen offset:0 sc1
  buffer_load_dwordx4 v[56:59], v2, s[32:35], s24 offen offset:1024 sc1
  buffer_load_dwordx4 v[60:63], v2, s[32:35], s25 offen offset:1024 sc1
  buffer_load_dwordx4 v[64:67], v2, s[32:35], s24 offen offset:2048 sc1
  buffer_load_dwordx4 v[68:71], v2, s[32:35], s25 offen offset:2048 sc1
  buffer_load_dwordx4 v[72:75], v2, s[32:35], s24 offen offset:3072 sc1
  buffer_load_dwordx4 v[76:79], v2, s[32:35], s25 offen offset:3072 sc1
  s_add_u32 s24, s17, 8192
  buffer_load_dwordx4 v[80:83], v2, s[32:35], s24 offen offset:0 sc1
  s_waitcnt vmcnt(0)
  v_xor_b32 v9, v32, v14
  v_bitop3_b32 v9, v9, v36, v14 bitop3:0xf6
  v_bitop3_b32 v9, v9, v40, v14 bitop3:0xf6
  v_bitop3_b32 v9, v9, v44, v14 bitop3:0xf6
  v_and_b32 v9, s23, v9
  v_cmp_ne_u32 vcc, 0, v9
  s_cbranch_vccnz .Lvpoll67
  s_branch .Lvback37
.Lvslow38:
  s_mov_b32 s56, 30000
.Lvpoll68:
  s_sub_u32 s56, s56, 1
  s_cbranch_scc1 .Lvback39
  s_add_u32 s24, s17, 4096
  buffer_load_dwordx4 v[48:51], v2, s[32:35], s24 offen offset:0 sc1
  s_add_u32 s25, s18, 4096
  buffer_load_dwordx4 v[52:55], v2, s[32:35], s25 offen offset:0 sc1
  buffer_load_dwordx4 v[56:59], v2, s[32:35], s24 offen offset:1024 sc1
  buffer_load_dwordx4 v[60:63], v2, s[32:35], s25 offen offset:1024 sc1
  buffer_load_dwordx4 v[64:67], v2, s[32:35], s24 offen offset:2048 sc1
  buffer_load_dwordx4 v[68:71], v2, s[32:35], s25 offen offset:2048 sc1
  buffer_load_dwordx4 v[72:75], v2, s[32:35], s24 offen offset:3072 sc1
  buffer_load_dwordx4 v[76:79], v2, s[32:35], s25 offen offset:3072 sc1
  s_add_u32 s24, s17, 8192
  buffer_load_dwordx4 v[80:83], v2, s[32:35], s24 offen offset:0 sc1
  s_add_u32 s25, s18, 8192
  buffer_load_dwordx4 v[84:87], v2, s[32:35], s25 offen offset:0 sc1
  buffer_load_dwordx4 v[88:91], v2, s[32:35], s24 offen offset:1024 sc1
  buffer_load_dwordx4 v[92:95], v2, s[32:35], s25 offen offset:1024 sc1
  buffer_load_dwordx4 v[96:99], v2, s[32:35], s24 offen offset:2048 sc1
  s_waitcnt vmcnt(0)
  v_xor_b32 v9, v48, v14
  v_bitop3_b32 v9, v9, v52, v14 bitop3:0xf6
  v_bitop3_b32 v9, v9, v56, v14 bitop3:0xf6
  v_bitop3_b32 v9, v9, v60, v14 bitop3:0xf6
  v_and_b32 v9, s23, v9
  v_cmp_ne_u32 vcc, 0, v9
  s_cbranch_vccnz .Lvpoll68
  s_branch .Lvback39
.Lvslow40:
  s_mov_b32 s56, 30000
.Lvpoll69:
  s_sub_u32 s56, s56, 1
  s_cbranch_scc1 .Lvback41
  s_add_u32 s24, s17, 4096
  buffer_load_dwordx4 v[64:67], v2, s[32:35], s24 offen offset:2048 sc1
  s_add_u32 s25, s18, 4096
  buffer_load_dwordx4 v[68:71], v2, s[32:35], s25 offen offset:2048 sc1
  buffer_load_dwordx4 v[72:75], v2, s[32:35], s24 offen offset:3072 sc1
  buffer_load_dwordx4 v[76:79], v2, s[32:35], s25 offen offset:3072 sc1
  s_add_u32 s24, s17, 8192
  buffer_load_dwordx4 v[80:83], v2, s[32:35], s24 offen offset:0 sc1
  s_add_u32 s25, s18, 8192
  buffer_load_dwordx4 v[84:87], v2, s[32:35], s25 offen offset:0 sc1
  buffer_load_dwordx4 v[88:91], v2, s[32:35], s24 offen offset:1024 sc1
  buffer_load_dwordx4 v[92:95], v2, s[32:35], s25 offen offset:1024 sc1
  buffer_load_dwordx4 v[96:99], v2, s[32:35], s24 offen offset:2048 sc1
  buffer_load_dwordx4 v[100:103], v2, s[32:35], s25 offen offset:2048 sc1
  buffer_load_dwordx4 v[104:107], v2, s[32:35], s24 offen offset:3072 sc1
  buffer_load_dwordx4 v[108:111], v2, s[32:35], s25 offen offset:3072 sc1
  s_add_u32 s24, s17, 12288
  buffer_load_dwordx4 v[16:19], v2, s[32:35], s24 offen offset:0 sc1
  s_waitcnt vmcnt(0)
  v_xor_b32 v9, v64, v14
  v_bitop3_b32 v9, v9, v68, v14 bitop3:0xf6
  v_bitop3_b32 v9, v9, v72, v14 bitop3:0xf6
  v_bitop3_b32 v9, v9, v76, v14 bitop3:0xf6
  v_and_b32 v9, s23, v9
  v_cmp_ne_u32 vcc, 0, v9
  s_cbranch_vccnz .Lvpoll69
  s_branch .Lvback41
.Lvslow42:
  s_mov_b32 s56, 30000
.Lvpoll70:
  s_sub_u32 s56, s56, 1
  s_cbranch_scc1 .Lvback43
  s_add_u32 s24, s17, 8192
  buffer_load_dwordx4 v[80:83], v2, s[32:35], s24 offen offset:0 sc1
  s_add_u32 s25, s18, 8192
  buffer_load_dwordx4 v[84:87], v2, s[32:35], s25 offen offset:0 sc1
  buffer_load_dwordx4 v[88:91], v2, s[32:35], s24 offen offset:1024 sc1
  buffer_load_dwordx4 v[92:95], v2, s[32:35], s25 offen offset:1024 sc1
  buffer_load_dwordx4 v[96:99], v2, s[32:35], s24 offen offset:2048 sc1
  buffer_load_dwordx4 v[100:103], v2, s[32:35], s25 offen offset:2048 sc1
  buffer_load_dwordx4 v[104:107], v2, s[32:35], s24 offen offset:3072 sc1
  buffer_load_dwordx4 v[108:111], v2, s[32:35], s25 offen offset:3072 sc1
  s_add_u32 s24, s17, 12288
  buffer_load_dwordx4 v[16:19], v2, s[32:35], s24 offen offset:0 sc1
  s_add_u32 s25, s18, 12288
  buffer_load_dwordx4 v[20:23], v2, s[32:35], s25 offen offset:0 sc1
  buffer_load_dwordx4 v[24:27], v2, s[32:35], s24 offen offset:1024 sc1
  buffer_load_dwordx4 v[28:31], v2, s[32:35], s25 offen offset:1024 sc1
  buffer_load_dwordx4 v[32:35], v2, s[32:35], s24 offen offset:2048 sc1
  s_waitcnt vmcnt(0)
  v_xor_b32 v9, v80, v14
  v_bitop3_b32 v9, v9, v84, v14 bitop3:0xf6
  v_bitop3_b32 v9, v9, v88, v14 bitop3:0xf6
  v_bitop3_b32 v9, v9, v92, v14 bitop3:0xf6
  v_and_b32 v9, s23, v9
  v_cmp_ne_u32 vcc, 0, v9
  s_cbranch_vccnz .Lvpoll70
  s_branch .Lvback43
.Lvslow44:
  s_mov_b32 s56, 30000
.Lvpoll71:
  s_sub_u32 s56, s56, 1
  s_cbranch_scc1 .Lvback45
  s_add_u32 s24, s17, 8192
  buffer_load_dwordx4 v[96:99], v2, s[32:35], s24 offen offset:2048 sc1
  s_add_u32 s25, s18, 8192
  buffer_load_dwordx4 v[100:103], v2, s[32:35], s25 offen offset:2048 sc1
  buffer_load_dwordx4 v[104:107], v2, s[32:35], s24 offen offset:3072 sc1
  buffer_load_dwordx4 v[108:111], v2, s[32:35], s25 offen offset:3072 sc1
  s_add_u32 s24, s17, 12288
  buffer_load_dwordx4 v[16:19], v2, s[32:35], s24 offen offset:0 sc1
  s_add_u32 s25, s18, 12288
  buffer_load_dwordx4 v[20:23], v2, s[32:35], s25 offen offset:0 sc1
  buffer_load_dwordx4 v[24:27], v2, s[32:35], s24 offen offset:1024 sc1
  buffer_load_dwordx4 v[28:31], v2, s[32:35], s25 offen offset:1024 sc1
  buffer_load_dwordx4 v[32:35], v2, s[32:35], s24 offen offset:2048 sc1
  buffer_load_dwordx4 v[36:39], v2, s[32:35], s25 offen offset:2048 sc1
  buffer_load_dwordx4 v[40:43], v2, s[32:35], s24 offen offset:3072 sc1
  buffer_load_dwordx4 v[44:47], v2, s[32:35], s25 offen offset:3072 sc1
  s_add_u32 s24, s17, 16384
  buffer_load_dwordx4 v[48:51], v2, s[32:35], s24 offen offset:0 sc1
  s_waitcnt vmcnt(0)
  v_xor_b32 v9, v96, v14
  v_bitop3_b32 v9, v9, v100, v14 bitop3:0xf6
  v_bitop3_b32 v9, v9, v104, v14 bitop3:0xf6
  v_bitop3_b32 v9, v9, v108, v14 bitop3:0xf6
  v_and_b32 v9, s23, v9
  v_cmp_ne_u32 vcc, 0, v9
  s_cbranch_vccnz .Lvpoll71
  s_branch .Lvback45
.Lvslow46:
  s_mov_b32 s56, 30000
.Lvpoll72:
  s_sub_u32 s56, s56, 1
  s_cbranch_scc1 .Lvback47
  s_add_u32 s24, s17, 12288
  buffer_load_dwordx4 v[16:19], v2, s[32:35], s24 offen offset:0 sc1
  s_add_u32 s25, s18, 12288
  buffer_load_dwordx4 v[20:23], v2, s[32:35], s25 offen offset:0 sc1
  buffer_load_dwordx4 v[24:27], v2, s[32:35], s24 offen offset:1024 sc1
  buffer_load_dwordx4 v[28:31], v2, s[32:35], s25 offen offset:1024 sc1
  buffer_load_dwordx4 v[32:35], v2, s[32:35], s24 offen offset:2048 sc1
  buffer_load_dwordx4 v[36:39], v2, s[32:35], s25 offen offset:2048 sc1
  buffer_load_dwordx4 v[40:43], v2, s[32:35], s24 offen offset:3072 sc1
  buffer_load_dwordx4 v[44:47], v2, s[32:35], s25 offen offset:3072 sc1
  s_add_u32 s24, s17, 16384
  buffer_load_dwordx4 v[48:51], v2, s[32:35], s24 offen offset:0 sc1
  s_add_u32 s25, s18, 16384
  buffer_load_dwordx4 v[52:55], v2, s[32:35], s25 offen offset:0 sc1
  buffer_load_dwordx4 v[56:59], v2, s[32:35], s24 offen offset:1024 sc1
  buffer_load_dwordx4 v[60:63], v2, s[32:35], s25 offen offset:1024 sc1
  buffer_load_dwordx4 v[64:67], v2, s[32:35], s24 offen offset:2048 sc1
  s_waitcnt vmcnt(0)
  v_xor_b32 v9, v16, v14
  v_bitop3_b32 v9, v9, v20, v14 bitop3:0xf6
  v_bitop3_b32 v9, v9, v24, v14 bitop3:0xf6
  v_bitop3_b32 v9, v9, v28, v14 bitop3:0xf6
  v_and_b32 v9, s23, v9
  v_cmp_ne_u32 vcc, 0, v9
  s_cbranch_vccnz .Lvpoll72
  s_branch .Lvback47
.Lvslow48:
  s_mov_b32 s56, 30000
.Lvpoll73:
  s_sub_u32 s56, s56, 1
  s_cbranch_scc1 .Lvback49
  s_add_u32 s24, s17, 12288
  buffer_load_dwordx4 v[32:35], v2, s[32:35], s24 offen offset:2048 sc1
  s_add_u32 s25, s18, 12288
  buffer_load_dwordx4 v[36:39], v2, s[32:35], s25 offen offset:2048 sc1
  buffer_load_dwordx4 v[40:43], v2, s[32:35], s24 offen offset:3072 sc1
  buffer_load_dwordx4 v[44:47], v2, s[32:35], s25 offen offset:3072 sc1
  s_add_u32 s24, s17, 16384
  buffer_load_dwordx4 v[48:51], v2, s[32:35], s24 offen offset:0 sc1
  s_add_u32 s25, s18, 16384
  buffer_load_dwordx4 v[52:55], v2, s[32:35], s25 offen offset:0 sc1
  buffer_load_dwordx4 v[56:59], v2, s[32:35], s24 offen offset:1024 sc1
  buffer_load_dwordx4 v[60:63], v2, s[32:35], s25 offen offset:1024 sc1
  buffer_load_dwordx4 v[64:67], v2, s[32:35], s24 offen offset:2048 sc1
  buffer_load_dwordx4 v[68:71], v2, s[32:35], s25 offen offset:2048 sc1
  buffer_load_dwordx4 v[72:75], v2, s[32:35], s24 offen offset:3072 sc1
  buffer_load_dwordx4 v[76:79], v2, s[32:35], s25 offen offset:3072 sc1
  s_add_u32 s24, s17, 20480
  buffer_load_dwordx4 v[80:83], v2, s[32:35], s24 offen offset:0 sc1
  s_waitcnt vmcnt(0)
  v_xor_b32 v9, v32, v14
  v_bitop3_b32 v9, v9, v36, v14 bitop3:0xf6
  v_bitop3_b32 v9, v9, v40, v14 bitop3:0xf6
  v_bitop3_b32 v9, v9, v44, v14 bitop3:0xf6
  v_and_b32 v9, s23, v9
  v_cmp_ne_u32 vcc, 0, v9
  s_cbranch_vccnz .Lvpoll73
  s_branch .Lvback49
.Lvslow50:
  s_mov_b32 s56, 30000
.Lvpoll74:
  s_sub_u32 s56, s56, 1
  s_cbranch_scc1 .Lvback51
  s_add_u32 s24, s17, 16384
  buffer_load_dwordx4 v[48:51], v2, s[32:35], s24 offen offset:0 sc1
  s_add_u32 s25, s18, 16384
  buffer_load_dwordx4 v[52:55], v2, s[32:35], s25 offen offset:0 sc1
  buffer_load_dwordx4 v[56:59], v2, s[32:35], s24 offen offset:1024 sc1
  buffer_load_dwordx4 v[60:63], v2, s[32:35], s25 offen offset:1024 sc1
  buffer_load_dwordx4 v[64:67], v2, s[32:35], s24 offen offset:2048 sc1
  buffer_load_dwordx4 v[68:71], v2, s[32:35], s25 offen offset:2048 sc1
  buffer_load_dwordx4 v[72:75], v2, s[32:35], s24 offen offset:3072 sc1
  buffer_load_dwordx4 v[76:79], v2, s[32:35], s25 offen offset:3072 sc1
  s_add_u32 s24, s17, 20480
  buffer_load_dwordx4 v[80:83], v2, s[32:35], s24 offen offset:0 sc1
  s_add_u32 s25, s18, 20480
  buffer_load_dwordx4 v[84:87], v2, s[32:35], s25 offen offset:0 sc1
  buffer_load_dwordx4 v[88:91], v2, s[32:35], s24 offen offset:1024 sc1
  buffer_load_dwordx4 v[92:95], v2, s[32:35], s25 offen offset:1024 sc1
  buffer_load_dwordx4 v[96:99], v2, s[32:35], s24 offen offset:2048 sc1
  s_waitcnt vmcnt(0)
  v_xor_b32 v9, v48, v14
  v_bitop3_b32 v9, v9, v52, v14 bitop3:0xf6
  v_bitop3_b32 v9, v9, v56, v14 bitop3:0xf6
  v_bitop3_b32 v9, v9, v60, v14 bitop3:0xf6
  v_and_b32 v9, s23, v9
  v_cmp_ne_u32 vcc, 0, v9
  s_cbranch_vccnz .Lvpoll74
  s_branch .Lvback51
.Lvslow52:
  s_mov_b32 s56, 30000
.Lvpoll75:
  s_sub_u32 s56, s56, 1
  s_cbranch_scc1 .Lvback53
  s_add_u32 s24, s17, 16384
  buffer_load_dwordx4 v[64:67], v2, s[32:35], s24 offen offset:2048 sc1
  s_add_u32 s25, s18, 16384
  buffer_load_dwordx4 v[68:71], v2, s[32:35], s25 offen offset:2048 sc1
  buffer_load_dwordx4 v[72:75], v2, s[32:35], s24 offen offset:3072 sc1
  buffer_load_dwordx4 v[76:79], v2, s[32:35], s25 offen offset:3072 sc1
  s_add_u32 s24, s17, 20480
  buffer_load_dwordx4 v[80:83], v2, s[32:35], s24 offen offset:0 sc1
  s_add_u32 s25, s18, 20480
  buffer_load_dwordx4 v[84:87], v2, s[32:35], s25 offen offset:0 sc1
  buffer_load_dwordx4 v[88:91], v2, s[32:35], s24 offen offset:1024 sc1
  buffer_load_dwordx4 v[92:95], v2, s[32:35], s25 offen offset:1024 sc1
  buffer_load_dwordx4 v[96:99], v2, s[32:35], s24 offen offset:2048 sc1
  buffer_load_dwordx4 v[100:103], v2, s[32:35], s25 offen offset:2048 sc1
  buffer_load_dwordx4 v[104:107], v2, s[32:35], s24 offen offset:3072 sc1
  buffer_load_dwordx4 v[108:111], v2, s[32:35], s25 offen offset:3072 sc1
  s_add_u32 s24, s17, 24576
  buffer_load_dwordx4 v[16:19], v2, s[32:35], s24 offen offset:0 sc1
  s_waitcnt vmcnt(0)
  v_xor_b32 v9, v64, v14
  v_bitop3_b32 v9, v9, v68, v14 bitop3:0xf6
  v_bitop3_b32 v9, v9, v72, v14 bitop3:0xf6
  v_bitop3_b32 v9, v9, v76, v14 bitop3:0xf6
  v_and_b32 v9, s23, v9
  v_cmp_ne_u32 vcc, 0, v9
  s_cbranch_vccnz .Lvpoll75
  s_branch .Lvback53
.Lvslow54:
  s_mov_b32 s56, 30000
.Lvpoll76:
  s_sub_u32 s56, s56, 1
  s_cbranch_scc1 .Lvback55
  s_add_u32 s24, s17, 20480
  buffer_load_dwordx4 v[80:83], v2, s[32:35], s24 offen offset:0 sc1
  s_add_u32 s25, s18, 20480
  buffer_load_dwordx4 v[84:87], v2, s[32:35], s25 offen offset:0 sc1
  buffer_load_dwordx4 v[88:91], v2, s[32:35], s24 offen offset:1024 sc1
  buffer_load_dwordx4 v[92:95], v2, s[32:35], s25 offen offset:1024 sc1
  buffer_load_dwordx4 v[96:99], v2, s[32:35], s24 offen offset:2048 sc1
  buffer_load_dwordx4 v[100:103], v2, s[32:35], s25 offen offset:2048 sc1
  buffer_load_dwordx4 v[104:107], v2, s[32:35], s24 offen offset:3072 sc1
  buffer_load_dwordx4 v[108:111], v2, s[32:35], s25 offen offset:3072 sc1
  s_add_u32 s24, s17, 24576
  buffer_load_dwordx4 v[16:19], v2, s[32:35], s24 offen offset:0 sc1
  s_add_u32 s25, s18, 24576
  buffer_load_dwordx4 v[20:23], v2, s[32:35], s25 offen offset:0 sc1
  buffer_load_dwordx4 v[24:27], v2, s[32:35], s24 offen offset:1024 sc1
  buffer_load_dwordx4 v[28:31], v2, s[32:35], s25 offen offset:1024 sc1
  buffer_load_dwordx4 v[32:35], v2, s[32:35], s24 offen offset:2048 sc1
  s_waitcnt vmcnt(0)
  v_xor_b32 v9, v80, v14
  v_bitop3_b32 v9, v9, v84, v14 bitop3:0xf6
  v_bitop3_b32 v9, v9, v88, v14 bitop3:0xf6
  v_bitop3_b32 v9, v9, v92, v14 bitop3:0xf6
  v_and_b32 v9, s23, v9
  v_cmp_ne_u32 vcc, 0, v9
  s_cbranch_vccnz .Lvpoll76
  s_branch .Lvback55
.Lvslow56:
  s_mov_b32 s56, 30000
.Lvpoll77:
  s_sub_u32 s56, s56, 1
  s_cbranch_scc1 .Lvback57
  s_add_u32 s24, s17, 20480
  buffer_load_dwordx4 v[96:99], v2, s[32:35], s24 offen offset:2048 sc1
  s_add_u32 s25, s18, 20480
  buffer_load_dwordx4 v[100:103], v2, s[32:35], s25 offen offset:2048 sc1
  buffer_load_dwordx4 v[104:107], v2, s[32:35], s24 offen offset:3072 sc1
  buffer_load_dwordx4 v[108:111], v2, s[32:35], s25 offen offset:3072 sc1
  s_add_u32 s24, s17, 24576
  buffer_load_dwordx4 v[16:19], v2, s[32:35], s24 offen offset:0 sc1
  s_add_u32 s25, s18, 24576
  buffer_load_dwordx4 v[20:23], v2, s[32:35], s25 offen offset:0 sc1
  buffer_load_dwordx4 v[24:27], v2, s[32:35], s24 offen offset:1024 sc1
  buffer_load_dwordx4 v[28:31], v2, s[32:35], s25 offen offset:1024 sc1
  buffer_load_dwordx4 v[32:35], v2, s[32:35], s24 offen offset:2048 sc1
  buffer_load_dwordx4 v[36:39], v2, s[32:35], s25 offen offset:2048 sc1
  buffer_load_dwordx4 v[40:43], v2, s[32:35], s24 offen offset:3072 sc1
  buffer_load_dwordx4 v[44:47], v2, s[32:35], s25 offen offset:3072 sc1
  s_waitcnt vmcnt(0)
  v_xor_b32 v9, v96, v14
  v_bitop3_b32 v9, v9, v100, v14 bitop3:0xf6
  v_bitop3_b32 v9, v9, v104, v14 bitop3:0xf6
  v_bitop3_b32 v9, v9, v108, v14 bitop3:0xf6
  v_and_b32 v9, s23, v9
  v_cmp_ne_u32 vcc, 0, v9
  s_cbranch_vccnz .Lvpoll77
  s_branch .Lvback57
.Lvslow58:
  s_mov_b32 s56, 30000
.Lvpoll78:
  s_sub_u32 s56, s56, 1
  s_cbranch_scc1 .Lvback59
  s_add_u32 s24, s17, 24576
  buffer_load_dwordx4 v[16:19], v2, s[32:35], s24 offen offset:0 sc1
  s_add_u32 s25, s18, 24576
  buffer_load_dwordx4 v[20:23], v2, s[32:35], s25 offen offset:0 sc1
  buffer_load_dwordx4 v[24:27], v2, s[32:35], s24 offen offset:1024 sc1
  buffer_load_dwordx4 v[28:31], v2, s[32:35], s25 offen offset:1024 sc1
  buffer_load_dwordx4 v[32:35], v2, s[32:35], s24 offen offset:2048 sc1
  buffer_load_dwordx4 v[36:39], v2, s[32:35], s25 offen offset:2048 sc1
  buffer_load_dwordx4 v[40:43], v2, s[32:35], s24 offen offset:3072 sc1
  buffer_load_dwordx4 v[44:47], v2, s[32:35], s25 offen offset:3072 sc1
  s_waitcnt vmcnt(0)
  v_xor_b32 v9, v16, v14
  v_bitop3_b32 v9, v9, v20, v14 bitop3:0xf6
  v_bitop3_b32 v9, v9, v24, v14 bitop3:0xf6
  v_bitop3_b32 v9, v9, v28, v14 bitop3:0xf6
  v_and_b32 v9, s23, v9
  v_cmp_ne_u32 vcc, 0, v9
  s_cbranch_vccnz .Lvpoll78
  s_branch .Lvback59
.Lvslow60:
  s_mov_b32 s56, 30000
.Lvpoll79:
  s_sub_u32 s56, s56, 1
  s_cbranch_scc1 .Lvback61
  s_add_u32 s24, s17, 24576
  buffer_load_dwordx4 v[32:35], v2, s[32:35], s24 offen offset:2048 sc1
  s_add_u32 s25, s18, 24576
  buffer_load_dwordx4 v[36:39], v2, s[32:35], s25 offen offset:2048 sc1
  buffer_load_dwordx4 v[40:43], v2, s[32:35], s24 offen offset:3072 sc1
  buffer_load_dwordx4 v[44:47], v2, s[32:35], s25 offen offset:3072 sc1
  s_waitcnt vmcnt(0)
  v_xor_b32 v9, v32, v14
  v_bitop3_b32 v9, v9, v36, v14 bitop3:0xf6
  v_bitop3_b32 v9, v9, v40, v14 bitop3:0xf6
  v_bitop3_b32 v9, v9, v44, v14 bitop3:0xf6
  v_and_b32 v9, s23, v9
  v_cmp_ne_u32 vcc, 0, v9
  s_cbranch_vccnz .Lvpoll79
  s_branch .Lvback61
.Lcode_end:
.section .rodata,"a"
.p2align 6
.amdhsa_kernel adaLN_cond__linear_kernel_hedgehog__geglu_ffn__prompt_kernel
  .amdhsa_next_free_vgpr 512
  .amdhsa_next_free_sgpr 70
  .amdhsa_accum_offset 256
  .amdhsa_group_segment_fixed_size 0
  .amdhsa_kernarg_size 104
  .amdhsa_user_sgpr_count 2
  .amdhsa_user_sgpr_kernarg_segment_ptr 1
  .amdhsa_system_sgpr_workgroup_id_x 1
  .amdhsa_float_denorm_mode_32 3
  .amdhsa_float_denorm_mode_16_64 3
.end_amdhsa_kernel
```
